```python
import torch

def _softmax(x, axis=-1):
    return torch.softmax(x, dim=axis)
def _gelu(x):
    return torch.nn.functional.gelu(x, approximate="tanh")
def _silu(x):
    return torch.nn.functional.silu(x)
def _sigmoid(x):
    return torch.sigmoid(x)
def _layernorm(x, axis=-1, eps=1e-5):
    m = x.mean(dim=axis, keepdim=True)
    v = x.var(dim=axis, keepdim=True, unbiased=False)
    return (x - m) / torch.sqrt(v + eps)
def _scatter_add(tgt, idx, src, axis=0):
    return tgt.clone().index_add_(axis, idx, src)
def _segment_sum(src, seg, n):
    out = torch.zeros((n,) + src.shape[1:], dtype=src.dtype)
    return out.index_add_(0, seg, src)
def _pad(x, pw):
    flat = tuple(v for pair in reversed(pw) for v in pair)
    return torch.nn.functional.pad(x, flat)

kernel_name = 'standalone__mha_block_cached__near_ridge'

def setup_inputs():

    _w = (lambda a: (lambda t: t.to(torch.bfloat16) if t.is_floating_point() else t)(torch.as_tensor(a)))
    B, Sq, D = 8, 240, 640
    H, Sk, Dh = 32, 2048, 128
    return {
        "x": _w((lambda *s: torch.randn(*s, dtype=torch.bfloat16) * 0.8)(B, Sq, D)),
        "k_cache": _w((lambda *s: torch.randn(*s, dtype=torch.bfloat16) * 0.8)(B, H, Sk, Dh)),
        "v_cache": _w((lambda *s: torch.randn(*s, dtype=torch.bfloat16) * 0.05)(B, H, Sk, Dh)),
        "wq": _w((lambda *s: torch.randn(*s, dtype=torch.bfloat16) * 0.8)(D, H * Dh) * (D ** -0.5)),
        "wo": _w((lambda *s: torch.randn(*s, dtype=torch.bfloat16) * 0.05)(H * Dh, D) * ((H * Dh) ** -0.5)),
    }

def reference(x, k_cache, v_cache, wq, wo):
    B, Sq, D = x.shape
    H, Dh = 32, 128
    q = (lambda x, *d: x.permute(*d))((x @ wq).reshape(B, Sq, H, Dh), 0, 2, 1, 3)
    scores = torch.einsum("bhqd,bhkd->bhqk", q, k_cache) * (Dh ** -0.5)
    p = _softmax(scores, axis=-1)
    o = torch.einsum("bhqk,bhkd->bhqd", p, v_cache)
    return (lambda x, *d: x.permute(*d))(o, 0, 2, 1, 3).reshape(B, Sq, H * Dh) @ wo
```

```asm
; @launch grid=(256,1,1) block=(256,1,1) lds=163840
.amdgcn_target "amdgcn-amd-amdhsa--gfx950"
.text
.globl standalone__mha_block_cached__near_ridge_kernel
.p2align 8
.type standalone__mha_block_cached__near_ridge_kernel,@function
standalone__mha_block_cached__near_ridge_kernel:
    s_load_dwordx4 s[36:39], s[0:1], 0
    s_load_dwordx4 s[40:43], s[0:1], 16
    s_load_dwordx4 s[84:87], s[0:1], 32
    s_load_dwordx4 s[88:91], s[0:1], 48
    s_cmp_ge_u32 s2, 256
    s_cbranch_scc1 L1_end
    v_lshrrev_b32 v1, 6, v0
    v_and_b32 v0, 63, v0
    v_readfirstlane_b32 s3, v1
    s_and_b32 s52, s2, 7
    s_lshr_b32 s46, s2, 3
    s_and_b32 s92, s52, 1
    s_lshl_b32 s92, s92, 2
    s_and_b32 s93, s46, 3
    s_add_u32 s92, s92, s93
    s_lshr_b32 s93, s52, 1
    s_lshl_b32 s93, s93, 3
    s_lshr_b32 s52, s46, 2
    s_add_u32 s93, s93, s52
    s_getpc_b64 s[4:5]
L1_pc:
    s_sub_u32 s4, s4, L1_pc-standalone__mha_block_cached__near_ridge_kernel
    s_subb_u32 s5, s5, 0
    s_and_b32 s52, s46, 7
    s_lshl_b32 s52, s52, 2
    s_add_u32 s52, s52, s3
    s_mul_i32 s52, s52, 1792
    v_and_b32 v2, 15, v0
    v_lshrrev_b32 v1, 4, v0
    v_min_u32 v12, 13, v0
    v_lshl_add_u32 v12, v12, 7, s52
    v_min_u32 v12, L1_end-standalone__mha_block_cached__near_ridge_kernel, v12
    v_mov_b32 v13, s5
    v_add_co_u32 v12, vcc, s4, v12
    v_lshrrev_b32 v3, 3, v0
    v_and_b32 v5, 7, v0
    v_addc_co_u32 v13, vcc, 0, v13, vcc
    global_load_dword v6, v[12:13], off
    v_lshlrev_b32 v9, 2, v1
    v_xor_b32 v9, v2, v9
    v_lshlrev_b32 v9, 4, v9
    v_lshl_add_u32 v9, v1, 13, v9
    v_xor_b32 v8, v5, v1
    v_lshlrev_b32 v8, 4, v8
    v_mul_u32_u24 v10, 1280, v3
    v_xor_b32 v11, 64, v8
    v_add_u32 v8, v10, v8
    v_add_u32 v11, v10, v11
    s_mov_b32 s53, 9216
    s_cmp_eq_u32 s3, 0
    s_cselect_b64 vcc, -1, 0
    s_cselect_b32 s53, 31744, s53
    s_lshl_b32 s54, s53, 1
    v_cndmask_b32 v34, v8, v9, vcc
    v_cndmask_b32 v11, v11, v9, vcc
    v_add_u32 v35, s53, v11
    v_add_u32 v36, s54, v34
    v_add_u32 v37, s54, v35
    s_and_b32 s52, s46, 1
    s_mul_i32 s52, s52, 5
    s_lshr_b32 s53, s46, 2
    s_and_b32 s53, s53, 3
    s_mul_i32 s53, s53, 2
    s_add_u32 s52, s52, s53
    s_cmp_ge_u32 s52, 10
    s_cselect_b32 s53, 10, 0
    s_sub_u32 s52, s52, s53
    s_sub_u32 s53, s3, 1
    s_mul_i32 s51, s53, 163840
    s_lshl_b32 s28, s52, 7
    s_add_u32 s28, s28, s51
    s_add_u32 s51, s51, 1280
    s_mov_b32 s50, 1280
    s_mov_b32 s30, 81920
    s_mov_b32 s31, 40960
    s_mov_b32 s32, -40832
    s_mov_b32 s34, 8192
    s_lshl_b32 s53, s53, 14
    s_add_u32 s12, s53, 32768
    s_add_u32 s13, s53, 36864
    s_add_u32 s14, s53, 98304
    s_add_u32 s15, s53, 102400
    s_mul_i32 s54, s92, 307200
    s_mov_b32 s10, 307200
    s_mov_b32 s11, 0x20000
    s_cmp_lg_u32 s3, 0
    s_cbranch_scc1 L1_xjob
    s_lshl_b32 s28, s52, 19
    s_mov_b32 s51, 5242880
    s_mov_b32 s50, 5242880
    s_mov_b32 s30, 131072
    s_mov_b32 s31, 262144
    s_mov_b32 s32, 262144
    s_mov_b32 s34, 4096
    s_mov_b32 s12, 131072
    s_mov_b32 s13, 139264
    s_mov_b32 s14, 147456
    s_mov_b32 s15, 155648
    s_lshl_b32 s54, s93, 8
    s_sub_u32 s10, 5242880, s54
L1_xjob:
    s_waitcnt lgkmcnt(0)
    s_mov_b32 s0, s51
    s_mov_b32 s1, s50
    s_cmp_eq_u32 s3, 0
    s_cselect_b32 s8, s42, s36
    s_cselect_b32 s9, s43, s37
    s_add_u32 s8, s8, s54
    s_addc_u32 s9, s9, 0
    s_mov_b32 s64, s84
    s_mov_b32 s65, s85
    s_mov_b32 s66, 5242880
    s_mov_b32 s67, 0x20000
    s_cmp_eq_u32 s3, 3
    s_cbranch_scc1 L1_nojob
    s_mov_b32 m0, s12
    s_add_u32 s29, s28, s30
    buffer_load_dwordx4 v34, s[8:11], s28 offen offset:0 lds
    buffer_load_dwordx4 v35, s[8:11], s28 offen offset:1024 lds
    buffer_load_dwordx4 v36, s[8:11], s28 offen offset:2048 lds
    buffer_load_dwordx4 v37, s[8:11], s28 offen offset:3072 lds
    s_add_u32 m0, s12, s34
    s_add_u32 s28, s28, s31
    buffer_load_dwordx4 v34, s[8:11], s29 offen offset:0 lds
    buffer_load_dwordx4 v35, s[8:11], s29 offen offset:1024 lds
    buffer_load_dwordx4 v36, s[8:11], s29 offen offset:2048 lds
    buffer_load_dwordx4 v37, s[8:11], s29 offen offset:3072 lds
    s_mov_b32 m0, s13
    s_add_u32 s29, s28, s30
    buffer_load_dwordx4 v34, s[8:11], s28 offen offset:0 lds
    buffer_load_dwordx4 v35, s[8:11], s28 offen offset:1024 lds
    buffer_load_dwordx4 v36, s[8:11], s28 offen offset:2048 lds
    buffer_load_dwordx4 v37, s[8:11], s28 offen offset:3072 lds
    s_add_u32 m0, s13, s34
    s_add_u32 s28, s28, s32
    buffer_load_dwordx4 v34, s[8:11], s29 offen offset:0 lds
    s_cmp_ge_u32 s28, s0
    s_cselect_b32 s52, s1, 0
    s_sub_u32 s28, s28, s52
    buffer_load_dwordx4 v35, s[8:11], s29 offen offset:1024 lds
    buffer_load_dwordx4 v36, s[8:11], s29 offen offset:2048 lds
    buffer_load_dwordx4 v37, s[8:11], s29 offen offset:3072 lds
L1_nojob:
    s_add_u32 s76, s90, 0x2000000
    s_addc_u32 s77, s91, 0
    s_mov_b32 s78, 8192
    s_mov_b32 s79, 0x20000
    s_mov_b32 s80, s88
    s_mov_b32 s81, s89
    s_mov_b32 s82, 256
    s_mov_b32 s83, 0x20000
    v_mov_b32 v255, 0
    s_xor_b32 s52, s3, 3
    s_lshl_b32 s52, s52, 5
    s_add_u32 s59, s52, s2
    s_cmp_ge_u32 s59, 32
    s_cbranch_scc1 L1_noclr
    s_lshl_b32 s52, s2, 8
    s_mov_b64 exec, 1
    buffer_store_dword v255, v255, s[76:79], s52 offen sc1
    s_mov_b64 exec, -1
L1_noclr:
    s_lshl_b32 s47, s3, 13
    v_and_b32 v4, 3, v0
    v_bfe_u32 v7, v0, 2, 2
    v_lshl_add_u32 v8, v1, 3, v7
    v_lshlrev_b32 v8, 8, v8
    v_lshl_add_u32 v8, v7, 6, v8
    v_lshl_add_u32 v8, v4, 4, v8
    v_add_u32 v38, 131072, v8
    v_xor_b32 v39, 64, v38
    v_xor_b32 v40, 0x80, v38
    v_xor_b32 v41, 0xc0, v38
    v_lshrrev_b32 v8, 1, v2
    v_xor_b32 v8, v1, v8
    v_lshlrev_b32 v8, 4, v8
    v_lshl_add_u32 v8, v2, 7, v8
    v_add_u32 v8, s47, v8
    v_add_u32 v42, 32768, v8
    v_xor_b32 v43, 64, v42
    v_add_u32 v44, 98304, v8
    v_xor_b32 v45, 64, v44
    s_add_u32 s47, s47, 131072
    s_lshl_b32 s52, s92, 5
    s_add_u32 s52, s52, s93
    s_lshl_b32 s52, s52, 19
    s_add_u32 s16, s38, s52
    s_addc_u32 s17, s39, 0
    s_mov_b32 s18, 524288
    s_mov_b32 s19, 0x20000
    s_add_u32 s20, s40, s52
    s_addc_u32 s21, s41, 0
    s_mov_b32 s22, 524288
    s_mov_b32 s23, 0x20000
    s_lshl_b32 s96, s3, 12
    s_add_u32 s50, s96, 32768
    s_add_u32 s95, s96, 16384
    v_xor_b32 v8, v2, v1
    v_lshlrev_b32 v8, 4, v8
    v_lshl_add_u32 v28, v1, 8, v8
    v_xor_b32 v29, 64, v28
    v_xor_b32 v30, 0x80, v28
    v_xor_b32 v31, 0xc0, v28
    v_lshlrev_b32 v9, 1, v1
    v_xor_b32 v9, v2, v9
    v_lshlrev_b32 v9, 4, v9
    v_lshl_add_u32 v32, v1, 8, v9
    v_xor_b32 v33, 0x80, v32
    s_mul_i32 s52, s92, 1966080
    s_add_u32 s24, s90, s52
    s_addc_u32 s25, s91, 0
    s_mov_b32 s26, 1966080
    s_mov_b32 s27, 0x20000
    v_lshl_add_u32 v16, v2, 8, v8
    v_xor_b32 v17, 64, v16
    v_xor_b32 v18, 0x80, v16
    v_xor_b32 v19, 0xc0, v16
    v_lshl_add_u32 v8, v1, 2, v7
    v_and_b32 v9, 7, v8
    v_lshlrev_b32 v8, 8, v8
    v_lshl_add_u32 v8, v9, 5, v8
    v_lshl_add_u32 v8, v4, 3, v8
    v_add_u32 v20, 65536, v8
    v_xor_b32 v21, 32, v20
    v_xor_b32 v22, 64, v20
    v_xor_b32 v23, 96, v20
    v_xor_b32 v24, 128, v20
    v_xor_b32 v25, 160, v20
    v_xor_b32 v26, 192, v20
    v_xor_b32 v27, 224, v20
    v_cmp_eq_u32 vcc, 0, v2
    v_mov_b32 v8, 0x3f803f80
    s_nop 0
    v_cndmask_b32 v248, 0, v8, vcc
    v_cndmask_b32 v249, 0, v8, vcc
    v_cndmask_b32 v250, 0, v8, vcc
    v_cndmask_b32 v251, 0, v8, vcc
    v_lshl_add_u32 v8, v4, 2, v1
    v_lshlrev_b32 v8, 4, v8
    v_lshl_add_u32 v254, v7, 10, v8
    s_mov_b32 s56, 0x3e0293ee
    s_mov_b32 s57, 0x3e0293ee
    s_mul_i32 s53, s46, 26
    s_lshr_b32 s53, s53, 8
    s_mul_i32 s52, s53, 10
    s_sub_u32 s35, s46, s52
    s_andn2_b32 s48, 1, s2
    s_lshl_b32 s48, s48, 2
    s_bfe_u32 s52, s2, 0x20001
    s_add_u32 s48, s48, s52
    s_mul_i32 s52, s48, 15
    s_min_u32 s53, s53, 2
    v_min_u32 v15, 11, v0
    v_mul_u32_u24 v15, 3, v15
    v_add_u32 v15, s53, v15
    v_mul_u32_u24 v15, 1280, v15
    s_mul_i32 s53, s53, 5
    s_add_u32 s52, s52, s53
    s_lshl_b32 s53, s52, 17
    s_add_u32 s68, s90, s53
    s_addc_u32 s69, s91, 0
    s_mov_b32 s70, 655360
    s_mov_b32 s71, 0x20000
    s_mul_i32 s53, s52, 20480
    s_add_u32 s72, s86, s53
    s_addc_u32 s73, s87, 0
    s_mov_b32 s74, 102400
    s_mov_b32 s75, 0x20000
    s_mul_i32 s45, s3, 1310720
    s_lshl_b32 s52, s35, 7
    s_add_u32 s45, s45, s52
    s_lshl_b32 s44, s3, 15
    s_and_b32 s52, s35, 0
    s_mul_i32 s53, s52, 655360
    s_sub_u32 s98, s45, s53
    s_add_u32 s45, s45, s53
    s_lshl_b32 s53, s52, 14
    s_sub_u32 s97, s44, s53
    s_add_u32 s44, s44, s53
    s_lshl_b32 s58, s48, 2
    s_add_u32 s58, s58, s3
    s_lshl_b32 s58, s58, 8
    v_and_b32 v8, 3, v3
    v_lshlrev_b32 v8, 4, v8
    v_lshrrev_b32 v9, 5, v0
    v_add_u32 v8, v8, v9
    v_mul_u32_u24 v8, 1280, v8
    v_lshlrev_b32 v9, 1, v1
    v_xor_b32 v9, v5, v9
    v_lshl_add_u32 v244, v9, 4, v8
    v_add_u32 v245, 1536, v244
    v_add_u32 v246, 79872, v244
    v_add_u32 v247, 81408, v244
    s_cmp_eq_u32 s3, 3
    s_cbranch_scc1 L1_q3
    s_mov_b32 m0, s14
    s_add_u32 s29, s28, s30
    buffer_load_dwordx4 v34, s[8:11], s28 offen offset:0 lds
    buffer_load_dwordx4 v35, s[8:11], s28 offen offset:1024 lds
    buffer_load_dwordx4 v36, s[8:11], s28 offen offset:2048 lds
    buffer_load_dwordx4 v37, s[8:11], s28 offen offset:3072 lds
    s_add_u32 m0, s14, s34
    s_add_u32 s28, s28, s31
    buffer_load_dwordx4 v34, s[8:11], s29 offen offset:0 lds
    buffer_load_dwordx4 v35, s[8:11], s29 offen offset:1024 lds
    buffer_load_dwordx4 v36, s[8:11], s29 offen offset:2048 lds
    buffer_load_dwordx4 v37, s[8:11], s29 offen offset:3072 lds
    s_waitcnt vmcnt(16)
    s_barrier
    ds_read_b128 a[192:195], v42 offset:0
    ds_read_b128 a[196:199], v42 offset:2048
    ds_read_b128 a[208:211], v43 offset:0
    ds_read_b128 a[212:215], v43 offset:2048
    ds_read_b64_tr_b16 a[128:129], v38 offset:0
    ds_read_b64_tr_b16 a[130:131], v38 offset:1024
    ds_read_b64_tr_b16 a[132:133], v38 offset:8
    ds_read_b64_tr_b16 a[134:135], v38 offset:1032
    ds_read_b64_tr_b16 a[136:137], v39 offset:0
    ds_read_b64_tr_b16 a[138:139], v39 offset:1024
    ds_read_b64_tr_b16 a[140:141], v39 offset:8
    ds_read_b64_tr_b16 a[142:143], v39 offset:1032
    ds_read_b64_tr_b16 a[144:145], v40 offset:0
    ds_read_b64_tr_b16 a[146:147], v40 offset:1024
    ds_read_b64_tr_b16 a[148:149], v40 offset:8
    ds_read_b64_tr_b16 a[150:151], v40 offset:1032
    ds_read_b64_tr_b16 a[152:153], v41 offset:0
    ds_read_b64_tr_b16 a[154:155], v41 offset:1024
    ds_read_b64_tr_b16 a[156:157], v41 offset:8
    ds_read_b64_tr_b16 a[158:159], v41 offset:1032
    s_mov_b32 m0, s15
    s_add_u32 s29, s28, s30
    buffer_load_dwordx4 v34, s[8:11], s28 offen offset:0 lds
    buffer_load_dwordx4 v35, s[8:11], s28 offen offset:1024 lds
    buffer_load_dwordx4 v36, s[8:11], s28 offen offset:2048 lds
    buffer_load_dwordx4 v37, s[8:11], s28 offen offset:3072 lds
    s_add_u32 m0, s15, s34
    s_add_u32 s28, s28, s32
    buffer_load_dwordx4 v34, s[8:11], s29 offen offset:0 lds
    s_cmp_ge_u32 s28, s0
    s_cselect_b32 s52, s1, 0
    s_sub_u32 s28, s28, s52
    buffer_load_dwordx4 v35, s[8:11], s29 offen offset:1024 lds
    buffer_load_dwordx4 v36, s[8:11], s29 offen offset:2048 lds
    buffer_load_dwordx4 v37, s[8:11], s29 offen offset:3072 lds
    s_waitcnt lgkmcnt(0)
    s_waitcnt vmcnt(16)
    s_barrier
    v_mfma_f32_16x16x32_bf16 v[112:115], a[128:131], a[192:195], 0
    s_mov_b32 m0, s12
    ds_read_b128 a[200:203], v42 offset:4096
    v_mfma_f32_16x16x32_bf16 v[116:119], a[132:135], a[192:195], 0
    s_add_u32 s29, s28, s30
    ds_read_b128 a[204:207], v42 offset:6144
    v_mfma_f32_16x16x32_bf16 v[120:123], a[136:139], a[192:195], 0
    buffer_load_dwordx4 v34, s[8:11], s28 offen offset:0 lds
    v_mfma_f32_16x16x32_bf16 v[124:127], a[140:143], a[192:195], 0
    ds_read_b128 a[216:219], v43 offset:4096
    v_accvgpr_write_b32 a0, 0
    v_mfma_f32_16x16x32_bf16 v[128:131], a[144:147], a[192:195], 0
    ds_read_b128 a[220:223], v43 offset:6144
    v_accvgpr_write_b32 a1, 0
    v_mfma_f32_16x16x32_bf16 v[132:135], a[148:151], a[192:195], 0
    ds_read_b64_tr_b16 a[160:161], v38 offset:8192
    v_accvgpr_write_b32 a2, 0
    v_mfma_f32_16x16x32_bf16 v[136:139], a[152:155], a[192:195], 0
    buffer_load_dwordx4 v35, s[8:11], s28 offen offset:1024 lds
    v_mfma_f32_16x16x32_bf16 v[140:143], a[156:159], a[192:195], 0
    ds_read_b64_tr_b16 a[162:163], v38 offset:9216
    v_accvgpr_write_b32 a3, 0
    v_mfma_f32_16x16x32_bf16 v[172:175], a[156:159], a[196:199], 0
    ds_read_b64_tr_b16 a[164:165], v38 offset:8200
    v_accvgpr_write_b32 a4, 0
    v_mfma_f32_16x16x32_bf16 v[168:171], a[152:155], a[196:199], 0
    ds_read_b64_tr_b16 a[166:167], v38 offset:9224
    v_accvgpr_write_b32 a5, 0
    v_mfma_f32_16x16x32_bf16 v[164:167], a[148:151], a[196:199], 0
    buffer_load_dwordx4 v36, s[8:11], s28 offen offset:2048 lds
    v_mfma_f32_16x16x32_bf16 v[160:163], a[144:147], a[196:199], 0
    ds_read_b64_tr_b16 a[168:169], v39 offset:8192
    v_accvgpr_write_b32 a6, 0
    v_mfma_f32_16x16x32_bf16 v[156:159], a[140:143], a[196:199], 0
    ds_read_b64_tr_b16 a[170:171], v39 offset:9216
    v_accvgpr_write_b32 a7, 0
    v_mfma_f32_16x16x32_bf16 v[152:155], a[136:139], a[196:199], 0
    ds_read_b64_tr_b16 a[172:173], v39 offset:8200
    v_accvgpr_write_b32 a8, 0
    v_mfma_f32_16x16x32_bf16 v[148:151], a[132:135], a[196:199], 0
    buffer_load_dwordx4 v37, s[8:11], s28 offen offset:3072 lds
    v_mfma_f32_16x16x32_bf16 v[144:147], a[128:131], a[196:199], 0
    s_waitcnt lgkmcnt(9)
    s_add_u32 m0, s12, s34
    ds_read_b64_tr_b16 a[174:175], v39 offset:9224
    v_mfma_f32_16x16x32_bf16 v[176:179], a[128:131], a[200:203], 0
    s_add_u32 s28, s28, s31
    ds_read_b64_tr_b16 a[176:177], v40 offset:8192
    v_mfma_f32_16x16x32_bf16 v[180:183], a[132:135], a[200:203], 0
    ds_read_b64_tr_b16 a[178:179], v40 offset:9216
    v_accvgpr_write_b32 a9, 0
    v_mfma_f32_16x16x32_bf16 v[184:187], a[136:139], a[200:203], 0
    buffer_load_dwordx4 v34, s[8:11], s29 offen offset:0 lds
    v_mfma_f32_16x16x32_bf16 v[188:191], a[140:143], a[200:203], 0
    ds_read_b64_tr_b16 a[180:181], v40 offset:8200
    v_accvgpr_write_b32 a10, 0
    v_mfma_f32_16x16x32_bf16 v[192:195], a[144:147], a[200:203], 0
    ds_read_b64_tr_b16 a[182:183], v40 offset:9224
    v_accvgpr_write_b32 a11, 0
    v_mfma_f32_16x16x32_bf16 v[196:199], a[148:151], a[200:203], 0
    ds_read_b64_tr_b16 a[184:185], v41 offset:8192
    v_accvgpr_write_b32 a12, 0
    v_mfma_f32_16x16x32_bf16 v[200:203], a[152:155], a[200:203], 0
    buffer_load_dwordx4 v35, s[8:11], s29 offen offset:1024 lds
    v_mfma_f32_16x16x32_bf16 v[204:207], a[156:159], a[200:203], 0
    ds_read_b64_tr_b16 a[186:187], v41 offset:9216
    v_accvgpr_write_b32 a13, 0
    v_mfma_f32_16x16x32_bf16 v[236:239], a[156:159], a[204:207], 0
    ds_read_b64_tr_b16 a[188:189], v41 offset:8200
    v_accvgpr_write_b32 a14, 0
    v_mfma_f32_16x16x32_bf16 v[232:235], a[152:155], a[204:207], 0
    ds_read_b64_tr_b16 a[190:191], v41 offset:9224
    v_accvgpr_write_b32 a15, 0
    v_mfma_f32_16x16x32_bf16 v[228:231], a[148:151], a[204:207], 0
    buffer_load_dwordx4 v36, s[8:11], s29 offen offset:2048 lds
    v_mfma_f32_16x16x32_bf16 v[224:227], a[144:147], a[204:207], 0
    v_mfma_f32_16x16x32_bf16 v[220:223], a[140:143], a[204:207], 0
    v_mfma_f32_16x16x32_bf16 v[216:219], a[136:139], a[204:207], 0
    v_mfma_f32_16x16x32_bf16 v[212:215], a[132:135], a[204:207], 0
    buffer_load_dwordx4 v37, s[8:11], s29 offen offset:3072 lds
    v_mfma_f32_16x16x32_bf16 v[208:211], a[128:131], a[204:207], 0
    s_waitcnt lgkmcnt(0)
    s_waitcnt vmcnt(16)
    s_barrier
    v_mfma_f32_16x16x32_bf16 v[112:115], a[160:163], a[208:211], v[112:115]
    s_mov_b32 m0, s13
    ds_read_b128 a[224:227], v44 offset:0
    v_mfma_f32_16x16x32_bf16 v[116:119], a[164:167], a[208:211], v[116:119]
    s_add_u32 s29, s28, s30
    ds_read_b128 a[228:231], v44 offset:2048
    v_mfma_f32_16x16x32_bf16 v[120:123], a[168:171], a[208:211], v[120:123]
    buffer_load_dwordx4 v34, s[8:11], s28 offen offset:0 lds
    v_mfma_f32_16x16x32_bf16 v[124:127], a[172:175], a[208:211], v[124:127]
    ds_read_b128 a[240:243], v45 offset:0
    v_accvgpr_write_b32 a16, 0
    v_mfma_f32_16x16x32_bf16 v[128:131], a[176:179], a[208:211], v[128:131]
    ds_read_b128 a[244:247], v45 offset:2048
    v_accvgpr_write_b32 a17, 0
    v_mfma_f32_16x16x32_bf16 v[132:135], a[180:183], a[208:211], v[132:135]
    ds_read_b64_tr_b16 a[128:129], v38 offset:16384
    v_accvgpr_write_b32 a18, 0
    v_mfma_f32_16x16x32_bf16 v[136:139], a[184:187], a[208:211], v[136:139]
    buffer_load_dwordx4 v35, s[8:11], s28 offen offset:1024 lds
    v_mfma_f32_16x16x32_bf16 v[140:143], a[188:191], a[208:211], v[140:143]
    ds_read_b64_tr_b16 a[130:131], v38 offset:17408
    v_accvgpr_write_b32 a19, 0
    v_mfma_f32_16x16x32_bf16 v[172:175], a[188:191], a[212:215], v[172:175]
    ds_read_b64_tr_b16 a[132:133], v38 offset:16392
    v_accvgpr_write_b32 a20, 0
    v_mfma_f32_16x16x32_bf16 v[168:171], a[184:187], a[212:215], v[168:171]
    ds_read_b64_tr_b16 a[134:135], v38 offset:17416
    v_accvgpr_write_b32 a21, 0
    v_mfma_f32_16x16x32_bf16 v[164:167], a[180:183], a[212:215], v[164:167]
    buffer_load_dwordx4 v36, s[8:11], s28 offen offset:2048 lds
    v_mfma_f32_16x16x32_bf16 v[160:163], a[176:179], a[212:215], v[160:163]
    ds_read_b64_tr_b16 a[136:137], v39 offset:16384
    v_accvgpr_write_b32 a22, 0
    v_mfma_f32_16x16x32_bf16 v[156:159], a[172:175], a[212:215], v[156:159]
    ds_read_b64_tr_b16 a[138:139], v39 offset:17408
    v_accvgpr_write_b32 a23, 0
    v_mfma_f32_16x16x32_bf16 v[152:155], a[168:171], a[212:215], v[152:155]
    ds_read_b64_tr_b16 a[140:141], v39 offset:16392
    v_accvgpr_write_b32 a24, 0
    v_mfma_f32_16x16x32_bf16 v[148:151], a[164:167], a[212:215], v[148:151]
    buffer_load_dwordx4 v37, s[8:11], s28 offen offset:3072 lds
    v_mfma_f32_16x16x32_bf16 v[144:147], a[160:163], a[212:215], v[144:147]
    s_add_u32 m0, s13, s34
    ds_read_b64_tr_b16 a[142:143], v39 offset:17416
    v_mfma_f32_16x16x32_bf16 v[176:179], a[160:163], a[216:219], v[176:179]
    s_add_u32 s28, s28, s32
    ds_read_b64_tr_b16 a[144:145], v40 offset:16384
    v_mfma_f32_16x16x32_bf16 v[180:183], a[164:167], a[216:219], v[180:183]
    ds_read_b64_tr_b16 a[146:147], v40 offset:17408
    v_accvgpr_write_b32 a25, 0
    v_mfma_f32_16x16x32_bf16 v[184:187], a[168:171], a[216:219], v[184:187]
    buffer_load_dwordx4 v34, s[8:11], s29 offen offset:0 lds
    v_mfma_f32_16x16x32_bf16 v[188:191], a[172:175], a[216:219], v[188:191]
    s_cmp_ge_u32 s28, s0
    ds_read_b64_tr_b16 a[148:149], v40 offset:16392
    v_mfma_f32_16x16x32_bf16 v[192:195], a[176:179], a[216:219], v[192:195]
    s_cselect_b32 s52, s1, 0
    ds_read_b64_tr_b16 a[150:151], v40 offset:17416
    v_mfma_f32_16x16x32_bf16 v[196:199], a[180:183], a[216:219], v[196:199]
    s_sub_u32 s28, s28, s52
    ds_read_b64_tr_b16 a[152:153], v41 offset:16384
    v_mfma_f32_16x16x32_bf16 v[200:203], a[184:187], a[216:219], v[200:203]
    buffer_load_dwordx4 v35, s[8:11], s29 offen offset:1024 lds
    v_mfma_f32_16x16x32_bf16 v[204:207], a[188:191], a[216:219], v[204:207]
    ds_read_b64_tr_b16 a[154:155], v41 offset:17408
    v_accvgpr_write_b32 a26, 0
    v_mfma_f32_16x16x32_bf16 v[236:239], a[188:191], a[220:223], v[236:239]
    ds_read_b64_tr_b16 a[156:157], v41 offset:16392
    v_accvgpr_write_b32 a27, 0
    v_mfma_f32_16x16x32_bf16 v[232:235], a[184:187], a[220:223], v[232:235]
    ds_read_b64_tr_b16 a[158:159], v41 offset:17416
    v_accvgpr_write_b32 a28, 0
    v_mfma_f32_16x16x32_bf16 v[228:231], a[180:183], a[220:223], v[228:231]
    buffer_load_dwordx4 v36, s[8:11], s29 offen offset:2048 lds
    v_mfma_f32_16x16x32_bf16 v[224:227], a[176:179], a[220:223], v[224:227]
    v_mfma_f32_16x16x32_bf16 v[220:223], a[172:175], a[220:223], v[220:223]
    v_mfma_f32_16x16x32_bf16 v[216:219], a[168:171], a[220:223], v[216:219]
    v_mfma_f32_16x16x32_bf16 v[212:215], a[164:167], a[220:223], v[212:215]
    buffer_load_dwordx4 v37, s[8:11], s29 offen offset:3072 lds
    v_mfma_f32_16x16x32_bf16 v[208:211], a[160:163], a[220:223], v[208:211]
    s_waitcnt lgkmcnt(0)
    s_waitcnt vmcnt(16)
    s_barrier
    v_mfma_f32_16x16x32_bf16 v[112:115], a[128:131], a[224:227], v[112:115]
    s_mov_b32 m0, s14
    ds_read_b128 a[232:235], v44 offset:4096
    v_mfma_f32_16x16x32_bf16 v[116:119], a[132:135], a[224:227], v[116:119]
    s_add_u32 s29, s28, s30
    ds_read_b128 a[236:239], v44 offset:6144
    v_mfma_f32_16x16x32_bf16 v[120:123], a[136:139], a[224:227], v[120:123]
    buffer_load_dwordx4 v34, s[8:11], s28 offen offset:0 lds
    v_mfma_f32_16x16x32_bf16 v[124:127], a[140:143], a[224:227], v[124:127]
    ds_read_b128 a[248:251], v45 offset:4096
    v_accvgpr_write_b32 a29, 0
    v_mfma_f32_16x16x32_bf16 v[128:131], a[144:147], a[224:227], v[128:131]
    ds_read_b128 a[252:255], v45 offset:6144
    v_accvgpr_write_b32 a30, 0
    v_mfma_f32_16x16x32_bf16 v[132:135], a[148:151], a[224:227], v[132:135]
    ds_read_b64_tr_b16 a[160:161], v38 offset:24576
    v_accvgpr_write_b32 a31, 0
    v_mfma_f32_16x16x32_bf16 v[136:139], a[152:155], a[224:227], v[136:139]
    buffer_load_dwordx4 v35, s[8:11], s28 offen offset:1024 lds
    v_mfma_f32_16x16x32_bf16 v[140:143], a[156:159], a[224:227], v[140:143]
    ds_read_b64_tr_b16 a[162:163], v38 offset:25600
    v_accvgpr_write_b32 a32, 0
    v_mfma_f32_16x16x32_bf16 v[172:175], a[156:159], a[228:231], v[172:175]
    ds_read_b64_tr_b16 a[164:165], v38 offset:24584
    v_accvgpr_write_b32 a33, 0
    v_mfma_f32_16x16x32_bf16 v[168:171], a[152:155], a[228:231], v[168:171]
    ds_read_b64_tr_b16 a[166:167], v38 offset:25608
    v_accvgpr_write_b32 a34, 0
    v_mfma_f32_16x16x32_bf16 v[164:167], a[148:151], a[228:231], v[164:167]
    buffer_load_dwordx4 v36, s[8:11], s28 offen offset:2048 lds
    v_mfma_f32_16x16x32_bf16 v[160:163], a[144:147], a[228:231], v[160:163]
    ds_read_b64_tr_b16 a[168:169], v39 offset:24576
    v_accvgpr_write_b32 a35, 0
    v_mfma_f32_16x16x32_bf16 v[156:159], a[140:143], a[228:231], v[156:159]
    ds_read_b64_tr_b16 a[170:171], v39 offset:25600
    v_accvgpr_write_b32 a36, 0
    v_mfma_f32_16x16x32_bf16 v[152:155], a[136:139], a[228:231], v[152:155]
    ds_read_b64_tr_b16 a[172:173], v39 offset:24584
    v_accvgpr_write_b32 a37, 0
    v_mfma_f32_16x16x32_bf16 v[148:151], a[132:135], a[228:231], v[148:151]
    buffer_load_dwordx4 v37, s[8:11], s28 offen offset:3072 lds
    v_mfma_f32_16x16x32_bf16 v[144:147], a[128:131], a[228:231], v[144:147]
    s_waitcnt lgkmcnt(9)
    s_add_u32 m0, s14, s34
    ds_read_b64_tr_b16 a[174:175], v39 offset:25608
    v_mfma_f32_16x16x32_bf16 v[176:179], a[128:131], a[232:235], v[176:179]
    s_add_u32 s28, s28, s31
    ds_read_b64_tr_b16 a[176:177], v40 offset:24576
    v_mfma_f32_16x16x32_bf16 v[180:183], a[132:135], a[232:235], v[180:183]
    ds_read_b64_tr_b16 a[178:179], v40 offset:25600
    v_accvgpr_write_b32 a38, 0
    v_mfma_f32_16x16x32_bf16 v[184:187], a[136:139], a[232:235], v[184:187]
    buffer_load_dwordx4 v34, s[8:11], s29 offen offset:0 lds
    v_mfma_f32_16x16x32_bf16 v[188:191], a[140:143], a[232:235], v[188:191]
    ds_read_b64_tr_b16 a[180:181], v40 offset:24584
    v_accvgpr_write_b32 a39, 0
    v_mfma_f32_16x16x32_bf16 v[192:195], a[144:147], a[232:235], v[192:195]
    ds_read_b64_tr_b16 a[182:183], v40 offset:25608
    v_accvgpr_write_b32 a40, 0
    v_mfma_f32_16x16x32_bf16 v[196:199], a[148:151], a[232:235], v[196:199]
    ds_read_b64_tr_b16 a[184:185], v41 offset:24576
    v_accvgpr_write_b32 a41, 0
    v_mfma_f32_16x16x32_bf16 v[200:203], a[152:155], a[232:235], v[200:203]
    buffer_load_dwordx4 v35, s[8:11], s29 offen offset:1024 lds
    v_mfma_f32_16x16x32_bf16 v[204:207], a[156:159], a[232:235], v[204:207]
    ds_read_b64_tr_b16 a[186:187], v41 offset:25600
    v_accvgpr_write_b32 a42, 0
    v_mfma_f32_16x16x32_bf16 v[236:239], a[156:159], a[236:239], v[236:239]
    ds_read_b64_tr_b16 a[188:189], v41 offset:24584
    v_accvgpr_write_b32 a43, 0
    v_mfma_f32_16x16x32_bf16 v[232:235], a[152:155], a[236:239], v[232:235]
    ds_read_b64_tr_b16 a[190:191], v41 offset:25608
    v_accvgpr_write_b32 a44, 0
    v_mfma_f32_16x16x32_bf16 v[228:231], a[148:151], a[236:239], v[228:231]
    buffer_load_dwordx4 v36, s[8:11], s29 offen offset:2048 lds
    v_mfma_f32_16x16x32_bf16 v[224:227], a[144:147], a[236:239], v[224:227]
    v_mfma_f32_16x16x32_bf16 v[220:223], a[140:143], a[236:239], v[220:223]
    v_mfma_f32_16x16x32_bf16 v[216:219], a[136:139], a[236:239], v[216:219]
    v_mfma_f32_16x16x32_bf16 v[212:215], a[132:135], a[236:239], v[212:215]
    buffer_load_dwordx4 v37, s[8:11], s29 offen offset:3072 lds
    v_mfma_f32_16x16x32_bf16 v[208:211], a[128:131], a[236:239], v[208:211]
    s_waitcnt lgkmcnt(0)
    s_waitcnt vmcnt(16)
    s_barrier
    v_mfma_f32_16x16x32_bf16 v[112:115], a[160:163], a[240:243], v[112:115]
    s_mov_b32 m0, s15
    ds_read_b128 a[192:195], v42 offset:0
    v_mfma_f32_16x16x32_bf16 v[116:119], a[164:167], a[240:243], v[116:119]
    s_add_u32 s29, s28, s30
    ds_read_b128 a[196:199], v42 offset:2048
    v_mfma_f32_16x16x32_bf16 v[120:123], a[168:171], a[240:243], v[120:123]
    buffer_load_dwordx4 v34, s[8:11], s28 offen offset:0 lds
    v_mfma_f32_16x16x32_bf16 v[124:127], a[172:175], a[240:243], v[124:127]
    ds_read_b128 a[208:211], v43 offset:0
    v_accvgpr_write_b32 a45, 0
    v_mfma_f32_16x16x32_bf16 v[128:131], a[176:179], a[240:243], v[128:131]
    ds_read_b128 a[212:215], v43 offset:2048
    v_accvgpr_write_b32 a46, 0
    v_mfma_f32_16x16x32_bf16 v[132:135], a[180:183], a[240:243], v[132:135]
    ds_read_b64_tr_b16 a[128:129], v38 offset:0
    v_accvgpr_write_b32 a47, 0
    v_mfma_f32_16x16x32_bf16 v[136:139], a[184:187], a[240:243], v[136:139]
    buffer_load_dwordx4 v35, s[8:11], s28 offen offset:1024 lds
    v_mfma_f32_16x16x32_bf16 v[140:143], a[188:191], a[240:243], v[140:143]
    ds_read_b64_tr_b16 a[130:131], v38 offset:1024
    v_accvgpr_write_b32 a48, 0
    v_mfma_f32_16x16x32_bf16 v[172:175], a[188:191], a[244:247], v[172:175]
    ds_read_b64_tr_b16 a[132:133], v38 offset:8
    v_accvgpr_write_b32 a49, 0
    v_mfma_f32_16x16x32_bf16 v[168:171], a[184:187], a[244:247], v[168:171]
    ds_read_b64_tr_b16 a[134:135], v38 offset:1032
    v_accvgpr_write_b32 a50, 0
    v_mfma_f32_16x16x32_bf16 v[164:167], a[180:183], a[244:247], v[164:167]
    buffer_load_dwordx4 v36, s[8:11], s28 offen offset:2048 lds
    v_mfma_f32_16x16x32_bf16 v[160:163], a[176:179], a[244:247], v[160:163]
    ds_read_b64_tr_b16 a[136:137], v39 offset:0
    v_accvgpr_write_b32 a51, 0
    v_mfma_f32_16x16x32_bf16 v[156:159], a[172:175], a[244:247], v[156:159]
    ds_read_b64_tr_b16 a[138:139], v39 offset:1024
    v_accvgpr_write_b32 a52, 0
    v_mfma_f32_16x16x32_bf16 v[152:155], a[168:171], a[244:247], v[152:155]
    ds_read_b64_tr_b16 a[140:141], v39 offset:8
    v_accvgpr_write_b32 a53, 0
    v_mfma_f32_16x16x32_bf16 v[148:151], a[164:167], a[244:247], v[148:151]
    buffer_load_dwordx4 v37, s[8:11], s28 offen offset:3072 lds
    v_mfma_f32_16x16x32_bf16 v[144:147], a[160:163], a[244:247], v[144:147]
    s_add_u32 m0, s15, s34
    ds_read_b64_tr_b16 a[142:143], v39 offset:1032
    v_mfma_f32_16x16x32_bf16 v[176:179], a[160:163], a[248:251], v[176:179]
    s_add_u32 s28, s28, s32
    ds_read_b64_tr_b16 a[144:145], v40 offset:0
    v_mfma_f32_16x16x32_bf16 v[180:183], a[164:167], a[248:251], v[180:183]
    ds_read_b64_tr_b16 a[146:147], v40 offset:1024
    v_accvgpr_write_b32 a54, 0
    v_mfma_f32_16x16x32_bf16 v[184:187], a[168:171], a[248:251], v[184:187]
    buffer_load_dwordx4 v34, s[8:11], s29 offen offset:0 lds
    v_mfma_f32_16x16x32_bf16 v[188:191], a[172:175], a[248:251], v[188:191]
    s_cmp_ge_u32 s28, s0
    ds_read_b64_tr_b16 a[148:149], v40 offset:8
    v_mfma_f32_16x16x32_bf16 v[192:195], a[176:179], a[248:251], v[192:195]
    s_cselect_b32 s52, s1, 0
    ds_read_b64_tr_b16 a[150:151], v40 offset:1032
    v_mfma_f32_16x16x32_bf16 v[196:199], a[180:183], a[248:251], v[196:199]
    s_sub_u32 s28, s28, s52
    ds_read_b64_tr_b16 a[152:153], v41 offset:0
    v_mfma_f32_16x16x32_bf16 v[200:203], a[184:187], a[248:251], v[200:203]
    buffer_load_dwordx4 v35, s[8:11], s29 offen offset:1024 lds
    v_mfma_f32_16x16x32_bf16 v[204:207], a[188:191], a[248:251], v[204:207]
    ds_read_b64_tr_b16 a[154:155], v41 offset:1024
    v_accvgpr_write_b32 a55, 0
    v_mfma_f32_16x16x32_bf16 v[236:239], a[188:191], a[252:255], v[236:239]
    ds_read_b64_tr_b16 a[156:157], v41 offset:8
    v_accvgpr_write_b32 a56, 0
    v_mfma_f32_16x16x32_bf16 v[232:235], a[184:187], a[252:255], v[232:235]
    ds_read_b64_tr_b16 a[158:159], v41 offset:1032
    v_accvgpr_write_b32 a57, 0
    v_mfma_f32_16x16x32_bf16 v[228:231], a[180:183], a[252:255], v[228:231]
    buffer_load_dwordx4 v36, s[8:11], s29 offen offset:2048 lds
    v_mfma_f32_16x16x32_bf16 v[224:227], a[176:179], a[252:255], v[224:227]
    v_mfma_f32_16x16x32_bf16 v[220:223], a[172:175], a[252:255], v[220:223]
    v_mfma_f32_16x16x32_bf16 v[216:219], a[168:171], a[252:255], v[216:219]
    v_mfma_f32_16x16x32_bf16 v[212:215], a[164:167], a[252:255], v[212:215]
    buffer_load_dwordx4 v37, s[8:11], s29 offen offset:3072 lds
    v_mfma_f32_16x16x32_bf16 v[208:211], a[160:163], a[252:255], v[208:211]
    s_waitcnt lgkmcnt(0)
    s_waitcnt vmcnt(16)
    s_barrier
    v_mfma_f32_16x16x32_bf16 v[112:115], a[128:131], a[192:195], v[112:115]
    s_mov_b32 m0, s12
    ds_read_b128 a[200:203], v42 offset:4096
    v_mfma_f32_16x16x32_bf16 v[116:119], a[132:135], a[192:195], v[116:119]
    s_add_u32 s29, s28, s30
    ds_read_b128 a[204:207], v42 offset:6144
    v_mfma_f32_16x16x32_bf16 v[120:123], a[136:139], a[192:195], v[120:123]
    buffer_load_dwordx4 v34, s[8:11], s28 offen offset:0 lds
    v_mfma_f32_16x16x32_bf16 v[124:127], a[140:143], a[192:195], v[124:127]
    ds_read_b128 a[216:219], v43 offset:4096
    v_accvgpr_write_b32 a58, 0
    v_mfma_f32_16x16x32_bf16 v[128:131], a[144:147], a[192:195], v[128:131]
    ds_read_b128 a[220:223], v43 offset:6144
    v_accvgpr_write_b32 a59, 0
    v_mfma_f32_16x16x32_bf16 v[132:135], a[148:151], a[192:195], v[132:135]
    ds_read_b64_tr_b16 a[160:161], v38 offset:8192
    v_accvgpr_write_b32 a60, 0
    v_mfma_f32_16x16x32_bf16 v[136:139], a[152:155], a[192:195], v[136:139]
    buffer_load_dwordx4 v35, s[8:11], s28 offen offset:1024 lds
    v_mfma_f32_16x16x32_bf16 v[140:143], a[156:159], a[192:195], v[140:143]
    ds_read_b64_tr_b16 a[162:163], v38 offset:9216
    v_accvgpr_write_b32 a61, 0
    v_mfma_f32_16x16x32_bf16 v[172:175], a[156:159], a[196:199], v[172:175]
    ds_read_b64_tr_b16 a[164:165], v38 offset:8200
    v_accvgpr_write_b32 a62, 0
    v_mfma_f32_16x16x32_bf16 v[168:171], a[152:155], a[196:199], v[168:171]
    ds_read_b64_tr_b16 a[166:167], v38 offset:9224
    v_accvgpr_write_b32 a63, 0
    v_mfma_f32_16x16x32_bf16 v[164:167], a[148:151], a[196:199], v[164:167]
    buffer_load_dwordx4 v36, s[8:11], s28 offen offset:2048 lds
    v_mfma_f32_16x16x32_bf16 v[160:163], a[144:147], a[196:199], v[160:163]
    ds_read_b64_tr_b16 a[168:169], v39 offset:8192
    v_accvgpr_write_b32 a64, 0
    v_mfma_f32_16x16x32_bf16 v[156:159], a[140:143], a[196:199], v[156:159]
    ds_read_b64_tr_b16 a[170:171], v39 offset:9216
    v_accvgpr_write_b32 a65, 0
    v_mfma_f32_16x16x32_bf16 v[152:155], a[136:139], a[196:199], v[152:155]
    ds_read_b64_tr_b16 a[172:173], v39 offset:8200
    v_accvgpr_write_b32 a66, 0
    v_mfma_f32_16x16x32_bf16 v[148:151], a[132:135], a[196:199], v[148:151]
    buffer_load_dwordx4 v37, s[8:11], s28 offen offset:3072 lds
    v_mfma_f32_16x16x32_bf16 v[144:147], a[128:131], a[196:199], v[144:147]
    s_waitcnt lgkmcnt(9)
    s_add_u32 m0, s12, s34
    ds_read_b64_tr_b16 a[174:175], v39 offset:9224
    v_mfma_f32_16x16x32_bf16 v[176:179], a[128:131], a[200:203], v[176:179]
    s_add_u32 s28, s28, s31
    ds_read_b64_tr_b16 a[176:177], v40 offset:8192
    v_mfma_f32_16x16x32_bf16 v[180:183], a[132:135], a[200:203], v[180:183]
    ds_read_b64_tr_b16 a[178:179], v40 offset:9216
    v_accvgpr_write_b32 a67, 0
    v_mfma_f32_16x16x32_bf16 v[184:187], a[136:139], a[200:203], v[184:187]
    buffer_load_dwordx4 v34, s[8:11], s29 offen offset:0 lds
    v_mfma_f32_16x16x32_bf16 v[188:191], a[140:143], a[200:203], v[188:191]
    ds_read_b64_tr_b16 a[180:181], v40 offset:8200
    v_accvgpr_write_b32 a68, 0
    v_mfma_f32_16x16x32_bf16 v[192:195], a[144:147], a[200:203], v[192:195]
    ds_read_b64_tr_b16 a[182:183], v40 offset:9224
    v_accvgpr_write_b32 a69, 0
    v_mfma_f32_16x16x32_bf16 v[196:199], a[148:151], a[200:203], v[196:199]
    ds_read_b64_tr_b16 a[184:185], v41 offset:8192
    v_accvgpr_write_b32 a70, 0
    v_mfma_f32_16x16x32_bf16 v[200:203], a[152:155], a[200:203], v[200:203]
    buffer_load_dwordx4 v35, s[8:11], s29 offen offset:1024 lds
    v_mfma_f32_16x16x32_bf16 v[204:207], a[156:159], a[200:203], v[204:207]
    ds_read_b64_tr_b16 a[186:187], v41 offset:9216
    v_accvgpr_write_b32 a71, 0
    v_mfma_f32_16x16x32_bf16 v[236:239], a[156:159], a[204:207], v[236:239]
    ds_read_b64_tr_b16 a[188:189], v41 offset:8200
    v_accvgpr_write_b32 a72, 0
    v_mfma_f32_16x16x32_bf16 v[232:235], a[152:155], a[204:207], v[232:235]
    ds_read_b64_tr_b16 a[190:191], v41 offset:9224
    v_accvgpr_write_b32 a73, 0
    v_mfma_f32_16x16x32_bf16 v[228:231], a[148:151], a[204:207], v[228:231]
    buffer_load_dwordx4 v36, s[8:11], s29 offen offset:2048 lds
    v_mfma_f32_16x16x32_bf16 v[224:227], a[144:147], a[204:207], v[224:227]
    v_mfma_f32_16x16x32_bf16 v[220:223], a[140:143], a[204:207], v[220:223]
    v_mfma_f32_16x16x32_bf16 v[216:219], a[136:139], a[204:207], v[216:219]
    v_mfma_f32_16x16x32_bf16 v[212:215], a[132:135], a[204:207], v[212:215]
    buffer_load_dwordx4 v37, s[8:11], s29 offen offset:3072 lds
    v_mfma_f32_16x16x32_bf16 v[208:211], a[128:131], a[204:207], v[208:211]
    s_waitcnt lgkmcnt(0)
    s_waitcnt vmcnt(16)
    s_barrier
    v_mfma_f32_16x16x32_bf16 v[112:115], a[160:163], a[208:211], v[112:115]
    s_mov_b32 m0, s13
    ds_read_b128 a[224:227], v44 offset:0
    v_mfma_f32_16x16x32_bf16 v[116:119], a[164:167], a[208:211], v[116:119]
    s_add_u32 s29, s28, s30
    ds_read_b128 a[228:231], v44 offset:2048
    v_mfma_f32_16x16x32_bf16 v[120:123], a[168:171], a[208:211], v[120:123]
    buffer_load_dwordx4 v34, s[8:11], s28 offen offset:0 lds
    v_mfma_f32_16x16x32_bf16 v[124:127], a[172:175], a[208:211], v[124:127]
    ds_read_b128 a[240:243], v45 offset:0
    v_accvgpr_write_b32 a74, 0
    v_mfma_f32_16x16x32_bf16 v[128:131], a[176:179], a[208:211], v[128:131]
    ds_read_b128 a[244:247], v45 offset:2048
    v_accvgpr_write_b32 a75, 0
    v_mfma_f32_16x16x32_bf16 v[132:135], a[180:183], a[208:211], v[132:135]
    ds_read_b64_tr_b16 a[128:129], v38 offset:16384
    v_accvgpr_write_b32 a76, 0
    v_mfma_f32_16x16x32_bf16 v[136:139], a[184:187], a[208:211], v[136:139]
    buffer_load_dwordx4 v35, s[8:11], s28 offen offset:1024 lds
    v_mfma_f32_16x16x32_bf16 v[140:143], a[188:191], a[208:211], v[140:143]
    ds_read_b64_tr_b16 a[130:131], v38 offset:17408
    v_accvgpr_write_b32 a77, 0
    v_mfma_f32_16x16x32_bf16 v[172:175], a[188:191], a[212:215], v[172:175]
    ds_read_b64_tr_b16 a[132:133], v38 offset:16392
    v_accvgpr_write_b32 a78, 0
    v_mfma_f32_16x16x32_bf16 v[168:171], a[184:187], a[212:215], v[168:171]
    ds_read_b64_tr_b16 a[134:135], v38 offset:17416
    v_accvgpr_write_b32 a79, 0
    v_mfma_f32_16x16x32_bf16 v[164:167], a[180:183], a[212:215], v[164:167]
    buffer_load_dwordx4 v36, s[8:11], s28 offen offset:2048 lds
    v_mfma_f32_16x16x32_bf16 v[160:163], a[176:179], a[212:215], v[160:163]
    ds_read_b64_tr_b16 a[136:137], v39 offset:16384
    v_accvgpr_write_b32 a80, 0
    v_mfma_f32_16x16x32_bf16 v[156:159], a[172:175], a[212:215], v[156:159]
    ds_read_b64_tr_b16 a[138:139], v39 offset:17408
    v_accvgpr_write_b32 a81, 0
    v_mfma_f32_16x16x32_bf16 v[152:155], a[168:171], a[212:215], v[152:155]
    ds_read_b64_tr_b16 a[140:141], v39 offset:16392
    v_accvgpr_write_b32 a82, 0
    v_mfma_f32_16x16x32_bf16 v[148:151], a[164:167], a[212:215], v[148:151]
    buffer_load_dwordx4 v37, s[8:11], s28 offen offset:3072 lds
    v_mfma_f32_16x16x32_bf16 v[144:147], a[160:163], a[212:215], v[144:147]
    s_add_u32 m0, s13, s34
    ds_read_b64_tr_b16 a[142:143], v39 offset:17416
    v_mfma_f32_16x16x32_bf16 v[176:179], a[160:163], a[216:219], v[176:179]
    s_add_u32 s28, s28, s32
    ds_read_b64_tr_b16 a[144:145], v40 offset:16384
    v_mfma_f32_16x16x32_bf16 v[180:183], a[164:167], a[216:219], v[180:183]
    ds_read_b64_tr_b16 a[146:147], v40 offset:17408
    v_accvgpr_write_b32 a83, 0
    v_mfma_f32_16x16x32_bf16 v[184:187], a[168:171], a[216:219], v[184:187]
    buffer_load_dwordx4 v34, s[8:11], s29 offen offset:0 lds
    v_mfma_f32_16x16x32_bf16 v[188:191], a[172:175], a[216:219], v[188:191]
    s_cmp_ge_u32 s28, s0
    ds_read_b64_tr_b16 a[148:149], v40 offset:16392
    v_mfma_f32_16x16x32_bf16 v[192:195], a[176:179], a[216:219], v[192:195]
    s_cselect_b32 s52, s1, 0
    ds_read_b64_tr_b16 a[150:151], v40 offset:17416
    v_mfma_f32_16x16x32_bf16 v[196:199], a[180:183], a[216:219], v[196:199]
    s_sub_u32 s28, s28, s52
    ds_read_b64_tr_b16 a[152:153], v41 offset:16384
    v_mfma_f32_16x16x32_bf16 v[200:203], a[184:187], a[216:219], v[200:203]
    buffer_load_dwordx4 v35, s[8:11], s29 offen offset:1024 lds
    v_mfma_f32_16x16x32_bf16 v[204:207], a[188:191], a[216:219], v[204:207]
    ds_read_b64_tr_b16 a[154:155], v41 offset:17408
    v_accvgpr_write_b32 a84, 0
    v_mfma_f32_16x16x32_bf16 v[236:239], a[188:191], a[220:223], v[236:239]
    ds_read_b64_tr_b16 a[156:157], v41 offset:16392
    v_accvgpr_write_b32 a85, 0
    v_mfma_f32_16x16x32_bf16 v[232:235], a[184:187], a[220:223], v[232:235]
    ds_read_b64_tr_b16 a[158:159], v41 offset:17416
    v_accvgpr_write_b32 a86, 0
    v_mfma_f32_16x16x32_bf16 v[228:231], a[180:183], a[220:223], v[228:231]
    buffer_load_dwordx4 v36, s[8:11], s29 offen offset:2048 lds
    v_mfma_f32_16x16x32_bf16 v[224:227], a[176:179], a[220:223], v[224:227]
    v_mfma_f32_16x16x32_bf16 v[220:223], a[172:175], a[220:223], v[220:223]
    v_mfma_f32_16x16x32_bf16 v[216:219], a[168:171], a[220:223], v[216:219]
    v_mfma_f32_16x16x32_bf16 v[212:215], a[164:167], a[220:223], v[212:215]
    buffer_load_dwordx4 v37, s[8:11], s29 offen offset:3072 lds
    v_mfma_f32_16x16x32_bf16 v[208:211], a[160:163], a[220:223], v[208:211]
    s_waitcnt lgkmcnt(0)
    s_waitcnt vmcnt(16)
    s_barrier
    v_mfma_f32_16x16x32_bf16 v[112:115], a[128:131], a[224:227], v[112:115]
    s_mov_b32 m0, s14
    ds_read_b128 a[232:235], v44 offset:4096
    v_mfma_f32_16x16x32_bf16 v[116:119], a[132:135], a[224:227], v[116:119]
    s_add_u32 s29, s28, s30
    ds_read_b128 a[236:239], v44 offset:6144
    v_mfma_f32_16x16x32_bf16 v[120:123], a[136:139], a[224:227], v[120:123]
    buffer_load_dwordx4 v34, s[8:11], s28 offen offset:0 lds
    v_mfma_f32_16x16x32_bf16 v[124:127], a[140:143], a[224:227], v[124:127]
    ds_read_b128 a[248:251], v45 offset:4096
    v_accvgpr_write_b32 a87, 0
    v_mfma_f32_16x16x32_bf16 v[128:131], a[144:147], a[224:227], v[128:131]
    ds_read_b128 a[252:255], v45 offset:6144
    v_accvgpr_write_b32 a88, 0
    v_mfma_f32_16x16x32_bf16 v[132:135], a[148:151], a[224:227], v[132:135]
    ds_read_b64_tr_b16 a[160:161], v38 offset:24576
    v_accvgpr_write_b32 a89, 0
    v_mfma_f32_16x16x32_bf16 v[136:139], a[152:155], a[224:227], v[136:139]
    buffer_load_dwordx4 v35, s[8:11], s28 offen offset:1024 lds
    v_mfma_f32_16x16x32_bf16 v[140:143], a[156:159], a[224:227], v[140:143]
    ds_read_b64_tr_b16 a[162:163], v38 offset:25600
    v_accvgpr_write_b32 a90, 0
    v_mfma_f32_16x16x32_bf16 v[172:175], a[156:159], a[228:231], v[172:175]
    ds_read_b64_tr_b16 a[164:165], v38 offset:24584
    v_accvgpr_write_b32 a91, 0
    v_mfma_f32_16x16x32_bf16 v[168:171], a[152:155], a[228:231], v[168:171]
    ds_read_b64_tr_b16 a[166:167], v38 offset:25608
    v_accvgpr_write_b32 a92, 0
    v_mfma_f32_16x16x32_bf16 v[164:167], a[148:151], a[228:231], v[164:167]
    buffer_load_dwordx4 v36, s[8:11], s28 offen offset:2048 lds
    v_mfma_f32_16x16x32_bf16 v[160:163], a[144:147], a[228:231], v[160:163]
    ds_read_b64_tr_b16 a[168:169], v39 offset:24576
    v_accvgpr_write_b32 a93, 0
    v_mfma_f32_16x16x32_bf16 v[156:159], a[140:143], a[228:231], v[156:159]
    ds_read_b64_tr_b16 a[170:171], v39 offset:25600
    v_accvgpr_write_b32 a94, 0
    v_mfma_f32_16x16x32_bf16 v[152:155], a[136:139], a[228:231], v[152:155]
    ds_read_b64_tr_b16 a[172:173], v39 offset:24584
    v_accvgpr_write_b32 a95, 0
    v_mfma_f32_16x16x32_bf16 v[148:151], a[132:135], a[228:231], v[148:151]
    buffer_load_dwordx4 v37, s[8:11], s28 offen offset:3072 lds
    v_mfma_f32_16x16x32_bf16 v[144:147], a[128:131], a[228:231], v[144:147]
    s_waitcnt lgkmcnt(9)
    s_add_u32 m0, s14, s34
    ds_read_b64_tr_b16 a[174:175], v39 offset:25608
    v_mfma_f32_16x16x32_bf16 v[176:179], a[128:131], a[232:235], v[176:179]
    s_add_u32 s28, s28, s31
    ds_read_b64_tr_b16 a[176:177], v40 offset:24576
    v_mfma_f32_16x16x32_bf16 v[180:183], a[132:135], a[232:235], v[180:183]
    ds_read_b64_tr_b16 a[178:179], v40 offset:25600
    v_accvgpr_write_b32 a96, 0
    v_mfma_f32_16x16x32_bf16 v[184:187], a[136:139], a[232:235], v[184:187]
    buffer_load_dwordx4 v34, s[8:11], s29 offen offset:0 lds
    v_mfma_f32_16x16x32_bf16 v[188:191], a[140:143], a[232:235], v[188:191]
    ds_read_b64_tr_b16 a[180:181], v40 offset:24584
    v_accvgpr_write_b32 a97, 0
    v_mfma_f32_16x16x32_bf16 v[192:195], a[144:147], a[232:235], v[192:195]
    ds_read_b64_tr_b16 a[182:183], v40 offset:25608
    v_accvgpr_write_b32 a98, 0
    v_mfma_f32_16x16x32_bf16 v[196:199], a[148:151], a[232:235], v[196:199]
    ds_read_b64_tr_b16 a[184:185], v41 offset:24576
    v_accvgpr_write_b32 a99, 0
    v_mfma_f32_16x16x32_bf16 v[200:203], a[152:155], a[232:235], v[200:203]
    buffer_load_dwordx4 v35, s[8:11], s29 offen offset:1024 lds
    v_mfma_f32_16x16x32_bf16 v[204:207], a[156:159], a[232:235], v[204:207]
    ds_read_b64_tr_b16 a[186:187], v41 offset:25600
    v_accvgpr_write_b32 a100, 0
    v_mfma_f32_16x16x32_bf16 v[236:239], a[156:159], a[236:239], v[236:239]
    ds_read_b64_tr_b16 a[188:189], v41 offset:24584
    v_accvgpr_write_b32 a101, 0
    v_mfma_f32_16x16x32_bf16 v[232:235], a[152:155], a[236:239], v[232:235]
    ds_read_b64_tr_b16 a[190:191], v41 offset:25608
    v_accvgpr_write_b32 a102, 0
    v_mfma_f32_16x16x32_bf16 v[228:231], a[148:151], a[236:239], v[228:231]
    buffer_load_dwordx4 v36, s[8:11], s29 offen offset:2048 lds
    v_mfma_f32_16x16x32_bf16 v[224:227], a[144:147], a[236:239], v[224:227]
    v_mfma_f32_16x16x32_bf16 v[220:223], a[140:143], a[236:239], v[220:223]
    v_mfma_f32_16x16x32_bf16 v[216:219], a[136:139], a[236:239], v[216:219]
    v_mfma_f32_16x16x32_bf16 v[212:215], a[132:135], a[236:239], v[212:215]
    buffer_load_dwordx4 v37, s[8:11], s29 offen offset:3072 lds
    v_mfma_f32_16x16x32_bf16 v[208:211], a[128:131], a[236:239], v[208:211]
    s_waitcnt lgkmcnt(0)
    s_waitcnt vmcnt(16)
    s_barrier
    v_mfma_f32_16x16x32_bf16 v[112:115], a[160:163], a[240:243], v[112:115]
    s_mov_b32 m0, s15
    ds_read_b128 a[192:195], v42 offset:0
    v_mfma_f32_16x16x32_bf16 v[116:119], a[164:167], a[240:243], v[116:119]
    s_add_u32 s29, s28, s30
    ds_read_b128 a[196:199], v42 offset:2048
    v_mfma_f32_16x16x32_bf16 v[120:123], a[168:171], a[240:243], v[120:123]
    buffer_load_dwordx4 v34, s[8:11], s28 offen offset:0 lds
    v_mfma_f32_16x16x32_bf16 v[124:127], a[172:175], a[240:243], v[124:127]
    ds_read_b128 a[208:211], v43 offset:0
    v_accvgpr_write_b32 a103, 0
    v_mfma_f32_16x16x32_bf16 v[128:131], a[176:179], a[240:243], v[128:131]
    ds_read_b128 a[212:215], v43 offset:2048
    v_accvgpr_write_b32 a104, 0
    v_mfma_f32_16x16x32_bf16 v[132:135], a[180:183], a[240:243], v[132:135]
    ds_read_b64_tr_b16 a[128:129], v38 offset:0
    v_accvgpr_write_b32 a105, 0
    v_mfma_f32_16x16x32_bf16 v[136:139], a[184:187], a[240:243], v[136:139]
    buffer_load_dwordx4 v35, s[8:11], s28 offen offset:1024 lds
    v_mfma_f32_16x16x32_bf16 v[140:143], a[188:191], a[240:243], v[140:143]
    ds_read_b64_tr_b16 a[130:131], v38 offset:1024
    v_accvgpr_write_b32 a106, 0
    v_mfma_f32_16x16x32_bf16 v[172:175], a[188:191], a[244:247], v[172:175]
    ds_read_b64_tr_b16 a[132:133], v38 offset:8
    v_accvgpr_write_b32 a107, 0
    v_mfma_f32_16x16x32_bf16 v[168:171], a[184:187], a[244:247], v[168:171]
    ds_read_b64_tr_b16 a[134:135], v38 offset:1032
    v_accvgpr_write_b32 a108, 0
    v_mfma_f32_16x16x32_bf16 v[164:167], a[180:183], a[244:247], v[164:167]
    buffer_load_dwordx4 v36, s[8:11], s28 offen offset:2048 lds
    v_mfma_f32_16x16x32_bf16 v[160:163], a[176:179], a[244:247], v[160:163]
    ds_read_b64_tr_b16 a[136:137], v39 offset:0
    v_accvgpr_write_b32 a109, 0
    v_mfma_f32_16x16x32_bf16 v[156:159], a[172:175], a[244:247], v[156:159]
    ds_read_b64_tr_b16 a[138:139], v39 offset:1024
    v_accvgpr_write_b32 a110, 0
    v_mfma_f32_16x16x32_bf16 v[152:155], a[168:171], a[244:247], v[152:155]
    ds_read_b64_tr_b16 a[140:141], v39 offset:8
    v_accvgpr_write_b32 a111, 0
    v_mfma_f32_16x16x32_bf16 v[148:151], a[164:167], a[244:247], v[148:151]
    buffer_load_dwordx4 v37, s[8:11], s28 offen offset:3072 lds
    v_mfma_f32_16x16x32_bf16 v[144:147], a[160:163], a[244:247], v[144:147]
    s_add_u32 m0, s15, s34
    ds_read_b64_tr_b16 a[142:143], v39 offset:1032
    v_mfma_f32_16x16x32_bf16 v[176:179], a[160:163], a[248:251], v[176:179]
    s_add_u32 s28, s28, s32
    ds_read_b64_tr_b16 a[144:145], v40 offset:0
    v_mfma_f32_16x16x32_bf16 v[180:183], a[164:167], a[248:251], v[180:183]
    ds_read_b64_tr_b16 a[146:147], v40 offset:1024
    v_accvgpr_write_b32 a112, 0
    v_mfma_f32_16x16x32_bf16 v[184:187], a[168:171], a[248:251], v[184:187]
    buffer_load_dwordx4 v34, s[8:11], s29 offen offset:0 lds
    v_mfma_f32_16x16x32_bf16 v[188:191], a[172:175], a[248:251], v[188:191]
    s_cmp_ge_u32 s28, s0
    ds_read_b64_tr_b16 a[148:149], v40 offset:8
    v_mfma_f32_16x16x32_bf16 v[192:195], a[176:179], a[248:251], v[192:195]
    s_cselect_b32 s52, s1, 0
    ds_read_b64_tr_b16 a[150:151], v40 offset:1032
    v_mfma_f32_16x16x32_bf16 v[196:199], a[180:183], a[248:251], v[196:199]
    s_sub_u32 s28, s28, s52
    ds_read_b64_tr_b16 a[152:153], v41 offset:0
    v_mfma_f32_16x16x32_bf16 v[200:203], a[184:187], a[248:251], v[200:203]
    buffer_load_dwordx4 v35, s[8:11], s29 offen offset:1024 lds
    v_mfma_f32_16x16x32_bf16 v[204:207], a[188:191], a[248:251], v[204:207]
    ds_read_b64_tr_b16 a[154:155], v41 offset:1024
    v_accvgpr_write_b32 a113, 0
    v_mfma_f32_16x16x32_bf16 v[236:239], a[188:191], a[252:255], v[236:239]
    ds_read_b64_tr_b16 a[156:157], v41 offset:8
    v_accvgpr_write_b32 a114, 0
    v_mfma_f32_16x16x32_bf16 v[232:235], a[184:187], a[252:255], v[232:235]
    ds_read_b64_tr_b16 a[158:159], v41 offset:1032
    v_accvgpr_write_b32 a115, 0
    v_mfma_f32_16x16x32_bf16 v[228:231], a[180:183], a[252:255], v[228:231]
    buffer_load_dwordx4 v36, s[8:11], s29 offen offset:2048 lds
    v_mfma_f32_16x16x32_bf16 v[224:227], a[176:179], a[252:255], v[224:227]
    v_mfma_f32_16x16x32_bf16 v[220:223], a[172:175], a[252:255], v[220:223]
    v_mfma_f32_16x16x32_bf16 v[216:219], a[168:171], a[252:255], v[216:219]
    v_mfma_f32_16x16x32_bf16 v[212:215], a[164:167], a[252:255], v[212:215]
    buffer_load_dwordx4 v37, s[8:11], s29 offen offset:3072 lds
    v_mfma_f32_16x16x32_bf16 v[208:211], a[160:163], a[252:255], v[208:211]
    s_waitcnt lgkmcnt(0)
    s_waitcnt vmcnt(16)
    s_barrier
    v_mfma_f32_16x16x32_bf16 v[112:115], a[128:131], a[192:195], v[112:115]
    s_mov_b32 m0, s12
    ds_read_b128 a[200:203], v42 offset:4096
    v_mfma_f32_16x16x32_bf16 v[116:119], a[132:135], a[192:195], v[116:119]
    s_add_u32 s29, s28, s30
    ds_read_b128 a[204:207], v42 offset:6144
    v_mfma_f32_16x16x32_bf16 v[120:123], a[136:139], a[192:195], v[120:123]
    buffer_load_dwordx4 v34, s[8:11], s28 offen offset:0 lds
    v_mfma_f32_16x16x32_bf16 v[124:127], a[140:143], a[192:195], v[124:127]
    ds_read_b128 a[216:219], v43 offset:4096
    v_accvgpr_write_b32 a116, 0
    v_mfma_f32_16x16x32_bf16 v[128:131], a[144:147], a[192:195], v[128:131]
    ds_read_b128 a[220:223], v43 offset:6144
    v_accvgpr_write_b32 a117, 0
    v_mfma_f32_16x16x32_bf16 v[132:135], a[148:151], a[192:195], v[132:135]
    ds_read_b64_tr_b16 a[160:161], v38 offset:8192
    v_accvgpr_write_b32 a118, 0
    v_mfma_f32_16x16x32_bf16 v[136:139], a[152:155], a[192:195], v[136:139]
    buffer_load_dwordx4 v35, s[8:11], s28 offen offset:1024 lds
    v_mfma_f32_16x16x32_bf16 v[140:143], a[156:159], a[192:195], v[140:143]
    ds_read_b64_tr_b16 a[162:163], v38 offset:9216
    v_accvgpr_write_b32 a119, 0
    v_mfma_f32_16x16x32_bf16 v[172:175], a[156:159], a[196:199], v[172:175]
    ds_read_b64_tr_b16 a[164:165], v38 offset:8200
    v_accvgpr_write_b32 a120, 0
    v_mfma_f32_16x16x32_bf16 v[168:171], a[152:155], a[196:199], v[168:171]
    ds_read_b64_tr_b16 a[166:167], v38 offset:9224
    v_accvgpr_write_b32 a121, 0
    v_mfma_f32_16x16x32_bf16 v[164:167], a[148:151], a[196:199], v[164:167]
    buffer_load_dwordx4 v36, s[8:11], s28 offen offset:2048 lds
    v_mfma_f32_16x16x32_bf16 v[160:163], a[144:147], a[196:199], v[160:163]
    ds_read_b64_tr_b16 a[168:169], v39 offset:8192
    v_accvgpr_write_b32 a122, 0
    v_mfma_f32_16x16x32_bf16 v[156:159], a[140:143], a[196:199], v[156:159]
    ds_read_b64_tr_b16 a[170:171], v39 offset:9216
    v_accvgpr_write_b32 a123, 0
    v_mfma_f32_16x16x32_bf16 v[152:155], a[136:139], a[196:199], v[152:155]
    ds_read_b64_tr_b16 a[172:173], v39 offset:8200
    v_accvgpr_write_b32 a124, 0
    v_mfma_f32_16x16x32_bf16 v[148:151], a[132:135], a[196:199], v[148:151]
    buffer_load_dwordx4 v37, s[8:11], s28 offen offset:3072 lds
    v_mfma_f32_16x16x32_bf16 v[144:147], a[128:131], a[196:199], v[144:147]
    s_waitcnt lgkmcnt(9)
    s_add_u32 m0, s12, s34
    ds_read_b64_tr_b16 a[174:175], v39 offset:9224
    v_mfma_f32_16x16x32_bf16 v[176:179], a[128:131], a[200:203], v[176:179]
    s_add_u32 s28, s28, s31
    ds_read_b64_tr_b16 a[176:177], v40 offset:8192
    v_mfma_f32_16x16x32_bf16 v[180:183], a[132:135], a[200:203], v[180:183]
    ds_read_b64_tr_b16 a[178:179], v40 offset:9216
    v_accvgpr_write_b32 a125, 0
    v_mfma_f32_16x16x32_bf16 v[184:187], a[136:139], a[200:203], v[184:187]
    buffer_load_dwordx4 v34, s[8:11], s29 offen offset:0 lds
    v_mfma_f32_16x16x32_bf16 v[188:191], a[140:143], a[200:203], v[188:191]
    ds_read_b64_tr_b16 a[180:181], v40 offset:8200
    v_accvgpr_write_b32 a126, 0
    v_mfma_f32_16x16x32_bf16 v[192:195], a[144:147], a[200:203], v[192:195]
    ds_read_b64_tr_b16 a[182:183], v40 offset:9224
    v_accvgpr_write_b32 a127, 0
    v_mfma_f32_16x16x32_bf16 v[196:199], a[148:151], a[200:203], v[196:199]
    ds_read_b64_tr_b16 a[184:185], v41 offset:8192
    v_mfma_f32_16x16x32_bf16 v[200:203], a[152:155], a[200:203], v[200:203]
    buffer_load_dwordx4 v35, s[8:11], s29 offen offset:1024 lds
    v_mfma_f32_16x16x32_bf16 v[204:207], a[156:159], a[200:203], v[204:207]
    ds_read_b64_tr_b16 a[186:187], v41 offset:9216
    v_mfma_f32_16x16x32_bf16 v[236:239], a[156:159], a[204:207], v[236:239]
    ds_read_b64_tr_b16 a[188:189], v41 offset:8200
    v_mfma_f32_16x16x32_bf16 v[232:235], a[152:155], a[204:207], v[232:235]
    ds_read_b64_tr_b16 a[190:191], v41 offset:9224
    v_mfma_f32_16x16x32_bf16 v[228:231], a[148:151], a[204:207], v[228:231]
    buffer_load_dwordx4 v36, s[8:11], s29 offen offset:2048 lds
    v_mfma_f32_16x16x32_bf16 v[224:227], a[144:147], a[204:207], v[224:227]
    v_mfma_f32_16x16x32_bf16 v[220:223], a[140:143], a[204:207], v[220:223]
    v_mfma_f32_16x16x32_bf16 v[216:219], a[136:139], a[204:207], v[216:219]
    v_mfma_f32_16x16x32_bf16 v[212:215], a[132:135], a[204:207], v[212:215]
    buffer_load_dwordx4 v37, s[8:11], s29 offen offset:3072 lds
    v_mfma_f32_16x16x32_bf16 v[208:211], a[128:131], a[204:207], v[208:211]
    s_waitcnt lgkmcnt(0)
    s_waitcnt vmcnt(16)
    s_barrier
    v_mfma_f32_16x16x32_bf16 v[112:115], a[160:163], a[208:211], v[112:115]
    s_mov_b32 m0, s13
    ds_read_b128 a[224:227], v44 offset:0
    v_mfma_f32_16x16x32_bf16 v[116:119], a[164:167], a[208:211], v[116:119]
    s_add_u32 s29, s28, s30
    ds_read_b128 a[228:231], v44 offset:2048
    v_mfma_f32_16x16x32_bf16 v[120:123], a[168:171], a[208:211], v[120:123]
    buffer_load_dwordx4 v34, s[8:11], s28 offen offset:0 lds
    v_mfma_f32_16x16x32_bf16 v[124:127], a[172:175], a[208:211], v[124:127]
    ds_read_b128 a[240:243], v45 offset:0
    v_mfma_f32_16x16x32_bf16 v[128:131], a[176:179], a[208:211], v[128:131]
    ds_read_b128 a[244:247], v45 offset:2048
    v_mfma_f32_16x16x32_bf16 v[132:135], a[180:183], a[208:211], v[132:135]
    ds_read_b64_tr_b16 a[128:129], v38 offset:16384
    v_mfma_f32_16x16x32_bf16 v[136:139], a[184:187], a[208:211], v[136:139]
    buffer_load_dwordx4 v35, s[8:11], s28 offen offset:1024 lds
    v_mfma_f32_16x16x32_bf16 v[140:143], a[188:191], a[208:211], v[140:143]
    ds_read_b64_tr_b16 a[130:131], v38 offset:17408
    v_mfma_f32_16x16x32_bf16 v[172:175], a[188:191], a[212:215], v[172:175]
    ds_read_b64_tr_b16 a[132:133], v38 offset:16392
    v_mfma_f32_16x16x32_bf16 v[168:171], a[184:187], a[212:215], v[168:171]
    ds_read_b64_tr_b16 a[134:135], v38 offset:17416
    v_mfma_f32_16x16x32_bf16 v[164:167], a[180:183], a[212:215], v[164:167]
    buffer_load_dwordx4 v36, s[8:11], s28 offen offset:2048 lds
    v_mfma_f32_16x16x32_bf16 v[160:163], a[176:179], a[212:215], v[160:163]
    ds_read_b64_tr_b16 a[136:137], v39 offset:16384
    v_mfma_f32_16x16x32_bf16 v[156:159], a[172:175], a[212:215], v[156:159]
    ds_read_b64_tr_b16 a[138:139], v39 offset:17408
    v_mfma_f32_16x16x32_bf16 v[152:155], a[168:171], a[212:215], v[152:155]
    ds_read_b64_tr_b16 a[140:141], v39 offset:16392
    v_mfma_f32_16x16x32_bf16 v[148:151], a[164:167], a[212:215], v[148:151]
    buffer_load_dwordx4 v37, s[8:11], s28 offen offset:3072 lds
    v_mfma_f32_16x16x32_bf16 v[144:147], a[160:163], a[212:215], v[144:147]
    s_add_u32 m0, s13, s34
    ds_read_b64_tr_b16 a[142:143], v39 offset:17416
    v_mfma_f32_16x16x32_bf16 v[176:179], a[160:163], a[216:219], v[176:179]
    s_add_u32 s28, s28, s32
    ds_read_b64_tr_b16 a[144:145], v40 offset:16384
    v_mfma_f32_16x16x32_bf16 v[180:183], a[164:167], a[216:219], v[180:183]
    ds_read_b64_tr_b16 a[146:147], v40 offset:17408
    v_mfma_f32_16x16x32_bf16 v[184:187], a[168:171], a[216:219], v[184:187]
    buffer_load_dwordx4 v34, s[8:11], s29 offen offset:0 lds
    v_mfma_f32_16x16x32_bf16 v[188:191], a[172:175], a[216:219], v[188:191]
    s_cmp_ge_u32 s28, s0
    ds_read_b64_tr_b16 a[148:149], v40 offset:16392
    v_mfma_f32_16x16x32_bf16 v[192:195], a[176:179], a[216:219], v[192:195]
    s_cselect_b32 s52, s1, 0
    ds_read_b64_tr_b16 a[150:151], v40 offset:17416
    v_mfma_f32_16x16x32_bf16 v[196:199], a[180:183], a[216:219], v[196:199]
    s_sub_u32 s28, s28, s52
    ds_read_b64_tr_b16 a[152:153], v41 offset:16384
    v_mfma_f32_16x16x32_bf16 v[200:203], a[184:187], a[216:219], v[200:203]
    buffer_load_dwordx4 v35, s[8:11], s29 offen offset:1024 lds
    v_mfma_f32_16x16x32_bf16 v[204:207], a[188:191], a[216:219], v[204:207]
    ds_read_b64_tr_b16 a[154:155], v41 offset:17408
    v_mfma_f32_16x16x32_bf16 v[236:239], a[188:191], a[220:223], v[236:239]
    ds_read_b64_tr_b16 a[156:157], v41 offset:16392
    v_mfma_f32_16x16x32_bf16 v[232:235], a[184:187], a[220:223], v[232:235]
    ds_read_b64_tr_b16 a[158:159], v41 offset:17416
    v_mfma_f32_16x16x32_bf16 v[228:231], a[180:183], a[220:223], v[228:231]
    buffer_load_dwordx4 v36, s[8:11], s29 offen offset:2048 lds
    v_mfma_f32_16x16x32_bf16 v[224:227], a[176:179], a[220:223], v[224:227]
    v_mfma_f32_16x16x32_bf16 v[220:223], a[172:175], a[220:223], v[220:223]
    v_mfma_f32_16x16x32_bf16 v[216:219], a[168:171], a[220:223], v[216:219]
    v_mfma_f32_16x16x32_bf16 v[212:215], a[164:167], a[220:223], v[212:215]
    buffer_load_dwordx4 v37, s[8:11], s29 offen offset:3072 lds
    v_mfma_f32_16x16x32_bf16 v[208:211], a[160:163], a[220:223], v[208:211]
    s_waitcnt lgkmcnt(0)
    s_waitcnt vmcnt(16)
    s_barrier
    v_mfma_f32_16x16x32_bf16 v[112:115], a[128:131], a[224:227], v[112:115]
    s_mov_b32 m0, s14
    ds_read_b128 a[232:235], v44 offset:4096
    v_mfma_f32_16x16x32_bf16 v[116:119], a[132:135], a[224:227], v[116:119]
    s_add_u32 s29, s28, s30
    ds_read_b128 a[236:239], v44 offset:6144
    v_mfma_f32_16x16x32_bf16 v[120:123], a[136:139], a[224:227], v[120:123]
    buffer_load_dwordx4 v34, s[8:11], s28 offen offset:0 lds
    v_mfma_f32_16x16x32_bf16 v[124:127], a[140:143], a[224:227], v[124:127]
    ds_read_b128 a[248:251], v45 offset:4096
    v_mfma_f32_16x16x32_bf16 v[128:131], a[144:147], a[224:227], v[128:131]
    ds_read_b128 a[252:255], v45 offset:6144
    v_mfma_f32_16x16x32_bf16 v[132:135], a[148:151], a[224:227], v[132:135]
    ds_read_b64_tr_b16 a[160:161], v38 offset:24576
    v_mfma_f32_16x16x32_bf16 v[136:139], a[152:155], a[224:227], v[136:139]
    buffer_load_dwordx4 v35, s[8:11], s28 offen offset:1024 lds
    v_mfma_f32_16x16x32_bf16 v[140:143], a[156:159], a[224:227], v[140:143]
    ds_read_b64_tr_b16 a[162:163], v38 offset:25600
    v_mfma_f32_16x16x32_bf16 v[172:175], a[156:159], a[228:231], v[172:175]
    ds_read_b64_tr_b16 a[164:165], v38 offset:24584
    v_mfma_f32_16x16x32_bf16 v[168:171], a[152:155], a[228:231], v[168:171]
    ds_read_b64_tr_b16 a[166:167], v38 offset:25608
    v_mfma_f32_16x16x32_bf16 v[164:167], a[148:151], a[228:231], v[164:167]
    buffer_load_dwordx4 v36, s[8:11], s28 offen offset:2048 lds
    v_mfma_f32_16x16x32_bf16 v[160:163], a[144:147], a[228:231], v[160:163]
    ds_read_b64_tr_b16 a[168:169], v39 offset:24576
    v_mfma_f32_16x16x32_bf16 v[156:159], a[140:143], a[228:231], v[156:159]
    ds_read_b64_tr_b16 a[170:171], v39 offset:25600
    v_mfma_f32_16x16x32_bf16 v[152:155], a[136:139], a[228:231], v[152:155]
    ds_read_b64_tr_b16 a[172:173], v39 offset:24584
    v_mfma_f32_16x16x32_bf16 v[148:151], a[132:135], a[228:231], v[148:151]
    buffer_load_dwordx4 v37, s[8:11], s28 offen offset:3072 lds
    v_mfma_f32_16x16x32_bf16 v[144:147], a[128:131], a[228:231], v[144:147]
    s_waitcnt lgkmcnt(9)
    s_add_u32 m0, s14, s34
    ds_read_b64_tr_b16 a[174:175], v39 offset:25608
    v_mfma_f32_16x16x32_bf16 v[176:179], a[128:131], a[232:235], v[176:179]
    s_add_u32 s28, s28, s31
    ds_read_b64_tr_b16 a[176:177], v40 offset:24576
    v_mfma_f32_16x16x32_bf16 v[180:183], a[132:135], a[232:235], v[180:183]
    ds_read_b64_tr_b16 a[178:179], v40 offset:25600
    v_mfma_f32_16x16x32_bf16 v[184:187], a[136:139], a[232:235], v[184:187]
    buffer_load_dwordx4 v34, s[8:11], s29 offen offset:0 lds
    v_mfma_f32_16x16x32_bf16 v[188:191], a[140:143], a[232:235], v[188:191]
    ds_read_b64_tr_b16 a[180:181], v40 offset:24584
    v_mfma_f32_16x16x32_bf16 v[192:195], a[144:147], a[232:235], v[192:195]
    ds_read_b64_tr_b16 a[182:183], v40 offset:25608
    v_mfma_f32_16x16x32_bf16 v[196:199], a[148:151], a[232:235], v[196:199]
    ds_read_b64_tr_b16 a[184:185], v41 offset:24576
    v_mfma_f32_16x16x32_bf16 v[200:203], a[152:155], a[232:235], v[200:203]
    buffer_load_dwordx4 v35, s[8:11], s29 offen offset:1024 lds
    v_mfma_f32_16x16x32_bf16 v[204:207], a[156:159], a[232:235], v[204:207]
    ds_read_b64_tr_b16 a[186:187], v41 offset:25600
    v_mfma_f32_16x16x32_bf16 v[236:239], a[156:159], a[236:239], v[236:239]
    ds_read_b64_tr_b16 a[188:189], v41 offset:24584
    v_mfma_f32_16x16x32_bf16 v[232:235], a[152:155], a[236:239], v[232:235]
    ds_read_b64_tr_b16 a[190:191], v41 offset:25608
    v_mfma_f32_16x16x32_bf16 v[228:231], a[148:151], a[236:239], v[228:231]
    buffer_load_dwordx4 v36, s[8:11], s29 offen offset:2048 lds
    v_mfma_f32_16x16x32_bf16 v[224:227], a[144:147], a[236:239], v[224:227]
    v_mfma_f32_16x16x32_bf16 v[220:223], a[140:143], a[236:239], v[220:223]
    v_mfma_f32_16x16x32_bf16 v[216:219], a[136:139], a[236:239], v[216:219]
    v_mfma_f32_16x16x32_bf16 v[212:215], a[132:135], a[236:239], v[212:215]
    buffer_load_dwordx4 v37, s[8:11], s29 offen offset:3072 lds
    v_mfma_f32_16x16x32_bf16 v[208:211], a[128:131], a[236:239], v[208:211]
    s_waitcnt lgkmcnt(0)
    s_waitcnt vmcnt(16)
    s_barrier
    v_mfma_f32_16x16x32_bf16 v[112:115], a[160:163], a[240:243], v[112:115]
    s_mov_b32 m0, s15
    ds_read_b128 a[192:195], v42 offset:0
    v_mfma_f32_16x16x32_bf16 v[116:119], a[164:167], a[240:243], v[116:119]
    s_add_u32 s29, s28, s30
    ds_read_b128 a[196:199], v42 offset:2048
    v_mfma_f32_16x16x32_bf16 v[120:123], a[168:171], a[240:243], v[120:123]
    buffer_load_dwordx4 v34, s[8:11], s28 offen offset:0 lds
    v_mfma_f32_16x16x32_bf16 v[124:127], a[172:175], a[240:243], v[124:127]
    ds_read_b128 a[208:211], v43 offset:0
    v_mfma_f32_16x16x32_bf16 v[128:131], a[176:179], a[240:243], v[128:131]
    ds_read_b128 a[212:215], v43 offset:2048
    v_mfma_f32_16x16x32_bf16 v[132:135], a[180:183], a[240:243], v[132:135]
    ds_read_b64_tr_b16 a[128:129], v38 offset:0
    v_mfma_f32_16x16x32_bf16 v[136:139], a[184:187], a[240:243], v[136:139]
    buffer_load_dwordx4 v35, s[8:11], s28 offen offset:1024 lds
    v_mfma_f32_16x16x32_bf16 v[140:143], a[188:191], a[240:243], v[140:143]
    ds_read_b64_tr_b16 a[130:131], v38 offset:1024
    v_mfma_f32_16x16x32_bf16 v[172:175], a[188:191], a[244:247], v[172:175]
    ds_read_b64_tr_b16 a[132:133], v38 offset:8
    v_mfma_f32_16x16x32_bf16 v[168:171], a[184:187], a[244:247], v[168:171]
    ds_read_b64_tr_b16 a[134:135], v38 offset:1032
    v_mfma_f32_16x16x32_bf16 v[164:167], a[180:183], a[244:247], v[164:167]
    buffer_load_dwordx4 v36, s[8:11], s28 offen offset:2048 lds
    v_mfma_f32_16x16x32_bf16 v[160:163], a[176:179], a[244:247], v[160:163]
    ds_read_b64_tr_b16 a[136:137], v39 offset:0
    v_mfma_f32_16x16x32_bf16 v[156:159], a[172:175], a[244:247], v[156:159]
    ds_read_b64_tr_b16 a[138:139], v39 offset:1024
    v_mfma_f32_16x16x32_bf16 v[152:155], a[168:171], a[244:247], v[152:155]
    ds_read_b64_tr_b16 a[140:141], v39 offset:8
    v_mfma_f32_16x16x32_bf16 v[148:151], a[164:167], a[244:247], v[148:151]
    buffer_load_dwordx4 v37, s[8:11], s28 offen offset:3072 lds
    v_mfma_f32_16x16x32_bf16 v[144:147], a[160:163], a[244:247], v[144:147]
    s_add_u32 m0, s15, s34
    ds_read_b64_tr_b16 a[142:143], v39 offset:1032
    v_mfma_f32_16x16x32_bf16 v[176:179], a[160:163], a[248:251], v[176:179]
    s_add_u32 s28, s28, s32
    ds_read_b64_tr_b16 a[144:145], v40 offset:0
    v_mfma_f32_16x16x32_bf16 v[180:183], a[164:167], a[248:251], v[180:183]
    ds_read_b64_tr_b16 a[146:147], v40 offset:1024
    v_mfma_f32_16x16x32_bf16 v[184:187], a[168:171], a[248:251], v[184:187]
    buffer_load_dwordx4 v34, s[8:11], s29 offen offset:0 lds
    v_mfma_f32_16x16x32_bf16 v[188:191], a[172:175], a[248:251], v[188:191]
    s_cmp_ge_u32 s28, s0
    ds_read_b64_tr_b16 a[148:149], v40 offset:8
    v_mfma_f32_16x16x32_bf16 v[192:195], a[176:179], a[248:251], v[192:195]
    s_cselect_b32 s52, s1, 0
    ds_read_b64_tr_b16 a[150:151], v40 offset:1032
    v_mfma_f32_16x16x32_bf16 v[196:199], a[180:183], a[248:251], v[196:199]
    s_sub_u32 s28, s28, s52
    ds_read_b64_tr_b16 a[152:153], v41 offset:0
    v_mfma_f32_16x16x32_bf16 v[200:203], a[184:187], a[248:251], v[200:203]
    buffer_load_dwordx4 v35, s[8:11], s29 offen offset:1024 lds
    v_mfma_f32_16x16x32_bf16 v[204:207], a[188:191], a[248:251], v[204:207]
    ds_read_b64_tr_b16 a[154:155], v41 offset:1024
    v_mfma_f32_16x16x32_bf16 v[236:239], a[188:191], a[252:255], v[236:239]
    ds_read_b64_tr_b16 a[156:157], v41 offset:8
    v_mfma_f32_16x16x32_bf16 v[232:235], a[184:187], a[252:255], v[232:235]
    ds_read_b64_tr_b16 a[158:159], v41 offset:1032
    v_mfma_f32_16x16x32_bf16 v[228:231], a[180:183], a[252:255], v[228:231]
    buffer_load_dwordx4 v36, s[8:11], s29 offen offset:2048 lds
    v_mfma_f32_16x16x32_bf16 v[224:227], a[176:179], a[252:255], v[224:227]
    v_mfma_f32_16x16x32_bf16 v[220:223], a[172:175], a[252:255], v[220:223]
    v_mfma_f32_16x16x32_bf16 v[216:219], a[168:171], a[252:255], v[216:219]
    v_mfma_f32_16x16x32_bf16 v[212:215], a[164:167], a[252:255], v[212:215]
    buffer_load_dwordx4 v37, s[8:11], s29 offen offset:3072 lds
    v_mfma_f32_16x16x32_bf16 v[208:211], a[160:163], a[252:255], v[208:211]
    s_waitcnt lgkmcnt(0)
    s_waitcnt vmcnt(16)
    s_barrier
    v_mfma_f32_16x16x32_bf16 v[112:115], a[128:131], a[192:195], v[112:115]
    s_mov_b32 m0, s12
    ds_read_b128 a[200:203], v42 offset:4096
    v_mfma_f32_16x16x32_bf16 v[116:119], a[132:135], a[192:195], v[116:119]
    s_add_u32 s29, s28, s30
    ds_read_b128 a[204:207], v42 offset:6144
    v_mfma_f32_16x16x32_bf16 v[120:123], a[136:139], a[192:195], v[120:123]
    buffer_load_dwordx4 v34, s[8:11], s28 offen offset:0 lds
    v_mfma_f32_16x16x32_bf16 v[124:127], a[140:143], a[192:195], v[124:127]
    ds_read_b128 a[216:219], v43 offset:4096
    v_mfma_f32_16x16x32_bf16 v[128:131], a[144:147], a[192:195], v[128:131]
    ds_read_b128 a[220:223], v43 offset:6144
    v_mfma_f32_16x16x32_bf16 v[132:135], a[148:151], a[192:195], v[132:135]
    ds_read_b64_tr_b16 a[160:161], v38 offset:8192
    v_mfma_f32_16x16x32_bf16 v[136:139], a[152:155], a[192:195], v[136:139]
    buffer_load_dwordx4 v35, s[8:11], s28 offen offset:1024 lds
    v_mfma_f32_16x16x32_bf16 v[140:143], a[156:159], a[192:195], v[140:143]
    ds_read_b64_tr_b16 a[162:163], v38 offset:9216
    v_mfma_f32_16x16x32_bf16 v[172:175], a[156:159], a[196:199], v[172:175]
    ds_read_b64_tr_b16 a[164:165], v38 offset:8200
    v_mfma_f32_16x16x32_bf16 v[168:171], a[152:155], a[196:199], v[168:171]
    ds_read_b64_tr_b16 a[166:167], v38 offset:9224
    v_mfma_f32_16x16x32_bf16 v[164:167], a[148:151], a[196:199], v[164:167]
    buffer_load_dwordx4 v36, s[8:11], s28 offen offset:2048 lds
    v_mfma_f32_16x16x32_bf16 v[160:163], a[144:147], a[196:199], v[160:163]
    ds_read_b64_tr_b16 a[168:169], v39 offset:8192
    v_mfma_f32_16x16x32_bf16 v[156:159], a[140:143], a[196:199], v[156:159]
    ds_read_b64_tr_b16 a[170:171], v39 offset:9216
    v_mfma_f32_16x16x32_bf16 v[152:155], a[136:139], a[196:199], v[152:155]
    ds_read_b64_tr_b16 a[172:173], v39 offset:8200
    v_mfma_f32_16x16x32_bf16 v[148:151], a[132:135], a[196:199], v[148:151]
    buffer_load_dwordx4 v37, s[8:11], s28 offen offset:3072 lds
    v_mfma_f32_16x16x32_bf16 v[144:147], a[128:131], a[196:199], v[144:147]
    s_waitcnt lgkmcnt(9)
    s_add_u32 m0, s12, s34
    ds_read_b64_tr_b16 a[174:175], v39 offset:9224
    v_mfma_f32_16x16x32_bf16 v[176:179], a[128:131], a[200:203], v[176:179]
    s_add_u32 s28, s28, s31
    ds_read_b64_tr_b16 a[176:177], v40 offset:8192
    v_mfma_f32_16x16x32_bf16 v[180:183], a[132:135], a[200:203], v[180:183]
    ds_read_b64_tr_b16 a[178:179], v40 offset:9216
    v_mfma_f32_16x16x32_bf16 v[184:187], a[136:139], a[200:203], v[184:187]
    buffer_load_dwordx4 v34, s[8:11], s29 offen offset:0 lds
    v_mfma_f32_16x16x32_bf16 v[188:191], a[140:143], a[200:203], v[188:191]
    ds_read_b64_tr_b16 a[180:181], v40 offset:8200
    v_mfma_f32_16x16x32_bf16 v[192:195], a[144:147], a[200:203], v[192:195]
    ds_read_b64_tr_b16 a[182:183], v40 offset:9224
    v_mfma_f32_16x16x32_bf16 v[196:199], a[148:151], a[200:203], v[196:199]
    ds_read_b64_tr_b16 a[184:185], v41 offset:8192
    v_mfma_f32_16x16x32_bf16 v[200:203], a[152:155], a[200:203], v[200:203]
    buffer_load_dwordx4 v35, s[8:11], s29 offen offset:1024 lds
    v_mfma_f32_16x16x32_bf16 v[204:207], a[156:159], a[200:203], v[204:207]
    ds_read_b64_tr_b16 a[186:187], v41 offset:9216
    v_mfma_f32_16x16x32_bf16 v[236:239], a[156:159], a[204:207], v[236:239]
    ds_read_b64_tr_b16 a[188:189], v41 offset:8200
    v_mfma_f32_16x16x32_bf16 v[232:235], a[152:155], a[204:207], v[232:235]
    ds_read_b64_tr_b16 a[190:191], v41 offset:9224
    v_mfma_f32_16x16x32_bf16 v[228:231], a[148:151], a[204:207], v[228:231]
    buffer_load_dwordx4 v36, s[8:11], s29 offen offset:2048 lds
    v_mfma_f32_16x16x32_bf16 v[224:227], a[144:147], a[204:207], v[224:227]
    v_mfma_f32_16x16x32_bf16 v[220:223], a[140:143], a[204:207], v[220:223]
    v_mfma_f32_16x16x32_bf16 v[216:219], a[136:139], a[204:207], v[216:219]
    v_mfma_f32_16x16x32_bf16 v[212:215], a[132:135], a[204:207], v[212:215]
    buffer_load_dwordx4 v37, s[8:11], s29 offen offset:3072 lds
    v_mfma_f32_16x16x32_bf16 v[208:211], a[128:131], a[204:207], v[208:211]
    s_waitcnt lgkmcnt(0)
    s_waitcnt vmcnt(16)
    s_barrier
    v_mfma_f32_16x16x32_bf16 v[112:115], a[160:163], a[208:211], v[112:115]
    s_mov_b32 m0, s13
    ds_read_b128 a[224:227], v44 offset:0
    v_mfma_f32_16x16x32_bf16 v[116:119], a[164:167], a[208:211], v[116:119]
    s_add_u32 s29, s28, s30
    ds_read_b128 a[228:231], v44 offset:2048
    v_mfma_f32_16x16x32_bf16 v[120:123], a[168:171], a[208:211], v[120:123]
    buffer_load_dwordx4 v34, s[8:11], s28 offen offset:0 lds
    v_mfma_f32_16x16x32_bf16 v[124:127], a[172:175], a[208:211], v[124:127]
    ds_read_b128 a[240:243], v45 offset:0
    v_mfma_f32_16x16x32_bf16 v[128:131], a[176:179], a[208:211], v[128:131]
    ds_read_b128 a[244:247], v45 offset:2048
    v_mfma_f32_16x16x32_bf16 v[132:135], a[180:183], a[208:211], v[132:135]
    ds_read_b64_tr_b16 a[128:129], v38 offset:16384
    v_mfma_f32_16x16x32_bf16 v[136:139], a[184:187], a[208:211], v[136:139]
    buffer_load_dwordx4 v35, s[8:11], s28 offen offset:1024 lds
    v_mfma_f32_16x16x32_bf16 v[140:143], a[188:191], a[208:211], v[140:143]
    ds_read_b64_tr_b16 a[130:131], v38 offset:17408
    v_mfma_f32_16x16x32_bf16 v[172:175], a[188:191], a[212:215], v[172:175]
    ds_read_b64_tr_b16 a[132:133], v38 offset:16392
    v_mfma_f32_16x16x32_bf16 v[168:171], a[184:187], a[212:215], v[168:171]
    ds_read_b64_tr_b16 a[134:135], v38 offset:17416
    v_mfma_f32_16x16x32_bf16 v[164:167], a[180:183], a[212:215], v[164:167]
    buffer_load_dwordx4 v36, s[8:11], s28 offen offset:2048 lds
    v_mfma_f32_16x16x32_bf16 v[160:163], a[176:179], a[212:215], v[160:163]
    ds_read_b64_tr_b16 a[136:137], v39 offset:16384
    v_mfma_f32_16x16x32_bf16 v[156:159], a[172:175], a[212:215], v[156:159]
    ds_read_b64_tr_b16 a[138:139], v39 offset:17408
    v_mfma_f32_16x16x32_bf16 v[152:155], a[168:171], a[212:215], v[152:155]
    ds_read_b64_tr_b16 a[140:141], v39 offset:16392
    v_mfma_f32_16x16x32_bf16 v[148:151], a[164:167], a[212:215], v[148:151]
    buffer_load_dwordx4 v37, s[8:11], s28 offen offset:3072 lds
    v_mfma_f32_16x16x32_bf16 v[144:147], a[160:163], a[212:215], v[144:147]
    s_add_u32 m0, s13, s34
    ds_read_b64_tr_b16 a[142:143], v39 offset:17416
    v_mfma_f32_16x16x32_bf16 v[176:179], a[160:163], a[216:219], v[176:179]
    s_add_u32 s28, s28, s32
    ds_read_b64_tr_b16 a[144:145], v40 offset:16384
    v_mfma_f32_16x16x32_bf16 v[180:183], a[164:167], a[216:219], v[180:183]
    ds_read_b64_tr_b16 a[146:147], v40 offset:17408
    v_mfma_f32_16x16x32_bf16 v[184:187], a[168:171], a[216:219], v[184:187]
    buffer_load_dwordx4 v34, s[8:11], s29 offen offset:0 lds
    v_mfma_f32_16x16x32_bf16 v[188:191], a[172:175], a[216:219], v[188:191]
    s_cmp_ge_u32 s28, s0
    ds_read_b64_tr_b16 a[148:149], v40 offset:16392
    v_mfma_f32_16x16x32_bf16 v[192:195], a[176:179], a[216:219], v[192:195]
    s_cselect_b32 s52, s1, 0
    ds_read_b64_tr_b16 a[150:151], v40 offset:17416
    v_mfma_f32_16x16x32_bf16 v[196:199], a[180:183], a[216:219], v[196:199]
    s_sub_u32 s28, s28, s52
    ds_read_b64_tr_b16 a[152:153], v41 offset:16384
    v_mfma_f32_16x16x32_bf16 v[200:203], a[184:187], a[216:219], v[200:203]
    buffer_load_dwordx4 v35, s[8:11], s29 offen offset:1024 lds
    v_mfma_f32_16x16x32_bf16 v[204:207], a[188:191], a[216:219], v[204:207]
    ds_read_b64_tr_b16 a[154:155], v41 offset:17408
    v_mfma_f32_16x16x32_bf16 v[236:239], a[188:191], a[220:223], v[236:239]
    ds_read_b64_tr_b16 a[156:157], v41 offset:16392
    v_mfma_f32_16x16x32_bf16 v[232:235], a[184:187], a[220:223], v[232:235]
    ds_read_b64_tr_b16 a[158:159], v41 offset:17416
    v_mfma_f32_16x16x32_bf16 v[228:231], a[180:183], a[220:223], v[228:231]
    buffer_load_dwordx4 v36, s[8:11], s29 offen offset:2048 lds
    v_mfma_f32_16x16x32_bf16 v[224:227], a[176:179], a[220:223], v[224:227]
    v_mfma_f32_16x16x32_bf16 v[220:223], a[172:175], a[220:223], v[220:223]
    v_mfma_f32_16x16x32_bf16 v[216:219], a[168:171], a[220:223], v[216:219]
    v_mfma_f32_16x16x32_bf16 v[212:215], a[164:167], a[220:223], v[212:215]
    buffer_load_dwordx4 v37, s[8:11], s29 offen offset:3072 lds
    v_mfma_f32_16x16x32_bf16 v[208:211], a[160:163], a[220:223], v[208:211]
    s_waitcnt lgkmcnt(0)
    s_waitcnt vmcnt(16)
    s_barrier
    v_mfma_f32_16x16x32_bf16 v[112:115], a[128:131], a[224:227], v[112:115]
    s_mov_b32 m0, s14
    ds_read_b128 a[232:235], v44 offset:4096
    v_mfma_f32_16x16x32_bf16 v[116:119], a[132:135], a[224:227], v[116:119]
    s_add_u32 s29, s28, s30
    ds_read_b128 a[236:239], v44 offset:6144
    v_mfma_f32_16x16x32_bf16 v[120:123], a[136:139], a[224:227], v[120:123]
    buffer_load_dwordx4 v34, s[8:11], s28 offen offset:0 lds
    v_mfma_f32_16x16x32_bf16 v[124:127], a[140:143], a[224:227], v[124:127]
    ds_read_b128 a[248:251], v45 offset:4096
    v_mfma_f32_16x16x32_bf16 v[128:131], a[144:147], a[224:227], v[128:131]
    ds_read_b128 a[252:255], v45 offset:6144
    v_mfma_f32_16x16x32_bf16 v[132:135], a[148:151], a[224:227], v[132:135]
    ds_read_b64_tr_b16 a[160:161], v38 offset:24576
    v_mfma_f32_16x16x32_bf16 v[136:139], a[152:155], a[224:227], v[136:139]
    buffer_load_dwordx4 v35, s[8:11], s28 offen offset:1024 lds
    v_mfma_f32_16x16x32_bf16 v[140:143], a[156:159], a[224:227], v[140:143]
    ds_read_b64_tr_b16 a[162:163], v38 offset:25600
    v_mfma_f32_16x16x32_bf16 v[172:175], a[156:159], a[228:231], v[172:175]
    ds_read_b64_tr_b16 a[164:165], v38 offset:24584
    v_mfma_f32_16x16x32_bf16 v[168:171], a[152:155], a[228:231], v[168:171]
    ds_read_b64_tr_b16 a[166:167], v38 offset:25608
    v_mfma_f32_16x16x32_bf16 v[164:167], a[148:151], a[228:231], v[164:167]
    buffer_load_dwordx4 v36, s[8:11], s28 offen offset:2048 lds
    v_mfma_f32_16x16x32_bf16 v[160:163], a[144:147], a[228:231], v[160:163]
    ds_read_b64_tr_b16 a[168:169], v39 offset:24576
    v_mfma_f32_16x16x32_bf16 v[156:159], a[140:143], a[228:231], v[156:159]
    ds_read_b64_tr_b16 a[170:171], v39 offset:25600
    v_mfma_f32_16x16x32_bf16 v[152:155], a[136:139], a[228:231], v[152:155]
    ds_read_b64_tr_b16 a[172:173], v39 offset:24584
    v_mfma_f32_16x16x32_bf16 v[148:151], a[132:135], a[228:231], v[148:151]
    buffer_load_dwordx4 v37, s[8:11], s28 offen offset:3072 lds
    v_mfma_f32_16x16x32_bf16 v[144:147], a[128:131], a[228:231], v[144:147]
    s_waitcnt lgkmcnt(9)
    s_add_u32 m0, s14, s34
    ds_read_b64_tr_b16 a[174:175], v39 offset:25608
    v_mfma_f32_16x16x32_bf16 v[176:179], a[128:131], a[232:235], v[176:179]
    s_add_u32 s28, s28, s31
    ds_read_b64_tr_b16 a[176:177], v40 offset:24576
    v_mfma_f32_16x16x32_bf16 v[180:183], a[132:135], a[232:235], v[180:183]
    ds_read_b64_tr_b16 a[178:179], v40 offset:25600
    v_mfma_f32_16x16x32_bf16 v[184:187], a[136:139], a[232:235], v[184:187]
    buffer_load_dwordx4 v34, s[8:11], s29 offen offset:0 lds
    v_mfma_f32_16x16x32_bf16 v[188:191], a[140:143], a[232:235], v[188:191]
    ds_read_b64_tr_b16 a[180:181], v40 offset:24584
    v_mfma_f32_16x16x32_bf16 v[192:195], a[144:147], a[232:235], v[192:195]
    ds_read_b64_tr_b16 a[182:183], v40 offset:25608
    v_mfma_f32_16x16x32_bf16 v[196:199], a[148:151], a[232:235], v[196:199]
    ds_read_b64_tr_b16 a[184:185], v41 offset:24576
    v_mfma_f32_16x16x32_bf16 v[200:203], a[152:155], a[232:235], v[200:203]
    buffer_load_dwordx4 v35, s[8:11], s29 offen offset:1024 lds
    v_mfma_f32_16x16x32_bf16 v[204:207], a[156:159], a[232:235], v[204:207]
    ds_read_b64_tr_b16 a[186:187], v41 offset:25600
    v_mfma_f32_16x16x32_bf16 v[236:239], a[156:159], a[236:239], v[236:239]
    ds_read_b64_tr_b16 a[188:189], v41 offset:24584
    v_mfma_f32_16x16x32_bf16 v[232:235], a[152:155], a[236:239], v[232:235]
    ds_read_b64_tr_b16 a[190:191], v41 offset:25608
    v_mfma_f32_16x16x32_bf16 v[228:231], a[148:151], a[236:239], v[228:231]
    buffer_load_dwordx4 v36, s[8:11], s29 offen offset:2048 lds
    v_mfma_f32_16x16x32_bf16 v[224:227], a[144:147], a[236:239], v[224:227]
    v_mfma_f32_16x16x32_bf16 v[220:223], a[140:143], a[236:239], v[220:223]
    v_mfma_f32_16x16x32_bf16 v[216:219], a[136:139], a[236:239], v[216:219]
    v_mfma_f32_16x16x32_bf16 v[212:215], a[132:135], a[236:239], v[212:215]
    buffer_load_dwordx4 v37, s[8:11], s29 offen offset:3072 lds
    v_mfma_f32_16x16x32_bf16 v[208:211], a[128:131], a[236:239], v[208:211]
    s_waitcnt lgkmcnt(0)
    s_waitcnt vmcnt(16)
    s_barrier
    v_mfma_f32_16x16x32_bf16 v[112:115], a[160:163], a[240:243], v[112:115]
    s_mov_b32 m0, s15
    ds_read_b128 a[192:195], v42 offset:0
    v_mfma_f32_16x16x32_bf16 v[116:119], a[164:167], a[240:243], v[116:119]
    s_add_u32 s29, s28, s30
    ds_read_b128 a[196:199], v42 offset:2048
    v_mfma_f32_16x16x32_bf16 v[120:123], a[168:171], a[240:243], v[120:123]
    buffer_load_dwordx4 v34, s[8:11], s28 offen offset:0 lds
    v_mfma_f32_16x16x32_bf16 v[124:127], a[172:175], a[240:243], v[124:127]
    ds_read_b128 a[208:211], v43 offset:0
    v_mfma_f32_16x16x32_bf16 v[128:131], a[176:179], a[240:243], v[128:131]
    ds_read_b128 a[212:215], v43 offset:2048
    v_mfma_f32_16x16x32_bf16 v[132:135], a[180:183], a[240:243], v[132:135]
    ds_read_b64_tr_b16 a[128:129], v38 offset:0
    v_mfma_f32_16x16x32_bf16 v[136:139], a[184:187], a[240:243], v[136:139]
    buffer_load_dwordx4 v35, s[8:11], s28 offen offset:1024 lds
    v_mfma_f32_16x16x32_bf16 v[140:143], a[188:191], a[240:243], v[140:143]
    ds_read_b64_tr_b16 a[130:131], v38 offset:1024
    v_mfma_f32_16x16x32_bf16 v[172:175], a[188:191], a[244:247], v[172:175]
    ds_read_b64_tr_b16 a[132:133], v38 offset:8
    v_mfma_f32_16x16x32_bf16 v[168:171], a[184:187], a[244:247], v[168:171]
    ds_read_b64_tr_b16 a[134:135], v38 offset:1032
    v_mfma_f32_16x16x32_bf16 v[164:167], a[180:183], a[244:247], v[164:167]
    buffer_load_dwordx4 v36, s[8:11], s28 offen offset:2048 lds
    v_mfma_f32_16x16x32_bf16 v[160:163], a[176:179], a[244:247], v[160:163]
    ds_read_b64_tr_b16 a[136:137], v39 offset:0
    v_mfma_f32_16x16x32_bf16 v[156:159], a[172:175], a[244:247], v[156:159]
    ds_read_b64_tr_b16 a[138:139], v39 offset:1024
    v_mfma_f32_16x16x32_bf16 v[152:155], a[168:171], a[244:247], v[152:155]
    ds_read_b64_tr_b16 a[140:141], v39 offset:8
    v_mfma_f32_16x16x32_bf16 v[148:151], a[164:167], a[244:247], v[148:151]
    buffer_load_dwordx4 v37, s[8:11], s28 offen offset:3072 lds
    v_mfma_f32_16x16x32_bf16 v[144:147], a[160:163], a[244:247], v[144:147]
    s_add_u32 m0, s15, s34
    ds_read_b64_tr_b16 a[142:143], v39 offset:1032
    v_mfma_f32_16x16x32_bf16 v[176:179], a[160:163], a[248:251], v[176:179]
    s_add_u32 s28, s28, s32
    ds_read_b64_tr_b16 a[144:145], v40 offset:0
    v_mfma_f32_16x16x32_bf16 v[180:183], a[164:167], a[248:251], v[180:183]
    ds_read_b64_tr_b16 a[146:147], v40 offset:1024
    v_mfma_f32_16x16x32_bf16 v[184:187], a[168:171], a[248:251], v[184:187]
    buffer_load_dwordx4 v34, s[8:11], s29 offen offset:0 lds
    v_mfma_f32_16x16x32_bf16 v[188:191], a[172:175], a[248:251], v[188:191]
    s_cmp_ge_u32 s28, s0
    ds_read_b64_tr_b16 a[148:149], v40 offset:8
    v_mfma_f32_16x16x32_bf16 v[192:195], a[176:179], a[248:251], v[192:195]
    s_cselect_b32 s52, s1, 0
    ds_read_b64_tr_b16 a[150:151], v40 offset:1032
    v_mfma_f32_16x16x32_bf16 v[196:199], a[180:183], a[248:251], v[196:199]
    s_sub_u32 s28, s28, s52
    ds_read_b64_tr_b16 a[152:153], v41 offset:0
    v_mfma_f32_16x16x32_bf16 v[200:203], a[184:187], a[248:251], v[200:203]
    buffer_load_dwordx4 v35, s[8:11], s29 offen offset:1024 lds
    v_mfma_f32_16x16x32_bf16 v[204:207], a[188:191], a[248:251], v[204:207]
    ds_read_b64_tr_b16 a[154:155], v41 offset:1024
    v_mfma_f32_16x16x32_bf16 v[236:239], a[188:191], a[252:255], v[236:239]
    ds_read_b64_tr_b16 a[156:157], v41 offset:8
    v_mfma_f32_16x16x32_bf16 v[232:235], a[184:187], a[252:255], v[232:235]
    ds_read_b64_tr_b16 a[158:159], v41 offset:1032
    v_mfma_f32_16x16x32_bf16 v[228:231], a[180:183], a[252:255], v[228:231]
    buffer_load_dwordx4 v36, s[8:11], s29 offen offset:2048 lds
    v_mfma_f32_16x16x32_bf16 v[224:227], a[176:179], a[252:255], v[224:227]
    v_mfma_f32_16x16x32_bf16 v[220:223], a[172:175], a[252:255], v[220:223]
    v_mfma_f32_16x16x32_bf16 v[216:219], a[168:171], a[252:255], v[216:219]
    v_mfma_f32_16x16x32_bf16 v[212:215], a[164:167], a[252:255], v[212:215]
    buffer_load_dwordx4 v37, s[8:11], s29 offen offset:3072 lds
    v_mfma_f32_16x16x32_bf16 v[208:211], a[160:163], a[252:255], v[208:211]
    s_waitcnt lgkmcnt(0)
    s_waitcnt vmcnt(16)
    s_barrier
    v_mfma_f32_16x16x32_bf16 v[112:115], a[128:131], a[192:195], v[112:115]
    s_add_u32 m0, s96, 81920
    ds_read_b128 a[200:203], v42 offset:4096
    v_mfma_f32_16x16x32_bf16 v[116:119], a[132:135], a[192:195], v[116:119]
    ds_read_b128 a[204:207], v42 offset:6144
    v_mfma_f32_16x16x32_bf16 v[120:123], a[136:139], a[192:195], v[120:123]
    buffer_load_dwordx4 v32, s[20:23], s95 offen offset:0 nt lds
    v_mfma_f32_16x16x32_bf16 v[124:127], a[140:143], a[192:195], v[124:127]
    ds_read_b128 a[216:219], v43 offset:4096
    v_mfma_f32_16x16x32_bf16 v[128:131], a[144:147], a[192:195], v[128:131]
    ds_read_b128 a[220:223], v43 offset:6144
    v_mfma_f32_16x16x32_bf16 v[132:135], a[148:151], a[192:195], v[132:135]
    ds_read_b64_tr_b16 a[160:161], v38 offset:8192
    v_mfma_f32_16x16x32_bf16 v[136:139], a[152:155], a[192:195], v[136:139]
    ds_read_b64_tr_b16 a[162:163], v38 offset:9216
    v_mfma_f32_16x16x32_bf16 v[140:143], a[156:159], a[192:195], v[140:143]
    buffer_load_dwordx4 v33, s[20:23], s95 offen offset:1024 nt lds
    v_mfma_f32_16x16x32_bf16 v[172:175], a[156:159], a[196:199], v[172:175]
    ds_read_b64_tr_b16 a[164:165], v38 offset:8200
    v_mfma_f32_16x16x32_bf16 v[168:171], a[152:155], a[196:199], v[168:171]
    ds_read_b64_tr_b16 a[166:167], v38 offset:9224
    v_mfma_f32_16x16x32_bf16 v[164:167], a[148:151], a[196:199], v[164:167]
    ds_read_b64_tr_b16 a[168:169], v39 offset:8192
    v_mfma_f32_16x16x32_bf16 v[160:163], a[144:147], a[196:199], v[160:163]
    ds_read_b64_tr_b16 a[170:171], v39 offset:9216
    v_mfma_f32_16x16x32_bf16 v[156:159], a[140:143], a[196:199], v[156:159]
    buffer_load_dwordx4 v32, s[20:23], s95 offen offset:2048 nt lds
    v_mfma_f32_16x16x32_bf16 v[152:155], a[136:139], a[196:199], v[152:155]
    ds_read_b64_tr_b16 a[172:173], v39 offset:8200
    v_mfma_f32_16x16x32_bf16 v[148:151], a[132:135], a[196:199], v[148:151]
    ds_read_b64_tr_b16 a[174:175], v39 offset:9224
    v_mfma_f32_16x16x32_bf16 v[144:147], a[128:131], a[196:199], v[144:147]
    s_waitcnt lgkmcnt(10)
    ds_read_b64_tr_b16 a[176:177], v40 offset:8192
    v_mfma_f32_16x16x32_bf16 v[176:179], a[128:131], a[200:203], v[176:179]
    ds_read_b64_tr_b16 a[178:179], v40 offset:9216
    v_mfma_f32_16x16x32_bf16 v[180:183], a[132:135], a[200:203], v[180:183]
    buffer_load_dwordx4 v33, s[20:23], s95 offen offset:3072 nt lds
    v_mfma_f32_16x16x32_bf16 v[184:187], a[136:139], a[200:203], v[184:187]
    s_add_u32 s95, s95, 16384
    ds_read_b64_tr_b16 a[180:181], v40 offset:8200
    v_mfma_f32_16x16x32_bf16 v[188:191], a[140:143], a[200:203], v[188:191]
    ds_read_b64_tr_b16 a[182:183], v40 offset:9224
    v_mfma_f32_16x16x32_bf16 v[192:195], a[144:147], a[200:203], v[192:195]
    ds_read_b64_tr_b16 a[184:185], v41 offset:8192
    v_mfma_f32_16x16x32_bf16 v[196:199], a[148:151], a[200:203], v[196:199]
    ds_read_b64_tr_b16 a[186:187], v41 offset:9216
    v_mfma_f32_16x16x32_bf16 v[200:203], a[152:155], a[200:203], v[200:203]
    ds_read_b64_tr_b16 a[188:189], v41 offset:8200
    v_mfma_f32_16x16x32_bf16 v[204:207], a[156:159], a[200:203], v[204:207]
    ds_read_b64_tr_b16 a[190:191], v41 offset:9224
    v_mfma_f32_16x16x32_bf16 v[236:239], a[156:159], a[204:207], v[236:239]
    v_mfma_f32_16x16x32_bf16 v[232:235], a[152:155], a[204:207], v[232:235]
    v_mfma_f32_16x16x32_bf16 v[228:231], a[148:151], a[204:207], v[228:231]
    v_mfma_f32_16x16x32_bf16 v[224:227], a[144:147], a[204:207], v[224:227]
    v_mfma_f32_16x16x32_bf16 v[220:223], a[140:143], a[204:207], v[220:223]
    v_mfma_f32_16x16x32_bf16 v[216:219], a[136:139], a[204:207], v[216:219]
    v_mfma_f32_16x16x32_bf16 v[212:215], a[132:135], a[204:207], v[212:215]
    v_mfma_f32_16x16x32_bf16 v[208:211], a[128:131], a[204:207], v[208:211]
    s_waitcnt lgkmcnt(0)
    s_waitcnt vmcnt(12)
    s_barrier
    v_mfma_f32_16x16x32_bf16 v[112:115], a[160:163], a[208:211], v[112:115]
    s_add_u32 m0, s96, 32768
    ds_read_b128 a[224:227], v44 offset:0
    v_mfma_f32_16x16x32_bf16 v[116:119], a[164:167], a[208:211], v[116:119]
    ds_read_b128 a[228:231], v44 offset:2048
    v_mfma_f32_16x16x32_bf16 v[120:123], a[168:171], a[208:211], v[120:123]
    buffer_load_dwordx4 v28, s[16:19], s50 offen offset:0 nt lds
    v_mfma_f32_16x16x32_bf16 v[124:127], a[172:175], a[208:211], v[124:127]
    ds_read_b128 a[240:243], v45 offset:0
    v_mfma_f32_16x16x32_bf16 v[128:131], a[176:179], a[208:211], v[128:131]
    ds_read_b128 a[244:247], v45 offset:2048
    v_mfma_f32_16x16x32_bf16 v[132:135], a[180:183], a[208:211], v[132:135]
    ds_read_b64_tr_b16 a[128:129], v38 offset:16384
    v_mfma_f32_16x16x32_bf16 v[136:139], a[184:187], a[208:211], v[136:139]
    ds_read_b64_tr_b16 a[130:131], v38 offset:17408
    v_mfma_f32_16x16x32_bf16 v[140:143], a[188:191], a[208:211], v[140:143]
    buffer_load_dwordx4 v29, s[16:19], s50 offen offset:1024 nt lds
    v_mfma_f32_16x16x32_bf16 v[172:175], a[188:191], a[212:215], v[172:175]
    ds_read_b64_tr_b16 a[132:133], v38 offset:16392
    v_mfma_f32_16x16x32_bf16 v[168:171], a[184:187], a[212:215], v[168:171]
    ds_read_b64_tr_b16 a[134:135], v38 offset:17416
    v_mfma_f32_16x16x32_bf16 v[164:167], a[180:183], a[212:215], v[164:167]
    ds_read_b64_tr_b16 a[136:137], v39 offset:16384
    v_mfma_f32_16x16x32_bf16 v[160:163], a[176:179], a[212:215], v[160:163]
    ds_read_b64_tr_b16 a[138:139], v39 offset:17408
    v_mfma_f32_16x16x32_bf16 v[156:159], a[172:175], a[212:215], v[156:159]
    buffer_load_dwordx4 v30, s[16:19], s50 offen offset:2048 nt lds
    v_mfma_f32_16x16x32_bf16 v[152:155], a[168:171], a[212:215], v[152:155]
    ds_read_b64_tr_b16 a[140:141], v39 offset:16392
    v_mfma_f32_16x16x32_bf16 v[148:151], a[164:167], a[212:215], v[148:151]
    ds_read_b64_tr_b16 a[142:143], v39 offset:17416
    v_mfma_f32_16x16x32_bf16 v[144:147], a[160:163], a[212:215], v[144:147]
    ds_read_b64_tr_b16 a[144:145], v40 offset:16384
    v_mfma_f32_16x16x32_bf16 v[176:179], a[160:163], a[216:219], v[176:179]
    ds_read_b64_tr_b16 a[146:147], v40 offset:17408
    v_mfma_f32_16x16x32_bf16 v[180:183], a[164:167], a[216:219], v[180:183]
    buffer_load_dwordx4 v31, s[16:19], s50 offen offset:3072 nt lds
    v_mfma_f32_16x16x32_bf16 v[184:187], a[168:171], a[216:219], v[184:187]
    s_add_u32 s50, s50, 16384
    ds_read_b64_tr_b16 a[148:149], v40 offset:16392
    v_mfma_f32_16x16x32_bf16 v[188:191], a[172:175], a[216:219], v[188:191]
    ds_read_b64_tr_b16 a[150:151], v40 offset:17416
    v_mfma_f32_16x16x32_bf16 v[192:195], a[176:179], a[216:219], v[192:195]
    ds_read_b64_tr_b16 a[152:153], v41 offset:16384
    v_mfma_f32_16x16x32_bf16 v[196:199], a[180:183], a[216:219], v[196:199]
    ds_read_b64_tr_b16 a[154:155], v41 offset:17408
    v_mfma_f32_16x16x32_bf16 v[200:203], a[184:187], a[216:219], v[200:203]
    ds_read_b64_tr_b16 a[156:157], v41 offset:16392
    v_mfma_f32_16x16x32_bf16 v[204:207], a[188:191], a[216:219], v[204:207]
    ds_read_b64_tr_b16 a[158:159], v41 offset:17416
    v_mfma_f32_16x16x32_bf16 v[236:239], a[188:191], a[220:223], v[236:239]
    v_mfma_f32_16x16x32_bf16 v[232:235], a[184:187], a[220:223], v[232:235]
    v_mfma_f32_16x16x32_bf16 v[228:231], a[180:183], a[220:223], v[228:231]
    v_mfma_f32_16x16x32_bf16 v[224:227], a[176:179], a[220:223], v[224:227]
    v_mfma_f32_16x16x32_bf16 v[220:223], a[172:175], a[220:223], v[220:223]
    v_mfma_f32_16x16x32_bf16 v[216:219], a[168:171], a[220:223], v[216:219]
    v_mfma_f32_16x16x32_bf16 v[212:215], a[164:167], a[220:223], v[212:215]
    v_mfma_f32_16x16x32_bf16 v[208:211], a[160:163], a[220:223], v[208:211]
    s_waitcnt lgkmcnt(0)
    s_branch L1_qend
L1_q3:
    s_lshr_b32 s52, s2, 6
    s_mul_i32 s54, s52, 1310720
    s_and_b32 s52, s2, 63
    s_mul_i32 s52, s52, 15360
    s_add_u32 s54, s54, s52
    s_add_u32 s54, s54, 327680
    v_lshlrev_b32 v46, 7, v0
    v_min_u32 v47, 7040, v46
    s_barrier
    ds_read_b128 a[192:195], v42 offset:0
    ds_read_b128 a[196:199], v42 offset:2048
    ds_read_b128 a[208:211], v43 offset:0
    ds_read_b128 a[212:215], v43 offset:2048
    ds_read_b64_tr_b16 a[128:129], v38 offset:0
    ds_read_b64_tr_b16 a[130:131], v38 offset:1024
    ds_read_b64_tr_b16 a[132:133], v38 offset:8
    ds_read_b64_tr_b16 a[134:135], v38 offset:1032
    ds_read_b64_tr_b16 a[136:137], v39 offset:0
    ds_read_b64_tr_b16 a[138:139], v39 offset:1024
    ds_read_b64_tr_b16 a[140:141], v39 offset:8
    ds_read_b64_tr_b16 a[142:143], v39 offset:1032
    ds_read_b64_tr_b16 a[144:145], v40 offset:0
    ds_read_b64_tr_b16 a[146:147], v40 offset:1024
    ds_read_b64_tr_b16 a[148:149], v40 offset:8
    ds_read_b64_tr_b16 a[150:151], v40 offset:1032
    ds_read_b64_tr_b16 a[152:153], v41 offset:0
    ds_read_b64_tr_b16 a[154:155], v41 offset:1024
    ds_read_b64_tr_b16 a[156:157], v41 offset:8
    ds_read_b64_tr_b16 a[158:159], v41 offset:1032
    s_waitcnt lgkmcnt(0)
    s_barrier
    v_mfma_f32_16x16x32_bf16 v[112:115], a[128:131], a[192:195], 0
    ds_read_b128 a[200:203], v42 offset:4096
    v_accvgpr_write_b32 a0, 0
    v_mfma_f32_16x16x32_bf16 v[116:119], a[132:135], a[192:195], 0
    ds_read_b128 a[204:207], v42 offset:6144
    v_accvgpr_write_b32 a1, 0
    v_mfma_f32_16x16x32_bf16 v[120:123], a[136:139], a[192:195], 0
    buffer_load_dword v34, v46, s[64:67], s54 offen
    v_mfma_f32_16x16x32_bf16 v[124:127], a[140:143], a[192:195], 0
    s_add_u32 s54, s54, 8192
    ds_read_b128 a[216:219], v43 offset:4096
    v_mfma_f32_16x16x32_bf16 v[128:131], a[144:147], a[192:195], 0
    ds_read_b128 a[220:223], v43 offset:6144
    v_accvgpr_write_b32 a2, 0
    v_mfma_f32_16x16x32_bf16 v[132:135], a[148:151], a[192:195], 0
    ds_read_b64_tr_b16 a[160:161], v38 offset:8192
    v_accvgpr_write_b32 a3, 0
    v_mfma_f32_16x16x32_bf16 v[136:139], a[152:155], a[192:195], 0
    ds_read_b64_tr_b16 a[162:163], v38 offset:9216
    v_accvgpr_write_b32 a4, 0
    v_mfma_f32_16x16x32_bf16 v[140:143], a[156:159], a[192:195], 0
    buffer_load_dword v35, v47, s[64:67], s54 offen
    v_mfma_f32_16x16x32_bf16 v[172:175], a[156:159], a[196:199], 0
    s_add_u32 s54, s54, 8192
    ds_read_b64_tr_b16 a[164:165], v38 offset:8200
    v_mfma_f32_16x16x32_bf16 v[168:171], a[152:155], a[196:199], 0
    ds_read_b64_tr_b16 a[166:167], v38 offset:9224
    v_accvgpr_write_b32 a5, 0
    v_mfma_f32_16x16x32_bf16 v[164:167], a[148:151], a[196:199], 0
    ds_read_b64_tr_b16 a[168:169], v39 offset:8192
    v_accvgpr_write_b32 a6, 0
    v_mfma_f32_16x16x32_bf16 v[160:163], a[144:147], a[196:199], 0
    ds_read_b64_tr_b16 a[170:171], v39 offset:9216
    v_accvgpr_write_b32 a7, 0
    v_mfma_f32_16x16x32_bf16 v[156:159], a[140:143], a[196:199], 0
    ds_read_b64_tr_b16 a[172:173], v39 offset:8200
    v_accvgpr_write_b32 a8, 0
    v_mfma_f32_16x16x32_bf16 v[152:155], a[136:139], a[196:199], 0
    ds_read_b64_tr_b16 a[174:175], v39 offset:9224
    v_accvgpr_write_b32 a9, 0
    v_mfma_f32_16x16x32_bf16 v[148:151], a[132:135], a[196:199], 0
    ds_read_b64_tr_b16 a[176:177], v40 offset:8192
    v_accvgpr_write_b32 a10, 0
    v_mfma_f32_16x16x32_bf16 v[144:147], a[128:131], a[196:199], 0
    s_waitcnt lgkmcnt(11)
    ds_read_b64_tr_b16 a[178:179], v40 offset:9216
    v_accvgpr_write_b32 a11, 0
    v_mfma_f32_16x16x32_bf16 v[176:179], a[128:131], a[200:203], 0
    ds_read_b64_tr_b16 a[180:181], v40 offset:8200
    v_accvgpr_write_b32 a12, 0
    v_mfma_f32_16x16x32_bf16 v[180:183], a[132:135], a[200:203], 0
    ds_read_b64_tr_b16 a[182:183], v40 offset:9224
    v_accvgpr_write_b32 a13, 0
    v_mfma_f32_16x16x32_bf16 v[184:187], a[136:139], a[200:203], 0
    ds_read_b64_tr_b16 a[184:185], v41 offset:8192
    v_accvgpr_write_b32 a14, 0
    v_mfma_f32_16x16x32_bf16 v[188:191], a[140:143], a[200:203], 0
    ds_read_b64_tr_b16 a[186:187], v41 offset:9216
    v_accvgpr_write_b32 a15, 0
    v_mfma_f32_16x16x32_bf16 v[192:195], a[144:147], a[200:203], 0
    ds_read_b64_tr_b16 a[188:189], v41 offset:8200
    v_accvgpr_write_b32 a16, 0
    v_mfma_f32_16x16x32_bf16 v[196:199], a[148:151], a[200:203], 0
    ds_read_b64_tr_b16 a[190:191], v41 offset:9224
    v_accvgpr_write_b32 a17, 0
    v_mfma_f32_16x16x32_bf16 v[200:203], a[152:155], a[200:203], 0
    v_mfma_f32_16x16x32_bf16 v[204:207], a[156:159], a[200:203], 0
    v_mfma_f32_16x16x32_bf16 v[236:239], a[156:159], a[204:207], 0
    v_mfma_f32_16x16x32_bf16 v[232:235], a[152:155], a[204:207], 0
    v_mfma_f32_16x16x32_bf16 v[228:231], a[148:151], a[204:207], 0
    v_mfma_f32_16x16x32_bf16 v[224:227], a[144:147], a[204:207], 0
    v_mfma_f32_16x16x32_bf16 v[220:223], a[140:143], a[204:207], 0
    v_mfma_f32_16x16x32_bf16 v[216:219], a[136:139], a[204:207], 0
    v_mfma_f32_16x16x32_bf16 v[212:215], a[132:135], a[204:207], 0
    v_mfma_f32_16x16x32_bf16 v[208:211], a[128:131], a[204:207], 0
    s_waitcnt lgkmcnt(0)
    s_barrier
    v_mfma_f32_16x16x32_bf16 v[112:115], a[160:163], a[208:211], v[112:115]
    ds_read_b128 a[224:227], v44 offset:0
    v_accvgpr_write_b32 a18, 0
    v_mfma_f32_16x16x32_bf16 v[116:119], a[164:167], a[208:211], v[116:119]
    ds_read_b128 a[228:231], v44 offset:2048
    v_accvgpr_write_b32 a19, 0
    v_mfma_f32_16x16x32_bf16 v[120:123], a[168:171], a[208:211], v[120:123]
    ds_read_b128 a[240:243], v45 offset:0
    v_accvgpr_write_b32 a20, 0
    v_mfma_f32_16x16x32_bf16 v[124:127], a[172:175], a[208:211], v[124:127]
    ds_read_b128 a[244:247], v45 offset:2048
    v_accvgpr_write_b32 a21, 0
    v_mfma_f32_16x16x32_bf16 v[128:131], a[176:179], a[208:211], v[128:131]
    ds_read_b64_tr_b16 a[128:129], v38 offset:16384
    v_accvgpr_write_b32 a22, 0
    v_mfma_f32_16x16x32_bf16 v[132:135], a[180:183], a[208:211], v[132:135]
    ds_read_b64_tr_b16 a[130:131], v38 offset:17408
    v_accvgpr_write_b32 a23, 0
    v_mfma_f32_16x16x32_bf16 v[136:139], a[184:187], a[208:211], v[136:139]
    ds_read_b64_tr_b16 a[132:133], v38 offset:16392
    v_accvgpr_write_b32 a24, 0
    v_mfma_f32_16x16x32_bf16 v[140:143], a[188:191], a[208:211], v[140:143]
    ds_read_b64_tr_b16 a[134:135], v38 offset:17416
    v_accvgpr_write_b32 a25, 0
    v_mfma_f32_16x16x32_bf16 v[172:175], a[188:191], a[212:215], v[172:175]
    ds_read_b64_tr_b16 a[136:137], v39 offset:16384
    v_accvgpr_write_b32 a26, 0
    v_mfma_f32_16x16x32_bf16 v[168:171], a[184:187], a[212:215], v[168:171]
    ds_read_b64_tr_b16 a[138:139], v39 offset:17408
    v_accvgpr_write_b32 a27, 0
    v_mfma_f32_16x16x32_bf16 v[164:167], a[180:183], a[212:215], v[164:167]
    ds_read_b64_tr_b16 a[140:141], v39 offset:16392
    v_accvgpr_write_b32 a28, 0
    v_mfma_f32_16x16x32_bf16 v[160:163], a[176:179], a[212:215], v[160:163]
    ds_read_b64_tr_b16 a[142:143], v39 offset:17416
    v_accvgpr_write_b32 a29, 0
    v_mfma_f32_16x16x32_bf16 v[156:159], a[172:175], a[212:215], v[156:159]
    ds_read_b64_tr_b16 a[144:145], v40 offset:16384
    v_accvgpr_write_b32 a30, 0
    v_mfma_f32_16x16x32_bf16 v[152:155], a[168:171], a[212:215], v[152:155]
    ds_read_b64_tr_b16 a[146:147], v40 offset:17408
    v_accvgpr_write_b32 a31, 0
    v_mfma_f32_16x16x32_bf16 v[148:151], a[164:167], a[212:215], v[148:151]
    ds_read_b64_tr_b16 a[148:149], v40 offset:16392
    v_accvgpr_write_b32 a32, 0
    v_mfma_f32_16x16x32_bf16 v[144:147], a[160:163], a[212:215], v[144:147]
    ds_read_b64_tr_b16 a[150:151], v40 offset:17416
    v_accvgpr_write_b32 a33, 0
    v_mfma_f32_16x16x32_bf16 v[176:179], a[160:163], a[216:219], v[176:179]
    ds_read_b64_tr_b16 a[152:153], v41 offset:16384
    v_accvgpr_write_b32 a34, 0
    v_mfma_f32_16x16x32_bf16 v[180:183], a[164:167], a[216:219], v[180:183]
    ds_read_b64_tr_b16 a[154:155], v41 offset:17408
    v_accvgpr_write_b32 a35, 0
    v_mfma_f32_16x16x32_bf16 v[184:187], a[168:171], a[216:219], v[184:187]
    ds_read_b64_tr_b16 a[156:157], v41 offset:16392
    v_accvgpr_write_b32 a36, 0
    v_mfma_f32_16x16x32_bf16 v[188:191], a[172:175], a[216:219], v[188:191]
    ds_read_b64_tr_b16 a[158:159], v41 offset:17416
    v_accvgpr_write_b32 a37, 0
    v_mfma_f32_16x16x32_bf16 v[192:195], a[176:179], a[216:219], v[192:195]
    v_mfma_f32_16x16x32_bf16 v[196:199], a[180:183], a[216:219], v[196:199]
    v_mfma_f32_16x16x32_bf16 v[200:203], a[184:187], a[216:219], v[200:203]
    v_mfma_f32_16x16x32_bf16 v[204:207], a[188:191], a[216:219], v[204:207]
    v_mfma_f32_16x16x32_bf16 v[236:239], a[188:191], a[220:223], v[236:239]
    v_mfma_f32_16x16x32_bf16 v[232:235], a[184:187], a[220:223], v[232:235]
    v_mfma_f32_16x16x32_bf16 v[228:231], a[180:183], a[220:223], v[228:231]
    v_mfma_f32_16x16x32_bf16 v[224:227], a[176:179], a[220:223], v[224:227]
    v_mfma_f32_16x16x32_bf16 v[220:223], a[172:175], a[220:223], v[220:223]
    v_mfma_f32_16x16x32_bf16 v[216:219], a[168:171], a[220:223], v[216:219]
    v_mfma_f32_16x16x32_bf16 v[212:215], a[164:167], a[220:223], v[212:215]
    v_mfma_f32_16x16x32_bf16 v[208:211], a[160:163], a[220:223], v[208:211]
    s_waitcnt lgkmcnt(0)
    s_barrier
    v_mfma_f32_16x16x32_bf16 v[112:115], a[128:131], a[224:227], v[112:115]
    s_mov_b32 m0, 0
    ds_read_b128 a[232:235], v44 offset:4096
    v_mfma_f32_16x16x32_bf16 v[116:119], a[132:135], a[224:227], v[116:119]
    s_mov_b32 s28, 0
    ds_read_b128 a[236:239], v44 offset:6144
    v_mfma_f32_16x16x32_bf16 v[120:123], a[136:139], a[224:227], v[120:123]
    buffer_load_dwordx4 v28, s[16:19], s28 offen offset:0 nt lds
    v_mfma_f32_16x16x32_bf16 v[124:127], a[140:143], a[224:227], v[124:127]
    ds_read_b128 a[248:251], v45 offset:4096
    v_accvgpr_write_b32 a38, 0
    v_mfma_f32_16x16x32_bf16 v[128:131], a[144:147], a[224:227], v[128:131]
    ds_read_b128 a[252:255], v45 offset:6144
    v_accvgpr_write_b32 a39, 0
    v_mfma_f32_16x16x32_bf16 v[132:135], a[148:151], a[224:227], v[132:135]
    ds_read_b64_tr_b16 a[160:161], v38 offset:24576
    v_accvgpr_write_b32 a40, 0
    v_mfma_f32_16x16x32_bf16 v[136:139], a[152:155], a[224:227], v[136:139]
    ds_read_b64_tr_b16 a[162:163], v38 offset:25600
    v_accvgpr_write_b32 a41, 0
    v_mfma_f32_16x16x32_bf16 v[140:143], a[156:159], a[224:227], v[140:143]
    buffer_load_dwordx4 v29, s[16:19], s28 offen offset:1024 nt lds
    v_mfma_f32_16x16x32_bf16 v[172:175], a[156:159], a[228:231], v[172:175]
    ds_read_b64_tr_b16 a[164:165], v38 offset:24584
    v_accvgpr_write_b32 a42, 0
    v_mfma_f32_16x16x32_bf16 v[168:171], a[152:155], a[228:231], v[168:171]
    ds_read_b64_tr_b16 a[166:167], v38 offset:25608
    v_accvgpr_write_b32 a43, 0
    v_mfma_f32_16x16x32_bf16 v[164:167], a[148:151], a[228:231], v[164:167]
    ds_read_b64_tr_b16 a[168:169], v39 offset:24576
    v_accvgpr_write_b32 a44, 0
    v_mfma_f32_16x16x32_bf16 v[160:163], a[144:147], a[228:231], v[160:163]
    ds_read_b64_tr_b16 a[170:171], v39 offset:25600
    v_accvgpr_write_b32 a45, 0
    v_mfma_f32_16x16x32_bf16 v[156:159], a[140:143], a[228:231], v[156:159]
    buffer_load_dwordx4 v30, s[16:19], s28 offen offset:2048 nt lds
    v_mfma_f32_16x16x32_bf16 v[152:155], a[136:139], a[228:231], v[152:155]
    ds_read_b64_tr_b16 a[172:173], v39 offset:24584
    v_accvgpr_write_b32 a46, 0
    v_mfma_f32_16x16x32_bf16 v[148:151], a[132:135], a[228:231], v[148:151]
    ds_read_b64_tr_b16 a[174:175], v39 offset:25608
    v_accvgpr_write_b32 a47, 0
    v_mfma_f32_16x16x32_bf16 v[144:147], a[128:131], a[228:231], v[144:147]
    s_waitcnt lgkmcnt(10)
    ds_read_b64_tr_b16 a[176:177], v40 offset:24576
    v_accvgpr_write_b32 a48, 0
    v_mfma_f32_16x16x32_bf16 v[176:179], a[128:131], a[232:235], v[176:179]
    ds_read_b64_tr_b16 a[178:179], v40 offset:25600
    v_accvgpr_write_b32 a49, 0
    v_mfma_f32_16x16x32_bf16 v[180:183], a[132:135], a[232:235], v[180:183]
    buffer_load_dwordx4 v31, s[16:19], s28 offen offset:3072 nt lds
    v_mfma_f32_16x16x32_bf16 v[184:187], a[136:139], a[232:235], v[184:187]
    ds_read_b64_tr_b16 a[180:181], v40 offset:24584
    v_accvgpr_write_b32 a50, 0
    v_mfma_f32_16x16x32_bf16 v[188:191], a[140:143], a[232:235], v[188:191]
    ds_read_b64_tr_b16 a[182:183], v40 offset:25608
    v_accvgpr_write_b32 a51, 0
    v_mfma_f32_16x16x32_bf16 v[192:195], a[144:147], a[232:235], v[192:195]
    ds_read_b64_tr_b16 a[184:185], v41 offset:24576
    v_accvgpr_write_b32 a52, 0
    v_mfma_f32_16x16x32_bf16 v[196:199], a[148:151], a[232:235], v[196:199]
    ds_read_b64_tr_b16 a[186:187], v41 offset:25600
    v_accvgpr_write_b32 a53, 0
    v_mfma_f32_16x16x32_bf16 v[200:203], a[152:155], a[232:235], v[200:203]
    ds_read_b64_tr_b16 a[188:189], v41 offset:24584
    v_accvgpr_write_b32 a54, 0
    v_mfma_f32_16x16x32_bf16 v[204:207], a[156:159], a[232:235], v[204:207]
    ds_read_b64_tr_b16 a[190:191], v41 offset:25608
    v_accvgpr_write_b32 a55, 0
    v_mfma_f32_16x16x32_bf16 v[236:239], a[156:159], a[236:239], v[236:239]
    v_mfma_f32_16x16x32_bf16 v[232:235], a[152:155], a[236:239], v[232:235]
    v_mfma_f32_16x16x32_bf16 v[228:231], a[148:151], a[236:239], v[228:231]
    v_mfma_f32_16x16x32_bf16 v[224:227], a[144:147], a[236:239], v[224:227]
    v_mfma_f32_16x16x32_bf16 v[220:223], a[140:143], a[236:239], v[220:223]
    v_mfma_f32_16x16x32_bf16 v[216:219], a[136:139], a[236:239], v[216:219]
    v_mfma_f32_16x16x32_bf16 v[212:215], a[132:135], a[236:239], v[212:215]
    v_mfma_f32_16x16x32_bf16 v[208:211], a[128:131], a[236:239], v[208:211]
    s_waitcnt lgkmcnt(0)
    s_barrier
    v_mfma_f32_16x16x32_bf16 v[112:115], a[160:163], a[240:243], v[112:115]
    s_mov_b32 m0, 4096
    ds_read_b128 a[192:195], v42 offset:0
    v_mfma_f32_16x16x32_bf16 v[116:119], a[164:167], a[240:243], v[116:119]
    s_mov_b32 s28, 4096
    ds_read_b128 a[196:199], v42 offset:2048
    v_mfma_f32_16x16x32_bf16 v[120:123], a[168:171], a[240:243], v[120:123]
    buffer_load_dwordx4 v28, s[16:19], s28 offen offset:0 nt lds
    v_mfma_f32_16x16x32_bf16 v[124:127], a[172:175], a[240:243], v[124:127]
    ds_read_b128 a[208:211], v43 offset:0
    v_accvgpr_write_b32 a56, 0
    v_mfma_f32_16x16x32_bf16 v[128:131], a[176:179], a[240:243], v[128:131]
    ds_read_b128 a[212:215], v43 offset:2048
    v_accvgpr_write_b32 a57, 0
    v_mfma_f32_16x16x32_bf16 v[132:135], a[180:183], a[240:243], v[132:135]
    ds_read_b64_tr_b16 a[128:129], v38 offset:0
    v_accvgpr_write_b32 a58, 0
    v_mfma_f32_16x16x32_bf16 v[136:139], a[184:187], a[240:243], v[136:139]
    ds_read_b64_tr_b16 a[130:131], v38 offset:1024
    v_accvgpr_write_b32 a59, 0
    v_mfma_f32_16x16x32_bf16 v[140:143], a[188:191], a[240:243], v[140:143]
    buffer_load_dwordx4 v29, s[16:19], s28 offen offset:1024 nt lds
    v_mfma_f32_16x16x32_bf16 v[172:175], a[188:191], a[244:247], v[172:175]
    ds_read_b64_tr_b16 a[132:133], v38 offset:8
    v_accvgpr_write_b32 a60, 0
    v_mfma_f32_16x16x32_bf16 v[168:171], a[184:187], a[244:247], v[168:171]
    ds_read_b64_tr_b16 a[134:135], v38 offset:1032
    v_accvgpr_write_b32 a61, 0
    v_mfma_f32_16x16x32_bf16 v[164:167], a[180:183], a[244:247], v[164:167]
    ds_read_b64_tr_b16 a[136:137], v39 offset:0
    v_accvgpr_write_b32 a62, 0
    v_mfma_f32_16x16x32_bf16 v[160:163], a[176:179], a[244:247], v[160:163]
    ds_read_b64_tr_b16 a[138:139], v39 offset:1024
    v_accvgpr_write_b32 a63, 0
    v_mfma_f32_16x16x32_bf16 v[156:159], a[172:175], a[244:247], v[156:159]
    buffer_load_dwordx4 v30, s[16:19], s28 offen offset:2048 nt lds
    v_mfma_f32_16x16x32_bf16 v[152:155], a[168:171], a[244:247], v[152:155]
    ds_read_b64_tr_b16 a[140:141], v39 offset:8
    v_accvgpr_write_b32 a64, 0
    v_mfma_f32_16x16x32_bf16 v[148:151], a[164:167], a[244:247], v[148:151]
    ds_read_b64_tr_b16 a[142:143], v39 offset:1032
    v_accvgpr_write_b32 a65, 0
    v_mfma_f32_16x16x32_bf16 v[144:147], a[160:163], a[244:247], v[144:147]
    ds_read_b64_tr_b16 a[144:145], v40 offset:0
    v_accvgpr_write_b32 a66, 0
    v_mfma_f32_16x16x32_bf16 v[176:179], a[160:163], a[248:251], v[176:179]
    ds_read_b64_tr_b16 a[146:147], v40 offset:1024
    v_accvgpr_write_b32 a67, 0
    v_mfma_f32_16x16x32_bf16 v[180:183], a[164:167], a[248:251], v[180:183]
    buffer_load_dwordx4 v31, s[16:19], s28 offen offset:3072 nt lds
    v_mfma_f32_16x16x32_bf16 v[184:187], a[168:171], a[248:251], v[184:187]
    ds_read_b64_tr_b16 a[148:149], v40 offset:8
    v_accvgpr_write_b32 a68, 0
    v_mfma_f32_16x16x32_bf16 v[188:191], a[172:175], a[248:251], v[188:191]
    ds_read_b64_tr_b16 a[150:151], v40 offset:1032
    v_accvgpr_write_b32 a69, 0
    v_mfma_f32_16x16x32_bf16 v[192:195], a[176:179], a[248:251], v[192:195]
    ds_read_b64_tr_b16 a[152:153], v41 offset:0
    v_accvgpr_write_b32 a70, 0
    v_mfma_f32_16x16x32_bf16 v[196:199], a[180:183], a[248:251], v[196:199]
    ds_read_b64_tr_b16 a[154:155], v41 offset:1024
    v_accvgpr_write_b32 a71, 0
    v_mfma_f32_16x16x32_bf16 v[200:203], a[184:187], a[248:251], v[200:203]
    ds_read_b64_tr_b16 a[156:157], v41 offset:8
    v_accvgpr_write_b32 a72, 0
    v_mfma_f32_16x16x32_bf16 v[204:207], a[188:191], a[248:251], v[204:207]
    ds_read_b64_tr_b16 a[158:159], v41 offset:1032
    v_accvgpr_write_b32 a73, 0
    v_mfma_f32_16x16x32_bf16 v[236:239], a[188:191], a[252:255], v[236:239]
    v_mfma_f32_16x16x32_bf16 v[232:235], a[184:187], a[252:255], v[232:235]
    v_mfma_f32_16x16x32_bf16 v[228:231], a[180:183], a[252:255], v[228:231]
    v_mfma_f32_16x16x32_bf16 v[224:227], a[176:179], a[252:255], v[224:227]
    v_mfma_f32_16x16x32_bf16 v[220:223], a[172:175], a[252:255], v[220:223]
    v_mfma_f32_16x16x32_bf16 v[216:219], a[168:171], a[252:255], v[216:219]
    v_mfma_f32_16x16x32_bf16 v[212:215], a[164:167], a[252:255], v[212:215]
    v_mfma_f32_16x16x32_bf16 v[208:211], a[160:163], a[252:255], v[208:211]
    s_waitcnt lgkmcnt(0)
    s_barrier
    v_mfma_f32_16x16x32_bf16 v[112:115], a[128:131], a[192:195], v[112:115]
    s_mov_b32 m0, 65536
    ds_read_b128 a[200:203], v42 offset:4096
    v_mfma_f32_16x16x32_bf16 v[116:119], a[132:135], a[192:195], v[116:119]
    s_mov_b32 s28, 0
    ds_read_b128 a[204:207], v42 offset:6144
    v_mfma_f32_16x16x32_bf16 v[120:123], a[136:139], a[192:195], v[120:123]
    buffer_load_dwordx4 v32, s[20:23], s28 offen offset:0 nt lds
    v_mfma_f32_16x16x32_bf16 v[124:127], a[140:143], a[192:195], v[124:127]
    ds_read_b128 a[216:219], v43 offset:4096
    v_accvgpr_write_b32 a74, 0
    v_mfma_f32_16x16x32_bf16 v[128:131], a[144:147], a[192:195], v[128:131]
    ds_read_b128 a[220:223], v43 offset:6144
    v_accvgpr_write_b32 a75, 0
    v_mfma_f32_16x16x32_bf16 v[132:135], a[148:151], a[192:195], v[132:135]
    ds_read_b64_tr_b16 a[160:161], v38 offset:8192
    v_accvgpr_write_b32 a76, 0
    v_mfma_f32_16x16x32_bf16 v[136:139], a[152:155], a[192:195], v[136:139]
    ds_read_b64_tr_b16 a[162:163], v38 offset:9216
    v_accvgpr_write_b32 a77, 0
    v_mfma_f32_16x16x32_bf16 v[140:143], a[156:159], a[192:195], v[140:143]
    buffer_load_dwordx4 v33, s[20:23], s28 offen offset:1024 nt lds
    v_mfma_f32_16x16x32_bf16 v[172:175], a[156:159], a[196:199], v[172:175]
    ds_read_b64_tr_b16 a[164:165], v38 offset:8200
    v_accvgpr_write_b32 a78, 0
    v_mfma_f32_16x16x32_bf16 v[168:171], a[152:155], a[196:199], v[168:171]
    ds_read_b64_tr_b16 a[166:167], v38 offset:9224
    v_accvgpr_write_b32 a79, 0
    v_mfma_f32_16x16x32_bf16 v[164:167], a[148:151], a[196:199], v[164:167]
    ds_read_b64_tr_b16 a[168:169], v39 offset:8192
    v_accvgpr_write_b32 a80, 0
    v_mfma_f32_16x16x32_bf16 v[160:163], a[144:147], a[196:199], v[160:163]
    ds_read_b64_tr_b16 a[170:171], v39 offset:9216
    v_accvgpr_write_b32 a81, 0
    v_mfma_f32_16x16x32_bf16 v[156:159], a[140:143], a[196:199], v[156:159]
    buffer_load_dwordx4 v32, s[20:23], s28 offen offset:2048 nt lds
    v_mfma_f32_16x16x32_bf16 v[152:155], a[136:139], a[196:199], v[152:155]
    ds_read_b64_tr_b16 a[172:173], v39 offset:8200
    v_accvgpr_write_b32 a82, 0
    v_mfma_f32_16x16x32_bf16 v[148:151], a[132:135], a[196:199], v[148:151]
    ds_read_b64_tr_b16 a[174:175], v39 offset:9224
    v_accvgpr_write_b32 a83, 0
    v_mfma_f32_16x16x32_bf16 v[144:147], a[128:131], a[196:199], v[144:147]
    s_waitcnt lgkmcnt(10)
    ds_read_b64_tr_b16 a[176:177], v40 offset:8192
    v_accvgpr_write_b32 a84, 0
    v_mfma_f32_16x16x32_bf16 v[176:179], a[128:131], a[200:203], v[176:179]
    ds_read_b64_tr_b16 a[178:179], v40 offset:9216
    v_accvgpr_write_b32 a85, 0
    v_mfma_f32_16x16x32_bf16 v[180:183], a[132:135], a[200:203], v[180:183]
    buffer_load_dwordx4 v33, s[20:23], s28 offen offset:3072 nt lds
    v_mfma_f32_16x16x32_bf16 v[184:187], a[136:139], a[200:203], v[184:187]
    ds_read_b64_tr_b16 a[180:181], v40 offset:8200
    v_accvgpr_write_b32 a86, 0
    v_mfma_f32_16x16x32_bf16 v[188:191], a[140:143], a[200:203], v[188:191]
    ds_read_b64_tr_b16 a[182:183], v40 offset:9224
    v_accvgpr_write_b32 a87, 0
    v_mfma_f32_16x16x32_bf16 v[192:195], a[144:147], a[200:203], v[192:195]
    ds_read_b64_tr_b16 a[184:185], v41 offset:8192
    v_accvgpr_write_b32 a88, 0
    v_mfma_f32_16x16x32_bf16 v[196:199], a[148:151], a[200:203], v[196:199]
    ds_read_b64_tr_b16 a[186:187], v41 offset:9216
    v_accvgpr_write_b32 a89, 0
    v_mfma_f32_16x16x32_bf16 v[200:203], a[152:155], a[200:203], v[200:203]
    ds_read_b64_tr_b16 a[188:189], v41 offset:8200
    v_accvgpr_write_b32 a90, 0
    v_mfma_f32_16x16x32_bf16 v[204:207], a[156:159], a[200:203], v[204:207]
    ds_read_b64_tr_b16 a[190:191], v41 offset:9224
    v_accvgpr_write_b32 a91, 0
    v_mfma_f32_16x16x32_bf16 v[236:239], a[156:159], a[204:207], v[236:239]
    v_mfma_f32_16x16x32_bf16 v[232:235], a[152:155], a[204:207], v[232:235]
    v_mfma_f32_16x16x32_bf16 v[228:231], a[148:151], a[204:207], v[228:231]
    v_mfma_f32_16x16x32_bf16 v[224:227], a[144:147], a[204:207], v[224:227]
    v_mfma_f32_16x16x32_bf16 v[220:223], a[140:143], a[204:207], v[220:223]
    v_mfma_f32_16x16x32_bf16 v[216:219], a[136:139], a[204:207], v[216:219]
    v_mfma_f32_16x16x32_bf16 v[212:215], a[132:135], a[204:207], v[212:215]
    v_mfma_f32_16x16x32_bf16 v[208:211], a[128:131], a[204:207], v[208:211]
    s_waitcnt lgkmcnt(0)
    s_barrier
    v_mfma_f32_16x16x32_bf16 v[112:115], a[160:163], a[208:211], v[112:115]
    s_mov_b32 m0, 69632
    ds_read_b128 a[224:227], v44 offset:0
    v_mfma_f32_16x16x32_bf16 v[116:119], a[164:167], a[208:211], v[116:119]
    s_mov_b32 s28, 4096
    ds_read_b128 a[228:231], v44 offset:2048
    v_mfma_f32_16x16x32_bf16 v[120:123], a[168:171], a[208:211], v[120:123]
    buffer_load_dwordx4 v32, s[20:23], s28 offen offset:0 nt lds
    v_mfma_f32_16x16x32_bf16 v[124:127], a[172:175], a[208:211], v[124:127]
    ds_read_b128 a[240:243], v45 offset:0
    v_accvgpr_write_b32 a92, 0
    v_mfma_f32_16x16x32_bf16 v[128:131], a[176:179], a[208:211], v[128:131]
    ds_read_b128 a[244:247], v45 offset:2048
    v_accvgpr_write_b32 a93, 0
    v_mfma_f32_16x16x32_bf16 v[132:135], a[180:183], a[208:211], v[132:135]
    ds_read_b64_tr_b16 a[128:129], v38 offset:16384
    v_accvgpr_write_b32 a94, 0
    v_mfma_f32_16x16x32_bf16 v[136:139], a[184:187], a[208:211], v[136:139]
    ds_read_b64_tr_b16 a[130:131], v38 offset:17408
    v_accvgpr_write_b32 a95, 0
    v_mfma_f32_16x16x32_bf16 v[140:143], a[188:191], a[208:211], v[140:143]
    buffer_load_dwordx4 v33, s[20:23], s28 offen offset:1024 nt lds
    v_mfma_f32_16x16x32_bf16 v[172:175], a[188:191], a[212:215], v[172:175]
    ds_read_b64_tr_b16 a[132:133], v38 offset:16392
    v_accvgpr_write_b32 a96, 0
    v_mfma_f32_16x16x32_bf16 v[168:171], a[184:187], a[212:215], v[168:171]
    ds_read_b64_tr_b16 a[134:135], v38 offset:17416
    v_accvgpr_write_b32 a97, 0
    v_mfma_f32_16x16x32_bf16 v[164:167], a[180:183], a[212:215], v[164:167]
    ds_read_b64_tr_b16 a[136:137], v39 offset:16384
    v_accvgpr_write_b32 a98, 0
    v_mfma_f32_16x16x32_bf16 v[160:163], a[176:179], a[212:215], v[160:163]
    ds_read_b64_tr_b16 a[138:139], v39 offset:17408
    v_accvgpr_write_b32 a99, 0
    v_mfma_f32_16x16x32_bf16 v[156:159], a[172:175], a[212:215], v[156:159]
    buffer_load_dwordx4 v32, s[20:23], s28 offen offset:2048 nt lds
    v_mfma_f32_16x16x32_bf16 v[152:155], a[168:171], a[212:215], v[152:155]
    ds_read_b64_tr_b16 a[140:141], v39 offset:16392
    v_accvgpr_write_b32 a100, 0
    v_mfma_f32_16x16x32_bf16 v[148:151], a[164:167], a[212:215], v[148:151]
    ds_read_b64_tr_b16 a[142:143], v39 offset:17416
    v_accvgpr_write_b32 a101, 0
    v_mfma_f32_16x16x32_bf16 v[144:147], a[160:163], a[212:215], v[144:147]
    ds_read_b64_tr_b16 a[144:145], v40 offset:16384
    v_accvgpr_write_b32 a102, 0
    v_mfma_f32_16x16x32_bf16 v[176:179], a[160:163], a[216:219], v[176:179]
    ds_read_b64_tr_b16 a[146:147], v40 offset:17408
    v_accvgpr_write_b32 a103, 0
    v_mfma_f32_16x16x32_bf16 v[180:183], a[164:167], a[216:219], v[180:183]
    buffer_load_dwordx4 v33, s[20:23], s28 offen offset:3072 nt lds
    v_mfma_f32_16x16x32_bf16 v[184:187], a[168:171], a[216:219], v[184:187]
    ds_read_b64_tr_b16 a[148:149], v40 offset:16392
    v_accvgpr_write_b32 a104, 0
    v_mfma_f32_16x16x32_bf16 v[188:191], a[172:175], a[216:219], v[188:191]
    ds_read_b64_tr_b16 a[150:151], v40 offset:17416
    v_accvgpr_write_b32 a105, 0
    v_mfma_f32_16x16x32_bf16 v[192:195], a[176:179], a[216:219], v[192:195]
    ds_read_b64_tr_b16 a[152:153], v41 offset:16384
    v_accvgpr_write_b32 a106, 0
    v_mfma_f32_16x16x32_bf16 v[196:199], a[180:183], a[216:219], v[196:199]
    ds_read_b64_tr_b16 a[154:155], v41 offset:17408
    v_accvgpr_write_b32 a107, 0
    v_mfma_f32_16x16x32_bf16 v[200:203], a[184:187], a[216:219], v[200:203]
    ds_read_b64_tr_b16 a[156:157], v41 offset:16392
    v_accvgpr_write_b32 a108, 0
    v_mfma_f32_16x16x32_bf16 v[204:207], a[188:191], a[216:219], v[204:207]
    ds_read_b64_tr_b16 a[158:159], v41 offset:17416
    v_accvgpr_write_b32 a109, 0
    v_mfma_f32_16x16x32_bf16 v[236:239], a[188:191], a[220:223], v[236:239]
    v_mfma_f32_16x16x32_bf16 v[232:235], a[184:187], a[220:223], v[232:235]
    v_mfma_f32_16x16x32_bf16 v[228:231], a[180:183], a[220:223], v[228:231]
    v_mfma_f32_16x16x32_bf16 v[224:227], a[176:179], a[220:223], v[224:227]
    v_mfma_f32_16x16x32_bf16 v[220:223], a[172:175], a[220:223], v[220:223]
    v_mfma_f32_16x16x32_bf16 v[216:219], a[168:171], a[220:223], v[216:219]
    v_mfma_f32_16x16x32_bf16 v[212:215], a[164:167], a[220:223], v[212:215]
    v_mfma_f32_16x16x32_bf16 v[208:211], a[160:163], a[220:223], v[208:211]
    s_waitcnt lgkmcnt(0)
    s_barrier
    v_mfma_f32_16x16x32_bf16 v[112:115], a[128:131], a[224:227], v[112:115]
    s_mov_b32 m0, 8192
    ds_read_b128 a[232:235], v44 offset:4096
    v_mfma_f32_16x16x32_bf16 v[116:119], a[132:135], a[224:227], v[116:119]
    s_mov_b32 s28, 8192
    ds_read_b128 a[236:239], v44 offset:6144
    v_mfma_f32_16x16x32_bf16 v[120:123], a[136:139], a[224:227], v[120:123]
    buffer_load_dwordx4 v28, s[16:19], s28 offen offset:0 nt lds
    v_mfma_f32_16x16x32_bf16 v[124:127], a[140:143], a[224:227], v[124:127]
    ds_read_b128 a[248:251], v45 offset:4096
    v_accvgpr_write_b32 a110, 0
    v_mfma_f32_16x16x32_bf16 v[128:131], a[144:147], a[224:227], v[128:131]
    ds_read_b128 a[252:255], v45 offset:6144
    v_accvgpr_write_b32 a111, 0
    v_mfma_f32_16x16x32_bf16 v[132:135], a[148:151], a[224:227], v[132:135]
    ds_read_b64_tr_b16 a[160:161], v38 offset:24576
    v_accvgpr_write_b32 a112, 0
    v_mfma_f32_16x16x32_bf16 v[136:139], a[152:155], a[224:227], v[136:139]
    ds_read_b64_tr_b16 a[162:163], v38 offset:25600
    v_accvgpr_write_b32 a113, 0
    v_mfma_f32_16x16x32_bf16 v[140:143], a[156:159], a[224:227], v[140:143]
    buffer_load_dwordx4 v29, s[16:19], s28 offen offset:1024 nt lds
    v_mfma_f32_16x16x32_bf16 v[172:175], a[156:159], a[228:231], v[172:175]
    ds_read_b64_tr_b16 a[164:165], v38 offset:24584
    v_accvgpr_write_b32 a114, 0
    v_mfma_f32_16x16x32_bf16 v[168:171], a[152:155], a[228:231], v[168:171]
    ds_read_b64_tr_b16 a[166:167], v38 offset:25608
    v_accvgpr_write_b32 a115, 0
    v_mfma_f32_16x16x32_bf16 v[164:167], a[148:151], a[228:231], v[164:167]
    ds_read_b64_tr_b16 a[168:169], v39 offset:24576
    v_accvgpr_write_b32 a116, 0
    v_mfma_f32_16x16x32_bf16 v[160:163], a[144:147], a[228:231], v[160:163]
    ds_read_b64_tr_b16 a[170:171], v39 offset:25600
    v_accvgpr_write_b32 a117, 0
    v_mfma_f32_16x16x32_bf16 v[156:159], a[140:143], a[228:231], v[156:159]
    buffer_load_dwordx4 v30, s[16:19], s28 offen offset:2048 nt lds
    v_mfma_f32_16x16x32_bf16 v[152:155], a[136:139], a[228:231], v[152:155]
    ds_read_b64_tr_b16 a[172:173], v39 offset:24584
    v_accvgpr_write_b32 a118, 0
    v_mfma_f32_16x16x32_bf16 v[148:151], a[132:135], a[228:231], v[148:151]
    ds_read_b64_tr_b16 a[174:175], v39 offset:25608
    v_accvgpr_write_b32 a119, 0
    v_mfma_f32_16x16x32_bf16 v[144:147], a[128:131], a[228:231], v[144:147]
    s_waitcnt lgkmcnt(10)
    ds_read_b64_tr_b16 a[176:177], v40 offset:24576
    v_accvgpr_write_b32 a120, 0
    v_mfma_f32_16x16x32_bf16 v[176:179], a[128:131], a[232:235], v[176:179]
    ds_read_b64_tr_b16 a[178:179], v40 offset:25600
    v_accvgpr_write_b32 a121, 0
    v_mfma_f32_16x16x32_bf16 v[180:183], a[132:135], a[232:235], v[180:183]
    buffer_load_dwordx4 v31, s[16:19], s28 offen offset:3072 nt lds
    v_mfma_f32_16x16x32_bf16 v[184:187], a[136:139], a[232:235], v[184:187]
    ds_read_b64_tr_b16 a[180:181], v40 offset:24584
    v_accvgpr_write_b32 a122, 0
    v_mfma_f32_16x16x32_bf16 v[188:191], a[140:143], a[232:235], v[188:191]
    ds_read_b64_tr_b16 a[182:183], v40 offset:25608
    v_accvgpr_write_b32 a123, 0
    v_mfma_f32_16x16x32_bf16 v[192:195], a[144:147], a[232:235], v[192:195]
    ds_read_b64_tr_b16 a[184:185], v41 offset:24576
    v_accvgpr_write_b32 a124, 0
    v_mfma_f32_16x16x32_bf16 v[196:199], a[148:151], a[232:235], v[196:199]
    ds_read_b64_tr_b16 a[186:187], v41 offset:25600
    v_accvgpr_write_b32 a125, 0
    v_mfma_f32_16x16x32_bf16 v[200:203], a[152:155], a[232:235], v[200:203]
    ds_read_b64_tr_b16 a[188:189], v41 offset:24584
    v_accvgpr_write_b32 a126, 0
    v_mfma_f32_16x16x32_bf16 v[204:207], a[156:159], a[232:235], v[204:207]
    ds_read_b64_tr_b16 a[190:191], v41 offset:25608
    v_accvgpr_write_b32 a127, 0
    v_mfma_f32_16x16x32_bf16 v[236:239], a[156:159], a[236:239], v[236:239]
    v_mfma_f32_16x16x32_bf16 v[232:235], a[152:155], a[236:239], v[232:235]
    v_mfma_f32_16x16x32_bf16 v[228:231], a[148:151], a[236:239], v[228:231]
    v_mfma_f32_16x16x32_bf16 v[224:227], a[144:147], a[236:239], v[224:227]
    v_mfma_f32_16x16x32_bf16 v[220:223], a[140:143], a[236:239], v[220:223]
    v_mfma_f32_16x16x32_bf16 v[216:219], a[136:139], a[236:239], v[216:219]
    v_mfma_f32_16x16x32_bf16 v[212:215], a[132:135], a[236:239], v[212:215]
    v_mfma_f32_16x16x32_bf16 v[208:211], a[128:131], a[236:239], v[208:211]
    s_waitcnt lgkmcnt(0)
    s_barrier
    v_mfma_f32_16x16x32_bf16 v[112:115], a[160:163], a[240:243], v[112:115]
    s_mov_b32 m0, 12288
    ds_read_b128 a[192:195], v42 offset:0
    v_mfma_f32_16x16x32_bf16 v[116:119], a[164:167], a[240:243], v[116:119]
    s_mov_b32 s28, 12288
    ds_read_b128 a[196:199], v42 offset:2048
    v_mfma_f32_16x16x32_bf16 v[120:123], a[168:171], a[240:243], v[120:123]
    buffer_load_dwordx4 v28, s[16:19], s28 offen offset:0 nt lds
    v_mfma_f32_16x16x32_bf16 v[124:127], a[172:175], a[240:243], v[124:127]
    ds_read_b128 a[208:211], v43 offset:0
    v_mfma_f32_16x16x32_bf16 v[128:131], a[176:179], a[240:243], v[128:131]
    ds_read_b128 a[212:215], v43 offset:2048
    v_mfma_f32_16x16x32_bf16 v[132:135], a[180:183], a[240:243], v[132:135]
    ds_read_b64_tr_b16 a[128:129], v38 offset:0
    v_mfma_f32_16x16x32_bf16 v[136:139], a[184:187], a[240:243], v[136:139]
    ds_read_b64_tr_b16 a[130:131], v38 offset:1024
    v_mfma_f32_16x16x32_bf16 v[140:143], a[188:191], a[240:243], v[140:143]
    buffer_load_dwordx4 v29, s[16:19], s28 offen offset:1024 nt lds
    v_mfma_f32_16x16x32_bf16 v[172:175], a[188:191], a[244:247], v[172:175]
    ds_read_b64_tr_b16 a[132:133], v38 offset:8
    v_mfma_f32_16x16x32_bf16 v[168:171], a[184:187], a[244:247], v[168:171]
    ds_read_b64_tr_b16 a[134:135], v38 offset:1032
    v_mfma_f32_16x16x32_bf16 v[164:167], a[180:183], a[244:247], v[164:167]
    ds_read_b64_tr_b16 a[136:137], v39 offset:0
    v_mfma_f32_16x16x32_bf16 v[160:163], a[176:179], a[244:247], v[160:163]
    ds_read_b64_tr_b16 a[138:139], v39 offset:1024
    v_mfma_f32_16x16x32_bf16 v[156:159], a[172:175], a[244:247], v[156:159]
    buffer_load_dwordx4 v30, s[16:19], s28 offen offset:2048 nt lds
    v_mfma_f32_16x16x32_bf16 v[152:155], a[168:171], a[244:247], v[152:155]
    ds_read_b64_tr_b16 a[140:141], v39 offset:8
    v_mfma_f32_16x16x32_bf16 v[148:151], a[164:167], a[244:247], v[148:151]
    ds_read_b64_tr_b16 a[142:143], v39 offset:1032
    v_mfma_f32_16x16x32_bf16 v[144:147], a[160:163], a[244:247], v[144:147]
    ds_read_b64_tr_b16 a[144:145], v40 offset:0
    v_mfma_f32_16x16x32_bf16 v[176:179], a[160:163], a[248:251], v[176:179]
    ds_read_b64_tr_b16 a[146:147], v40 offset:1024
    v_mfma_f32_16x16x32_bf16 v[180:183], a[164:167], a[248:251], v[180:183]
    buffer_load_dwordx4 v31, s[16:19], s28 offen offset:3072 nt lds
    v_mfma_f32_16x16x32_bf16 v[184:187], a[168:171], a[248:251], v[184:187]
    ds_read_b64_tr_b16 a[148:149], v40 offset:8
    v_mfma_f32_16x16x32_bf16 v[188:191], a[172:175], a[248:251], v[188:191]
    ds_read_b64_tr_b16 a[150:151], v40 offset:1032
    v_mfma_f32_16x16x32_bf16 v[192:195], a[176:179], a[248:251], v[192:195]
    ds_read_b64_tr_b16 a[152:153], v41 offset:0
    v_mfma_f32_16x16x32_bf16 v[196:199], a[180:183], a[248:251], v[196:199]
    ds_read_b64_tr_b16 a[154:155], v41 offset:1024
    v_mfma_f32_16x16x32_bf16 v[200:203], a[184:187], a[248:251], v[200:203]
    ds_read_b64_tr_b16 a[156:157], v41 offset:8
    v_mfma_f32_16x16x32_bf16 v[204:207], a[188:191], a[248:251], v[204:207]
    ds_read_b64_tr_b16 a[158:159], v41 offset:1032
    v_mfma_f32_16x16x32_bf16 v[236:239], a[188:191], a[252:255], v[236:239]
    v_mfma_f32_16x16x32_bf16 v[232:235], a[184:187], a[252:255], v[232:235]
    v_mfma_f32_16x16x32_bf16 v[228:231], a[180:183], a[252:255], v[228:231]
    v_mfma_f32_16x16x32_bf16 v[224:227], a[176:179], a[252:255], v[224:227]
    v_mfma_f32_16x16x32_bf16 v[220:223], a[172:175], a[252:255], v[220:223]
    v_mfma_f32_16x16x32_bf16 v[216:219], a[168:171], a[252:255], v[216:219]
    v_mfma_f32_16x16x32_bf16 v[212:215], a[164:167], a[252:255], v[212:215]
    v_mfma_f32_16x16x32_bf16 v[208:211], a[160:163], a[252:255], v[208:211]
    s_waitcnt lgkmcnt(0)
    s_barrier
    v_mfma_f32_16x16x32_bf16 v[112:115], a[128:131], a[192:195], v[112:115]
    s_mov_b32 m0, 73728
    ds_read_b128 a[200:203], v42 offset:4096
    v_mfma_f32_16x16x32_bf16 v[116:119], a[132:135], a[192:195], v[116:119]
    s_mov_b32 s28, 8192
    ds_read_b128 a[204:207], v42 offset:6144
    v_mfma_f32_16x16x32_bf16 v[120:123], a[136:139], a[192:195], v[120:123]
    buffer_load_dwordx4 v32, s[20:23], s28 offen offset:0 nt lds
    v_mfma_f32_16x16x32_bf16 v[124:127], a[140:143], a[192:195], v[124:127]
    ds_read_b128 a[216:219], v43 offset:4096
    v_mfma_f32_16x16x32_bf16 v[128:131], a[144:147], a[192:195], v[128:131]
    ds_read_b128 a[220:223], v43 offset:6144
    v_mfma_f32_16x16x32_bf16 v[132:135], a[148:151], a[192:195], v[132:135]
    ds_read_b64_tr_b16 a[160:161], v38 offset:8192
    v_mfma_f32_16x16x32_bf16 v[136:139], a[152:155], a[192:195], v[136:139]
    ds_read_b64_tr_b16 a[162:163], v38 offset:9216
    v_mfma_f32_16x16x32_bf16 v[140:143], a[156:159], a[192:195], v[140:143]
    buffer_load_dwordx4 v33, s[20:23], s28 offen offset:1024 nt lds
    v_mfma_f32_16x16x32_bf16 v[172:175], a[156:159], a[196:199], v[172:175]
    ds_read_b64_tr_b16 a[164:165], v38 offset:8200
    v_mfma_f32_16x16x32_bf16 v[168:171], a[152:155], a[196:199], v[168:171]
    ds_read_b64_tr_b16 a[166:167], v38 offset:9224
    v_mfma_f32_16x16x32_bf16 v[164:167], a[148:151], a[196:199], v[164:167]
    ds_read_b64_tr_b16 a[168:169], v39 offset:8192
    v_mfma_f32_16x16x32_bf16 v[160:163], a[144:147], a[196:199], v[160:163]
    ds_read_b64_tr_b16 a[170:171], v39 offset:9216
    v_mfma_f32_16x16x32_bf16 v[156:159], a[140:143], a[196:199], v[156:159]
    buffer_load_dwordx4 v32, s[20:23], s28 offen offset:2048 nt lds
    v_mfma_f32_16x16x32_bf16 v[152:155], a[136:139], a[196:199], v[152:155]
    ds_read_b64_tr_b16 a[172:173], v39 offset:8200
    v_mfma_f32_16x16x32_bf16 v[148:151], a[132:135], a[196:199], v[148:151]
    ds_read_b64_tr_b16 a[174:175], v39 offset:9224
    v_mfma_f32_16x16x32_bf16 v[144:147], a[128:131], a[196:199], v[144:147]
    s_waitcnt lgkmcnt(10)
    ds_read_b64_tr_b16 a[176:177], v40 offset:8192
    v_mfma_f32_16x16x32_bf16 v[176:179], a[128:131], a[200:203], v[176:179]
    ds_read_b64_tr_b16 a[178:179], v40 offset:9216
    v_mfma_f32_16x16x32_bf16 v[180:183], a[132:135], a[200:203], v[180:183]
    buffer_load_dwordx4 v33, s[20:23], s28 offen offset:3072 nt lds
    v_mfma_f32_16x16x32_bf16 v[184:187], a[136:139], a[200:203], v[184:187]
    ds_read_b64_tr_b16 a[180:181], v40 offset:8200
    v_mfma_f32_16x16x32_bf16 v[188:191], a[140:143], a[200:203], v[188:191]
    ds_read_b64_tr_b16 a[182:183], v40 offset:9224
    v_mfma_f32_16x16x32_bf16 v[192:195], a[144:147], a[200:203], v[192:195]
    ds_read_b64_tr_b16 a[184:185], v41 offset:8192
    v_mfma_f32_16x16x32_bf16 v[196:199], a[148:151], a[200:203], v[196:199]
    ds_read_b64_tr_b16 a[186:187], v41 offset:9216
    v_mfma_f32_16x16x32_bf16 v[200:203], a[152:155], a[200:203], v[200:203]
    ds_read_b64_tr_b16 a[188:189], v41 offset:8200
    v_mfma_f32_16x16x32_bf16 v[204:207], a[156:159], a[200:203], v[204:207]
    ds_read_b64_tr_b16 a[190:191], v41 offset:9224
    v_mfma_f32_16x16x32_bf16 v[236:239], a[156:159], a[204:207], v[236:239]
    v_mfma_f32_16x16x32_bf16 v[232:235], a[152:155], a[204:207], v[232:235]
    v_mfma_f32_16x16x32_bf16 v[228:231], a[148:151], a[204:207], v[228:231]
    v_mfma_f32_16x16x32_bf16 v[224:227], a[144:147], a[204:207], v[224:227]
    v_mfma_f32_16x16x32_bf16 v[220:223], a[140:143], a[204:207], v[220:223]
    v_mfma_f32_16x16x32_bf16 v[216:219], a[136:139], a[204:207], v[216:219]
    v_mfma_f32_16x16x32_bf16 v[212:215], a[132:135], a[204:207], v[212:215]
    v_mfma_f32_16x16x32_bf16 v[208:211], a[128:131], a[204:207], v[208:211]
    s_waitcnt lgkmcnt(0)
    s_barrier
    v_mfma_f32_16x16x32_bf16 v[112:115], a[160:163], a[208:211], v[112:115]
    s_mov_b32 m0, 77824
    ds_read_b128 a[224:227], v44 offset:0
    v_mfma_f32_16x16x32_bf16 v[116:119], a[164:167], a[208:211], v[116:119]
    s_mov_b32 s28, 12288
    ds_read_b128 a[228:231], v44 offset:2048
    v_mfma_f32_16x16x32_bf16 v[120:123], a[168:171], a[208:211], v[120:123]
    buffer_load_dwordx4 v32, s[20:23], s28 offen offset:0 nt lds
    v_mfma_f32_16x16x32_bf16 v[124:127], a[172:175], a[208:211], v[124:127]
    ds_read_b128 a[240:243], v45 offset:0
    v_mfma_f32_16x16x32_bf16 v[128:131], a[176:179], a[208:211], v[128:131]
    ds_read_b128 a[244:247], v45 offset:2048
    v_mfma_f32_16x16x32_bf16 v[132:135], a[180:183], a[208:211], v[132:135]
    ds_read_b64_tr_b16 a[128:129], v38 offset:16384
    v_mfma_f32_16x16x32_bf16 v[136:139], a[184:187], a[208:211], v[136:139]
    ds_read_b64_tr_b16 a[130:131], v38 offset:17408
    v_mfma_f32_16x16x32_bf16 v[140:143], a[188:191], a[208:211], v[140:143]
    buffer_load_dwordx4 v33, s[20:23], s28 offen offset:1024 nt lds
    v_mfma_f32_16x16x32_bf16 v[172:175], a[188:191], a[212:215], v[172:175]
    ds_read_b64_tr_b16 a[132:133], v38 offset:16392
    v_mfma_f32_16x16x32_bf16 v[168:171], a[184:187], a[212:215], v[168:171]
    ds_read_b64_tr_b16 a[134:135], v38 offset:17416
    v_mfma_f32_16x16x32_bf16 v[164:167], a[180:183], a[212:215], v[164:167]
    ds_read_b64_tr_b16 a[136:137], v39 offset:16384
    v_mfma_f32_16x16x32_bf16 v[160:163], a[176:179], a[212:215], v[160:163]
    ds_read_b64_tr_b16 a[138:139], v39 offset:17408
    v_mfma_f32_16x16x32_bf16 v[156:159], a[172:175], a[212:215], v[156:159]
    buffer_load_dwordx4 v32, s[20:23], s28 offen offset:2048 nt lds
    v_mfma_f32_16x16x32_bf16 v[152:155], a[168:171], a[212:215], v[152:155]
    ds_read_b64_tr_b16 a[140:141], v39 offset:16392
    v_mfma_f32_16x16x32_bf16 v[148:151], a[164:167], a[212:215], v[148:151]
    ds_read_b64_tr_b16 a[142:143], v39 offset:17416
    v_mfma_f32_16x16x32_bf16 v[144:147], a[160:163], a[212:215], v[144:147]
    ds_read_b64_tr_b16 a[144:145], v40 offset:16384
    v_mfma_f32_16x16x32_bf16 v[176:179], a[160:163], a[216:219], v[176:179]
    ds_read_b64_tr_b16 a[146:147], v40 offset:17408
    v_mfma_f32_16x16x32_bf16 v[180:183], a[164:167], a[216:219], v[180:183]
    buffer_load_dwordx4 v33, s[20:23], s28 offen offset:3072 nt lds
    v_mfma_f32_16x16x32_bf16 v[184:187], a[168:171], a[216:219], v[184:187]
    ds_read_b64_tr_b16 a[148:149], v40 offset:16392
    v_mfma_f32_16x16x32_bf16 v[188:191], a[172:175], a[216:219], v[188:191]
    ds_read_b64_tr_b16 a[150:151], v40 offset:17416
    v_mfma_f32_16x16x32_bf16 v[192:195], a[176:179], a[216:219], v[192:195]
    ds_read_b64_tr_b16 a[152:153], v41 offset:16384
    v_mfma_f32_16x16x32_bf16 v[196:199], a[180:183], a[216:219], v[196:199]
    ds_read_b64_tr_b16 a[154:155], v41 offset:17408
    v_mfma_f32_16x16x32_bf16 v[200:203], a[184:187], a[216:219], v[200:203]
    ds_read_b64_tr_b16 a[156:157], v41 offset:16392
    v_mfma_f32_16x16x32_bf16 v[204:207], a[188:191], a[216:219], v[204:207]
    ds_read_b64_tr_b16 a[158:159], v41 offset:17416
    v_mfma_f32_16x16x32_bf16 v[236:239], a[188:191], a[220:223], v[236:239]
    v_mfma_f32_16x16x32_bf16 v[232:235], a[184:187], a[220:223], v[232:235]
    v_mfma_f32_16x16x32_bf16 v[228:231], a[180:183], a[220:223], v[228:231]
    v_mfma_f32_16x16x32_bf16 v[224:227], a[176:179], a[220:223], v[224:227]
    v_mfma_f32_16x16x32_bf16 v[220:223], a[172:175], a[220:223], v[220:223]
    v_mfma_f32_16x16x32_bf16 v[216:219], a[168:171], a[220:223], v[216:219]
    v_mfma_f32_16x16x32_bf16 v[212:215], a[164:167], a[220:223], v[212:215]
    v_mfma_f32_16x16x32_bf16 v[208:211], a[160:163], a[220:223], v[208:211]
    s_waitcnt lgkmcnt(0)
    s_waitcnt vmcnt(44)
    s_barrier
    v_mfma_f32_16x16x32_bf16 v[112:115], a[128:131], a[224:227], v[112:115]
    s_mov_b32 m0, 16384
    ds_read_b128 a[232:235], v44 offset:4096
    v_mfma_f32_16x16x32_bf16 v[116:119], a[132:135], a[224:227], v[116:119]
    s_mov_b32 s28, 16384
    ds_read_b128 a[236:239], v44 offset:6144
    v_mfma_f32_16x16x32_bf16 v[120:123], a[136:139], a[224:227], v[120:123]
    buffer_load_dwordx4 v28, s[16:19], s28 offen offset:0 nt lds
    v_mfma_f32_16x16x32_bf16 v[124:127], a[140:143], a[224:227], v[124:127]
    ds_read_b128 a[248:251], v45 offset:4096
    v_mfma_f32_16x16x32_bf16 v[128:131], a[144:147], a[224:227], v[128:131]
    ds_read_b128 a[252:255], v45 offset:6144
    v_mfma_f32_16x16x32_bf16 v[132:135], a[148:151], a[224:227], v[132:135]
    ds_read_b64_tr_b16 a[160:161], v38 offset:24576
    v_mfma_f32_16x16x32_bf16 v[136:139], a[152:155], a[224:227], v[136:139]
    ds_read_b64_tr_b16 a[162:163], v38 offset:25600
    v_mfma_f32_16x16x32_bf16 v[140:143], a[156:159], a[224:227], v[140:143]
    buffer_load_dwordx4 v29, s[16:19], s28 offen offset:1024 nt lds
    v_mfma_f32_16x16x32_bf16 v[172:175], a[156:159], a[228:231], v[172:175]
    ds_read_b64_tr_b16 a[164:165], v38 offset:24584
    v_mfma_f32_16x16x32_bf16 v[168:171], a[152:155], a[228:231], v[168:171]
    ds_read_b64_tr_b16 a[166:167], v38 offset:25608
    v_mfma_f32_16x16x32_bf16 v[164:167], a[148:151], a[228:231], v[164:167]
    ds_read_b64_tr_b16 a[168:169], v39 offset:24576
    v_mfma_f32_16x16x32_bf16 v[160:163], a[144:147], a[228:231], v[160:163]
    ds_read_b64_tr_b16 a[170:171], v39 offset:25600
    v_mfma_f32_16x16x32_bf16 v[156:159], a[140:143], a[228:231], v[156:159]
    buffer_load_dwordx4 v30, s[16:19], s28 offen offset:2048 nt lds
    v_mfma_f32_16x16x32_bf16 v[152:155], a[136:139], a[228:231], v[152:155]
    ds_read_b64_tr_b16 a[172:173], v39 offset:24584
    v_mfma_f32_16x16x32_bf16 v[148:151], a[132:135], a[228:231], v[148:151]
    ds_read_b64_tr_b16 a[174:175], v39 offset:25608
    v_mfma_f32_16x16x32_bf16 v[144:147], a[128:131], a[228:231], v[144:147]
    s_waitcnt lgkmcnt(10)
    ds_read_b64_tr_b16 a[176:177], v40 offset:24576
    v_mfma_f32_16x16x32_bf16 v[176:179], a[128:131], a[232:235], v[176:179]
    ds_read_b64_tr_b16 a[178:179], v40 offset:25600
    v_mfma_f32_16x16x32_bf16 v[180:183], a[132:135], a[232:235], v[180:183]
    buffer_load_dwordx4 v31, s[16:19], s28 offen offset:3072 nt lds
    v_mfma_f32_16x16x32_bf16 v[184:187], a[136:139], a[232:235], v[184:187]
    ds_read_b64_tr_b16 a[180:181], v40 offset:24584
    v_mfma_f32_16x16x32_bf16 v[188:191], a[140:143], a[232:235], v[188:191]
    ds_read_b64_tr_b16 a[182:183], v40 offset:25608
    v_mfma_f32_16x16x32_bf16 v[192:195], a[144:147], a[232:235], v[192:195]
    ds_read_b64_tr_b16 a[184:185], v41 offset:24576
    v_mfma_f32_16x16x32_bf16 v[196:199], a[148:151], a[232:235], v[196:199]
    ds_read_b64_tr_b16 a[186:187], v41 offset:25600
    v_mfma_f32_16x16x32_bf16 v[200:203], a[152:155], a[232:235], v[200:203]
    ds_read_b64_tr_b16 a[188:189], v41 offset:24584
    v_mfma_f32_16x16x32_bf16 v[204:207], a[156:159], a[232:235], v[204:207]
    ds_read_b64_tr_b16 a[190:191], v41 offset:25608
    v_mfma_f32_16x16x32_bf16 v[236:239], a[156:159], a[236:239], v[236:239]
    v_mfma_f32_16x16x32_bf16 v[232:235], a[152:155], a[236:239], v[232:235]
    v_mfma_f32_16x16x32_bf16 v[228:231], a[148:151], a[236:239], v[228:231]
    v_mfma_f32_16x16x32_bf16 v[224:227], a[144:147], a[236:239], v[224:227]
    v_mfma_f32_16x16x32_bf16 v[220:223], a[140:143], a[236:239], v[220:223]
    v_mfma_f32_16x16x32_bf16 v[216:219], a[136:139], a[236:239], v[216:219]
    v_mfma_f32_16x16x32_bf16 v[212:215], a[132:135], a[236:239], v[212:215]
    v_mfma_f32_16x16x32_bf16 v[208:211], a[128:131], a[236:239], v[208:211]
    s_waitcnt lgkmcnt(0)
    s_waitcnt vmcnt(44)
    s_barrier
    v_mfma_f32_16x16x32_bf16 v[112:115], a[160:163], a[240:243], v[112:115]
    s_mov_b32 m0, 20480
    ds_read_b128 a[192:195], v42 offset:0
    v_mfma_f32_16x16x32_bf16 v[116:119], a[164:167], a[240:243], v[116:119]
    s_mov_b32 s28, 20480
    ds_read_b128 a[196:199], v42 offset:2048
    v_mfma_f32_16x16x32_bf16 v[120:123], a[168:171], a[240:243], v[120:123]
    buffer_load_dwordx4 v28, s[16:19], s28 offen offset:0 nt lds
    v_mfma_f32_16x16x32_bf16 v[124:127], a[172:175], a[240:243], v[124:127]
    ds_read_b128 a[208:211], v43 offset:0
    v_mfma_f32_16x16x32_bf16 v[128:131], a[176:179], a[240:243], v[128:131]
    ds_read_b128 a[212:215], v43 offset:2048
    v_mfma_f32_16x16x32_bf16 v[132:135], a[180:183], a[240:243], v[132:135]
    ds_read_b64_tr_b16 a[128:129], v38 offset:0
    v_mfma_f32_16x16x32_bf16 v[136:139], a[184:187], a[240:243], v[136:139]
    ds_read_b64_tr_b16 a[130:131], v38 offset:1024
    v_mfma_f32_16x16x32_bf16 v[140:143], a[188:191], a[240:243], v[140:143]
    buffer_load_dwordx4 v29, s[16:19], s28 offen offset:1024 nt lds
    v_mfma_f32_16x16x32_bf16 v[172:175], a[188:191], a[244:247], v[172:175]
    ds_read_b64_tr_b16 a[132:133], v38 offset:8
    v_mfma_f32_16x16x32_bf16 v[168:171], a[184:187], a[244:247], v[168:171]
    ds_read_b64_tr_b16 a[134:135], v38 offset:1032
    v_mfma_f32_16x16x32_bf16 v[164:167], a[180:183], a[244:247], v[164:167]
    ds_read_b64_tr_b16 a[136:137], v39 offset:0
    v_mfma_f32_16x16x32_bf16 v[160:163], a[176:179], a[244:247], v[160:163]
    ds_read_b64_tr_b16 a[138:139], v39 offset:1024
    v_mfma_f32_16x16x32_bf16 v[156:159], a[172:175], a[244:247], v[156:159]
    buffer_load_dwordx4 v30, s[16:19], s28 offen offset:2048 nt lds
    v_mfma_f32_16x16x32_bf16 v[152:155], a[168:171], a[244:247], v[152:155]
    ds_read_b64_tr_b16 a[140:141], v39 offset:8
    v_mfma_f32_16x16x32_bf16 v[148:151], a[164:167], a[244:247], v[148:151]
    ds_read_b64_tr_b16 a[142:143], v39 offset:1032
    v_mfma_f32_16x16x32_bf16 v[144:147], a[160:163], a[244:247], v[144:147]
    ds_read_b64_tr_b16 a[144:145], v40 offset:0
    v_mfma_f32_16x16x32_bf16 v[176:179], a[160:163], a[248:251], v[176:179]
    ds_read_b64_tr_b16 a[146:147], v40 offset:1024
    v_mfma_f32_16x16x32_bf16 v[180:183], a[164:167], a[248:251], v[180:183]
    buffer_load_dwordx4 v31, s[16:19], s28 offen offset:3072 nt lds
    v_mfma_f32_16x16x32_bf16 v[184:187], a[168:171], a[248:251], v[184:187]
    ds_read_b64_tr_b16 a[148:149], v40 offset:8
    v_mfma_f32_16x16x32_bf16 v[188:191], a[172:175], a[248:251], v[188:191]
    ds_read_b64_tr_b16 a[150:151], v40 offset:1032
    v_mfma_f32_16x16x32_bf16 v[192:195], a[176:179], a[248:251], v[192:195]
    ds_read_b64_tr_b16 a[152:153], v41 offset:0
    v_mfma_f32_16x16x32_bf16 v[196:199], a[180:183], a[248:251], v[196:199]
    ds_read_b64_tr_b16 a[154:155], v41 offset:1024
    v_mfma_f32_16x16x32_bf16 v[200:203], a[184:187], a[248:251], v[200:203]
    ds_read_b64_tr_b16 a[156:157], v41 offset:8
    v_mfma_f32_16x16x32_bf16 v[204:207], a[188:191], a[248:251], v[204:207]
    ds_read_b64_tr_b16 a[158:159], v41 offset:1032
    v_mfma_f32_16x16x32_bf16 v[236:239], a[188:191], a[252:255], v[236:239]
    v_mfma_f32_16x16x32_bf16 v[232:235], a[184:187], a[252:255], v[232:235]
    v_mfma_f32_16x16x32_bf16 v[228:231], a[180:183], a[252:255], v[228:231]
    v_mfma_f32_16x16x32_bf16 v[224:227], a[176:179], a[252:255], v[224:227]
    v_mfma_f32_16x16x32_bf16 v[220:223], a[172:175], a[252:255], v[220:223]
    v_mfma_f32_16x16x32_bf16 v[216:219], a[168:171], a[252:255], v[216:219]
    v_mfma_f32_16x16x32_bf16 v[212:215], a[164:167], a[252:255], v[212:215]
    v_mfma_f32_16x16x32_bf16 v[208:211], a[160:163], a[252:255], v[208:211]
    s_waitcnt lgkmcnt(0)
    s_waitcnt vmcnt(44)
    s_barrier
    v_mfma_f32_16x16x32_bf16 v[112:115], a[128:131], a[192:195], v[112:115]
    s_mov_b32 m0, 24576
    ds_read_b128 a[200:203], v42 offset:4096
    v_mfma_f32_16x16x32_bf16 v[116:119], a[132:135], a[192:195], v[116:119]
    s_mov_b32 s28, 24576
    ds_read_b128 a[204:207], v42 offset:6144
    v_mfma_f32_16x16x32_bf16 v[120:123], a[136:139], a[192:195], v[120:123]
    buffer_load_dwordx4 v28, s[16:19], s28 offen offset:0 nt lds
    v_mfma_f32_16x16x32_bf16 v[124:127], a[140:143], a[192:195], v[124:127]
    ds_read_b128 a[216:219], v43 offset:4096
    v_mfma_f32_16x16x32_bf16 v[128:131], a[144:147], a[192:195], v[128:131]
    ds_read_b128 a[220:223], v43 offset:6144
    v_mfma_f32_16x16x32_bf16 v[132:135], a[148:151], a[192:195], v[132:135]
    ds_read_b64_tr_b16 a[160:161], v38 offset:8192
    v_mfma_f32_16x16x32_bf16 v[136:139], a[152:155], a[192:195], v[136:139]
    ds_read_b64_tr_b16 a[162:163], v38 offset:9216
    v_mfma_f32_16x16x32_bf16 v[140:143], a[156:159], a[192:195], v[140:143]
    buffer_load_dwordx4 v29, s[16:19], s28 offen offset:1024 nt lds
    v_mfma_f32_16x16x32_bf16 v[172:175], a[156:159], a[196:199], v[172:175]
    ds_read_b64_tr_b16 a[164:165], v38 offset:8200
    v_mfma_f32_16x16x32_bf16 v[168:171], a[152:155], a[196:199], v[168:171]
    ds_read_b64_tr_b16 a[166:167], v38 offset:9224
    v_mfma_f32_16x16x32_bf16 v[164:167], a[148:151], a[196:199], v[164:167]
    ds_read_b64_tr_b16 a[168:169], v39 offset:8192
    v_mfma_f32_16x16x32_bf16 v[160:163], a[144:147], a[196:199], v[160:163]
    ds_read_b64_tr_b16 a[170:171], v39 offset:9216
    v_mfma_f32_16x16x32_bf16 v[156:159], a[140:143], a[196:199], v[156:159]
    buffer_load_dwordx4 v30, s[16:19], s28 offen offset:2048 nt lds
    v_mfma_f32_16x16x32_bf16 v[152:155], a[136:139], a[196:199], v[152:155]
    ds_read_b64_tr_b16 a[172:173], v39 offset:8200
    v_mfma_f32_16x16x32_bf16 v[148:151], a[132:135], a[196:199], v[148:151]
    ds_read_b64_tr_b16 a[174:175], v39 offset:9224
    v_mfma_f32_16x16x32_bf16 v[144:147], a[128:131], a[196:199], v[144:147]
    s_waitcnt lgkmcnt(10)
    ds_read_b64_tr_b16 a[176:177], v40 offset:8192
    v_mfma_f32_16x16x32_bf16 v[176:179], a[128:131], a[200:203], v[176:179]
    ds_read_b64_tr_b16 a[178:179], v40 offset:9216
    v_mfma_f32_16x16x32_bf16 v[180:183], a[132:135], a[200:203], v[180:183]
    buffer_load_dwordx4 v31, s[16:19], s28 offen offset:3072 nt lds
    v_mfma_f32_16x16x32_bf16 v[184:187], a[136:139], a[200:203], v[184:187]
    ds_read_b64_tr_b16 a[180:181], v40 offset:8200
    v_mfma_f32_16x16x32_bf16 v[188:191], a[140:143], a[200:203], v[188:191]
    ds_read_b64_tr_b16 a[182:183], v40 offset:9224
    v_mfma_f32_16x16x32_bf16 v[192:195], a[144:147], a[200:203], v[192:195]
    ds_read_b64_tr_b16 a[184:185], v41 offset:8192
    v_mfma_f32_16x16x32_bf16 v[196:199], a[148:151], a[200:203], v[196:199]
    ds_read_b64_tr_b16 a[186:187], v41 offset:9216
    v_mfma_f32_16x16x32_bf16 v[200:203], a[152:155], a[200:203], v[200:203]
    ds_read_b64_tr_b16 a[188:189], v41 offset:8200
    v_mfma_f32_16x16x32_bf16 v[204:207], a[156:159], a[200:203], v[204:207]
    ds_read_b64_tr_b16 a[190:191], v41 offset:9224
    v_mfma_f32_16x16x32_bf16 v[236:239], a[156:159], a[204:207], v[236:239]
    v_mfma_f32_16x16x32_bf16 v[232:235], a[152:155], a[204:207], v[232:235]
    v_mfma_f32_16x16x32_bf16 v[228:231], a[148:151], a[204:207], v[228:231]
    v_mfma_f32_16x16x32_bf16 v[224:227], a[144:147], a[204:207], v[224:227]
    v_mfma_f32_16x16x32_bf16 v[220:223], a[140:143], a[204:207], v[220:223]
    v_mfma_f32_16x16x32_bf16 v[216:219], a[136:139], a[204:207], v[216:219]
    v_mfma_f32_16x16x32_bf16 v[212:215], a[132:135], a[204:207], v[212:215]
    v_mfma_f32_16x16x32_bf16 v[208:211], a[128:131], a[204:207], v[208:211]
    s_waitcnt lgkmcnt(0)
    s_waitcnt vmcnt(44)
    s_barrier
    v_mfma_f32_16x16x32_bf16 v[112:115], a[160:163], a[208:211], v[112:115]
    s_mov_b32 m0, 28672
    ds_read_b128 a[224:227], v44 offset:0
    v_mfma_f32_16x16x32_bf16 v[116:119], a[164:167], a[208:211], v[116:119]
    s_mov_b32 s28, 28672
    ds_read_b128 a[228:231], v44 offset:2048
    v_mfma_f32_16x16x32_bf16 v[120:123], a[168:171], a[208:211], v[120:123]
    buffer_load_dwordx4 v28, s[16:19], s28 offen offset:0 nt lds
    v_mfma_f32_16x16x32_bf16 v[124:127], a[172:175], a[208:211], v[124:127]
    ds_read_b128 a[240:243], v45 offset:0
    v_mfma_f32_16x16x32_bf16 v[128:131], a[176:179], a[208:211], v[128:131]
    ds_read_b128 a[244:247], v45 offset:2048
    v_mfma_f32_16x16x32_bf16 v[132:135], a[180:183], a[208:211], v[132:135]
    ds_read_b64_tr_b16 a[128:129], v38 offset:16384
    v_mfma_f32_16x16x32_bf16 v[136:139], a[184:187], a[208:211], v[136:139]
    ds_read_b64_tr_b16 a[130:131], v38 offset:17408
    v_mfma_f32_16x16x32_bf16 v[140:143], a[188:191], a[208:211], v[140:143]
    buffer_load_dwordx4 v29, s[16:19], s28 offen offset:1024 nt lds
    v_mfma_f32_16x16x32_bf16 v[172:175], a[188:191], a[212:215], v[172:175]
    ds_read_b64_tr_b16 a[132:133], v38 offset:16392
    v_mfma_f32_16x16x32_bf16 v[168:171], a[184:187], a[212:215], v[168:171]
    ds_read_b64_tr_b16 a[134:135], v38 offset:17416
    v_mfma_f32_16x16x32_bf16 v[164:167], a[180:183], a[212:215], v[164:167]
    ds_read_b64_tr_b16 a[136:137], v39 offset:16384
    v_mfma_f32_16x16x32_bf16 v[160:163], a[176:179], a[212:215], v[160:163]
    ds_read_b64_tr_b16 a[138:139], v39 offset:17408
    v_mfma_f32_16x16x32_bf16 v[156:159], a[172:175], a[212:215], v[156:159]
    buffer_load_dwordx4 v30, s[16:19], s28 offen offset:2048 nt lds
    v_mfma_f32_16x16x32_bf16 v[152:155], a[168:171], a[212:215], v[152:155]
    ds_read_b64_tr_b16 a[140:141], v39 offset:16392
    v_mfma_f32_16x16x32_bf16 v[148:151], a[164:167], a[212:215], v[148:151]
    ds_read_b64_tr_b16 a[142:143], v39 offset:17416
    v_mfma_f32_16x16x32_bf16 v[144:147], a[160:163], a[212:215], v[144:147]
    ds_read_b64_tr_b16 a[144:145], v40 offset:16384
    v_mfma_f32_16x16x32_bf16 v[176:179], a[160:163], a[216:219], v[176:179]
    ds_read_b64_tr_b16 a[146:147], v40 offset:17408
    v_mfma_f32_16x16x32_bf16 v[180:183], a[164:167], a[216:219], v[180:183]
    buffer_load_dwordx4 v31, s[16:19], s28 offen offset:3072 nt lds
    v_mfma_f32_16x16x32_bf16 v[184:187], a[168:171], a[216:219], v[184:187]
    ds_read_b64_tr_b16 a[148:149], v40 offset:16392
    v_mfma_f32_16x16x32_bf16 v[188:191], a[172:175], a[216:219], v[188:191]
    ds_read_b64_tr_b16 a[150:151], v40 offset:17416
    v_mfma_f32_16x16x32_bf16 v[192:195], a[176:179], a[216:219], v[192:195]
    ds_read_b64_tr_b16 a[152:153], v41 offset:16384
    v_mfma_f32_16x16x32_bf16 v[196:199], a[180:183], a[216:219], v[196:199]
    ds_read_b64_tr_b16 a[154:155], v41 offset:17408
    v_mfma_f32_16x16x32_bf16 v[200:203], a[184:187], a[216:219], v[200:203]
    ds_read_b64_tr_b16 a[156:157], v41 offset:16392
    v_mfma_f32_16x16x32_bf16 v[204:207], a[188:191], a[216:219], v[204:207]
    ds_read_b64_tr_b16 a[158:159], v41 offset:17416
    v_mfma_f32_16x16x32_bf16 v[236:239], a[188:191], a[220:223], v[236:239]
    v_mfma_f32_16x16x32_bf16 v[232:235], a[184:187], a[220:223], v[232:235]
    v_mfma_f32_16x16x32_bf16 v[228:231], a[180:183], a[220:223], v[228:231]
    v_mfma_f32_16x16x32_bf16 v[224:227], a[176:179], a[220:223], v[224:227]
    v_mfma_f32_16x16x32_bf16 v[220:223], a[172:175], a[220:223], v[220:223]
    v_mfma_f32_16x16x32_bf16 v[216:219], a[168:171], a[220:223], v[216:219]
    v_mfma_f32_16x16x32_bf16 v[212:215], a[164:167], a[220:223], v[212:215]
    v_mfma_f32_16x16x32_bf16 v[208:211], a[160:163], a[220:223], v[208:211]
    s_waitcnt lgkmcnt(0)
    s_waitcnt vmcnt(44)
    s_barrier
    v_mfma_f32_16x16x32_bf16 v[112:115], a[128:131], a[224:227], v[112:115]
    ds_read_b128 a[232:235], v44 offset:4096
    v_mfma_f32_16x16x32_bf16 v[116:119], a[132:135], a[224:227], v[116:119]
    ds_read_b128 a[236:239], v44 offset:6144
    v_mfma_f32_16x16x32_bf16 v[120:123], a[136:139], a[224:227], v[120:123]
    ds_read_b128 a[248:251], v45 offset:4096
    v_mfma_f32_16x16x32_bf16 v[124:127], a[140:143], a[224:227], v[124:127]
    ds_read_b128 a[252:255], v45 offset:6144
    v_mfma_f32_16x16x32_bf16 v[128:131], a[144:147], a[224:227], v[128:131]
    ds_read_b64_tr_b16 a[160:161], v38 offset:24576
    v_mfma_f32_16x16x32_bf16 v[132:135], a[148:151], a[224:227], v[132:135]
    ds_read_b64_tr_b16 a[162:163], v38 offset:25600
    v_mfma_f32_16x16x32_bf16 v[136:139], a[152:155], a[224:227], v[136:139]
    ds_read_b64_tr_b16 a[164:165], v38 offset:24584
    v_mfma_f32_16x16x32_bf16 v[140:143], a[156:159], a[224:227], v[140:143]
    ds_read_b64_tr_b16 a[166:167], v38 offset:25608
    v_mfma_f32_16x16x32_bf16 v[172:175], a[156:159], a[228:231], v[172:175]
    ds_read_b64_tr_b16 a[168:169], v39 offset:24576
    v_mfma_f32_16x16x32_bf16 v[168:171], a[152:155], a[228:231], v[168:171]
    ds_read_b64_tr_b16 a[170:171], v39 offset:25600
    v_mfma_f32_16x16x32_bf16 v[164:167], a[148:151], a[228:231], v[164:167]
    ds_read_b64_tr_b16 a[172:173], v39 offset:24584
    v_mfma_f32_16x16x32_bf16 v[160:163], a[144:147], a[228:231], v[160:163]
    ds_read_b64_tr_b16 a[174:175], v39 offset:25608
    v_mfma_f32_16x16x32_bf16 v[156:159], a[140:143], a[228:231], v[156:159]
    ds_read_b64_tr_b16 a[176:177], v40 offset:24576
    v_mfma_f32_16x16x32_bf16 v[152:155], a[136:139], a[228:231], v[152:155]
    ds_read_b64_tr_b16 a[178:179], v40 offset:25600
    v_mfma_f32_16x16x32_bf16 v[148:151], a[132:135], a[228:231], v[148:151]
    ds_read_b64_tr_b16 a[180:181], v40 offset:24584
    v_mfma_f32_16x16x32_bf16 v[144:147], a[128:131], a[228:231], v[144:147]
    s_waitcnt lgkmcnt(13)
    ds_read_b64_tr_b16 a[182:183], v40 offset:25608
    v_mfma_f32_16x16x32_bf16 v[176:179], a[128:131], a[232:235], v[176:179]
    ds_read_b64_tr_b16 a[184:185], v41 offset:24576
    v_mfma_f32_16x16x32_bf16 v[180:183], a[132:135], a[232:235], v[180:183]
    ds_read_b64_tr_b16 a[186:187], v41 offset:25600
    v_mfma_f32_16x16x32_bf16 v[184:187], a[136:139], a[232:235], v[184:187]
    ds_read_b64_tr_b16 a[188:189], v41 offset:24584
    v_mfma_f32_16x16x32_bf16 v[188:191], a[140:143], a[232:235], v[188:191]
    ds_read_b64_tr_b16 a[190:191], v41 offset:25608
    v_mfma_f32_16x16x32_bf16 v[192:195], a[144:147], a[232:235], v[192:195]
    v_mfma_f32_16x16x32_bf16 v[196:199], a[148:151], a[232:235], v[196:199]
    v_mfma_f32_16x16x32_bf16 v[200:203], a[152:155], a[232:235], v[200:203]
    v_mfma_f32_16x16x32_bf16 v[204:207], a[156:159], a[232:235], v[204:207]
    v_mfma_f32_16x16x32_bf16 v[236:239], a[156:159], a[236:239], v[236:239]
    v_mfma_f32_16x16x32_bf16 v[232:235], a[152:155], a[236:239], v[232:235]
    v_mfma_f32_16x16x32_bf16 v[228:231], a[148:151], a[236:239], v[228:231]
    v_mfma_f32_16x16x32_bf16 v[224:227], a[144:147], a[236:239], v[224:227]
    v_mfma_f32_16x16x32_bf16 v[220:223], a[140:143], a[236:239], v[220:223]
    v_mfma_f32_16x16x32_bf16 v[216:219], a[136:139], a[236:239], v[216:219]
    v_mfma_f32_16x16x32_bf16 v[212:215], a[132:135], a[236:239], v[212:215]
    v_mfma_f32_16x16x32_bf16 v[208:211], a[128:131], a[236:239], v[208:211]
    s_waitcnt lgkmcnt(0)
    s_waitcnt vmcnt(44)
    s_barrier
    v_mfma_f32_16x16x32_bf16 v[112:115], a[160:163], a[240:243], v[112:115]
    ds_read_b128 a[192:195], v42 offset:0
    v_mfma_f32_16x16x32_bf16 v[116:119], a[164:167], a[240:243], v[116:119]
    ds_read_b128 a[196:199], v42 offset:2048
    v_mfma_f32_16x16x32_bf16 v[120:123], a[168:171], a[240:243], v[120:123]
    ds_read_b128 a[208:211], v43 offset:0
    v_mfma_f32_16x16x32_bf16 v[124:127], a[172:175], a[240:243], v[124:127]
    ds_read_b128 a[212:215], v43 offset:2048
    v_mfma_f32_16x16x32_bf16 v[128:131], a[176:179], a[240:243], v[128:131]
    ds_read_b64_tr_b16 a[128:129], v38 offset:0
    v_mfma_f32_16x16x32_bf16 v[132:135], a[180:183], a[240:243], v[132:135]
    ds_read_b64_tr_b16 a[130:131], v38 offset:1024
    v_mfma_f32_16x16x32_bf16 v[136:139], a[184:187], a[240:243], v[136:139]
    ds_read_b64_tr_b16 a[132:133], v38 offset:8
    v_mfma_f32_16x16x32_bf16 v[140:143], a[188:191], a[240:243], v[140:143]
    ds_read_b64_tr_b16 a[134:135], v38 offset:1032
    v_mfma_f32_16x16x32_bf16 v[172:175], a[188:191], a[244:247], v[172:175]
    ds_read_b64_tr_b16 a[136:137], v39 offset:0
    v_mfma_f32_16x16x32_bf16 v[168:171], a[184:187], a[244:247], v[168:171]
    ds_read_b64_tr_b16 a[138:139], v39 offset:1024
    v_mfma_f32_16x16x32_bf16 v[164:167], a[180:183], a[244:247], v[164:167]
    ds_read_b64_tr_b16 a[140:141], v39 offset:8
    v_mfma_f32_16x16x32_bf16 v[160:163], a[176:179], a[244:247], v[160:163]
    ds_read_b64_tr_b16 a[142:143], v39 offset:1032
    v_mfma_f32_16x16x32_bf16 v[156:159], a[172:175], a[244:247], v[156:159]
    ds_read_b64_tr_b16 a[144:145], v40 offset:0
    v_mfma_f32_16x16x32_bf16 v[152:155], a[168:171], a[244:247], v[152:155]
    ds_read_b64_tr_b16 a[146:147], v40 offset:1024
    v_mfma_f32_16x16x32_bf16 v[148:151], a[164:167], a[244:247], v[148:151]
    ds_read_b64_tr_b16 a[148:149], v40 offset:8
    v_mfma_f32_16x16x32_bf16 v[144:147], a[160:163], a[244:247], v[144:147]
    ds_read_b64_tr_b16 a[150:151], v40 offset:1032
    v_mfma_f32_16x16x32_bf16 v[176:179], a[160:163], a[248:251], v[176:179]
    ds_read_b64_tr_b16 a[152:153], v41 offset:0
    v_mfma_f32_16x16x32_bf16 v[180:183], a[164:167], a[248:251], v[180:183]
    ds_read_b64_tr_b16 a[154:155], v41 offset:1024
    v_mfma_f32_16x16x32_bf16 v[184:187], a[168:171], a[248:251], v[184:187]
    ds_read_b64_tr_b16 a[156:157], v41 offset:8
    v_mfma_f32_16x16x32_bf16 v[188:191], a[172:175], a[248:251], v[188:191]
    ds_read_b64_tr_b16 a[158:159], v41 offset:1032
    v_mfma_f32_16x16x32_bf16 v[192:195], a[176:179], a[248:251], v[192:195]
    v_mfma_f32_16x16x32_bf16 v[196:199], a[180:183], a[248:251], v[196:199]
    v_mfma_f32_16x16x32_bf16 v[200:203], a[184:187], a[248:251], v[200:203]
    v_mfma_f32_16x16x32_bf16 v[204:207], a[188:191], a[248:251], v[204:207]
    v_mfma_f32_16x16x32_bf16 v[236:239], a[188:191], a[252:255], v[236:239]
    v_mfma_f32_16x16x32_bf16 v[232:235], a[184:187], a[252:255], v[232:235]
    v_mfma_f32_16x16x32_bf16 v[228:231], a[180:183], a[252:255], v[228:231]
    v_mfma_f32_16x16x32_bf16 v[224:227], a[176:179], a[252:255], v[224:227]
    v_mfma_f32_16x16x32_bf16 v[220:223], a[172:175], a[252:255], v[220:223]
    v_mfma_f32_16x16x32_bf16 v[216:219], a[168:171], a[252:255], v[216:219]
    v_mfma_f32_16x16x32_bf16 v[212:215], a[164:167], a[252:255], v[212:215]
    v_mfma_f32_16x16x32_bf16 v[208:211], a[160:163], a[252:255], v[208:211]
    s_waitcnt lgkmcnt(0)
    s_waitcnt vmcnt(0)
    s_barrier
    v_mfma_f32_16x16x32_bf16 v[112:115], a[128:131], a[192:195], v[112:115]
    s_add_u32 m0, s96, 81920
    ds_read_b128 a[200:203], v42 offset:4096
    v_mfma_f32_16x16x32_bf16 v[116:119], a[132:135], a[192:195], v[116:119]
    ds_read_b128 a[204:207], v42 offset:6144
    v_mfma_f32_16x16x32_bf16 v[120:123], a[136:139], a[192:195], v[120:123]
    buffer_load_dwordx4 v32, s[20:23], s95 offen offset:0 nt lds
    v_mfma_f32_16x16x32_bf16 v[124:127], a[140:143], a[192:195], v[124:127]
    ds_read_b128 a[216:219], v43 offset:4096
    v_mfma_f32_16x16x32_bf16 v[128:131], a[144:147], a[192:195], v[128:131]
    ds_read_b128 a[220:223], v43 offset:6144
    v_mfma_f32_16x16x32_bf16 v[132:135], a[148:151], a[192:195], v[132:135]
    ds_read_b64_tr_b16 a[160:161], v38 offset:8192
    v_mfma_f32_16x16x32_bf16 v[136:139], a[152:155], a[192:195], v[136:139]
    ds_read_b64_tr_b16 a[162:163], v38 offset:9216
    v_mfma_f32_16x16x32_bf16 v[140:143], a[156:159], a[192:195], v[140:143]
    buffer_load_dwordx4 v33, s[20:23], s95 offen offset:1024 nt lds
    v_mfma_f32_16x16x32_bf16 v[172:175], a[156:159], a[196:199], v[172:175]
    ds_read_b64_tr_b16 a[164:165], v38 offset:8200
    v_mfma_f32_16x16x32_bf16 v[168:171], a[152:155], a[196:199], v[168:171]
    ds_read_b64_tr_b16 a[166:167], v38 offset:9224
    v_mfma_f32_16x16x32_bf16 v[164:167], a[148:151], a[196:199], v[164:167]
    ds_read_b64_tr_b16 a[168:169], v39 offset:8192
    v_mfma_f32_16x16x32_bf16 v[160:163], a[144:147], a[196:199], v[160:163]
    ds_read_b64_tr_b16 a[170:171], v39 offset:9216
    v_mfma_f32_16x16x32_bf16 v[156:159], a[140:143], a[196:199], v[156:159]
    buffer_load_dwordx4 v32, s[20:23], s95 offen offset:2048 nt lds
    v_mfma_f32_16x16x32_bf16 v[152:155], a[136:139], a[196:199], v[152:155]
    ds_read_b64_tr_b16 a[172:173], v39 offset:8200
    v_mfma_f32_16x16x32_bf16 v[148:151], a[132:135], a[196:199], v[148:151]
    ds_read_b64_tr_b16 a[174:175], v39 offset:9224
    v_mfma_f32_16x16x32_bf16 v[144:147], a[128:131], a[196:199], v[144:147]
    s_waitcnt lgkmcnt(10)
    ds_read_b64_tr_b16 a[176:177], v40 offset:8192
    v_mfma_f32_16x16x32_bf16 v[176:179], a[128:131], a[200:203], v[176:179]
    ds_read_b64_tr_b16 a[178:179], v40 offset:9216
    v_mfma_f32_16x16x32_bf16 v[180:183], a[132:135], a[200:203], v[180:183]
    buffer_load_dwordx4 v33, s[20:23], s95 offen offset:3072 nt lds
    v_mfma_f32_16x16x32_bf16 v[184:187], a[136:139], a[200:203], v[184:187]
    s_add_u32 s95, s95, 16384
    ds_read_b64_tr_b16 a[180:181], v40 offset:8200
    v_mfma_f32_16x16x32_bf16 v[188:191], a[140:143], a[200:203], v[188:191]
    ds_read_b64_tr_b16 a[182:183], v40 offset:9224
    v_mfma_f32_16x16x32_bf16 v[192:195], a[144:147], a[200:203], v[192:195]
    ds_read_b64_tr_b16 a[184:185], v41 offset:8192
    v_mfma_f32_16x16x32_bf16 v[196:199], a[148:151], a[200:203], v[196:199]
    ds_read_b64_tr_b16 a[186:187], v41 offset:9216
    v_mfma_f32_16x16x32_bf16 v[200:203], a[152:155], a[200:203], v[200:203]
    ds_read_b64_tr_b16 a[188:189], v41 offset:8200
    v_mfma_f32_16x16x32_bf16 v[204:207], a[156:159], a[200:203], v[204:207]
    ds_read_b64_tr_b16 a[190:191], v41 offset:9224
    v_mfma_f32_16x16x32_bf16 v[236:239], a[156:159], a[204:207], v[236:239]
    v_mfma_f32_16x16x32_bf16 v[232:235], a[152:155], a[204:207], v[232:235]
    v_mfma_f32_16x16x32_bf16 v[228:231], a[148:151], a[204:207], v[228:231]
    v_mfma_f32_16x16x32_bf16 v[224:227], a[144:147], a[204:207], v[224:227]
    v_mfma_f32_16x16x32_bf16 v[220:223], a[140:143], a[204:207], v[220:223]
    v_mfma_f32_16x16x32_bf16 v[216:219], a[136:139], a[204:207], v[216:219]
    v_mfma_f32_16x16x32_bf16 v[212:215], a[132:135], a[204:207], v[212:215]
    v_mfma_f32_16x16x32_bf16 v[208:211], a[128:131], a[204:207], v[208:211]
    s_waitcnt lgkmcnt(0)
    s_barrier
    v_mfma_f32_16x16x32_bf16 v[112:115], a[160:163], a[208:211], v[112:115]
    s_add_u32 m0, s96, 32768
    ds_read_b128 a[224:227], v44 offset:0
    v_mfma_f32_16x16x32_bf16 v[116:119], a[164:167], a[208:211], v[116:119]
    ds_read_b128 a[228:231], v44 offset:2048
    v_mfma_f32_16x16x32_bf16 v[120:123], a[168:171], a[208:211], v[120:123]
    buffer_load_dwordx4 v28, s[16:19], s50 offen offset:0 nt lds
    v_mfma_f32_16x16x32_bf16 v[124:127], a[172:175], a[208:211], v[124:127]
    ds_read_b128 a[240:243], v45 offset:0
    v_mfma_f32_16x16x32_bf16 v[128:131], a[176:179], a[208:211], v[128:131]
    ds_read_b128 a[244:247], v45 offset:2048
    v_mfma_f32_16x16x32_bf16 v[132:135], a[180:183], a[208:211], v[132:135]
    ds_read_b64_tr_b16 a[128:129], v38 offset:16384
    v_mfma_f32_16x16x32_bf16 v[136:139], a[184:187], a[208:211], v[136:139]
    ds_read_b64_tr_b16 a[130:131], v38 offset:17408
    v_mfma_f32_16x16x32_bf16 v[140:143], a[188:191], a[208:211], v[140:143]
    buffer_load_dwordx4 v29, s[16:19], s50 offen offset:1024 nt lds
    v_mfma_f32_16x16x32_bf16 v[172:175], a[188:191], a[212:215], v[172:175]
    ds_read_b64_tr_b16 a[132:133], v38 offset:16392
    v_mfma_f32_16x16x32_bf16 v[168:171], a[184:187], a[212:215], v[168:171]
    ds_read_b64_tr_b16 a[134:135], v38 offset:17416
    v_mfma_f32_16x16x32_bf16 v[164:167], a[180:183], a[212:215], v[164:167]
    ds_read_b64_tr_b16 a[136:137], v39 offset:16384
    v_mfma_f32_16x16x32_bf16 v[160:163], a[176:179], a[212:215], v[160:163]
    ds_read_b64_tr_b16 a[138:139], v39 offset:17408
    v_mfma_f32_16x16x32_bf16 v[156:159], a[172:175], a[212:215], v[156:159]
    buffer_load_dwordx4 v30, s[16:19], s50 offen offset:2048 nt lds
    v_mfma_f32_16x16x32_bf16 v[152:155], a[168:171], a[212:215], v[152:155]
    ds_read_b64_tr_b16 a[140:141], v39 offset:16392
    v_mfma_f32_16x16x32_bf16 v[148:151], a[164:167], a[212:215], v[148:151]
    ds_read_b64_tr_b16 a[142:143], v39 offset:17416
    v_mfma_f32_16x16x32_bf16 v[144:147], a[160:163], a[212:215], v[144:147]
    ds_read_b64_tr_b16 a[144:145], v40 offset:16384
    v_mfma_f32_16x16x32_bf16 v[176:179], a[160:163], a[216:219], v[176:179]
    ds_read_b64_tr_b16 a[146:147], v40 offset:17408
    v_mfma_f32_16x16x32_bf16 v[180:183], a[164:167], a[216:219], v[180:183]
    buffer_load_dwordx4 v31, s[16:19], s50 offen offset:3072 nt lds
    v_mfma_f32_16x16x32_bf16 v[184:187], a[168:171], a[216:219], v[184:187]
    s_add_u32 s50, s50, 16384
    ds_read_b64_tr_b16 a[148:149], v40 offset:16392
    v_mfma_f32_16x16x32_bf16 v[188:191], a[172:175], a[216:219], v[188:191]
    ds_read_b64_tr_b16 a[150:151], v40 offset:17416
    v_mfma_f32_16x16x32_bf16 v[192:195], a[176:179], a[216:219], v[192:195]
    ds_read_b64_tr_b16 a[152:153], v41 offset:16384
    v_mfma_f32_16x16x32_bf16 v[196:199], a[180:183], a[216:219], v[196:199]
    ds_read_b64_tr_b16 a[154:155], v41 offset:17408
    v_mfma_f32_16x16x32_bf16 v[200:203], a[184:187], a[216:219], v[200:203]
    ds_read_b64_tr_b16 a[156:157], v41 offset:16392
    v_mfma_f32_16x16x32_bf16 v[204:207], a[188:191], a[216:219], v[204:207]
    ds_read_b64_tr_b16 a[158:159], v41 offset:17416
    v_mfma_f32_16x16x32_bf16 v[236:239], a[188:191], a[220:223], v[236:239]
    v_mfma_f32_16x16x32_bf16 v[232:235], a[184:187], a[220:223], v[232:235]
    v_mfma_f32_16x16x32_bf16 v[228:231], a[180:183], a[220:223], v[228:231]
    v_mfma_f32_16x16x32_bf16 v[224:227], a[176:179], a[220:223], v[224:227]
    v_mfma_f32_16x16x32_bf16 v[220:223], a[172:175], a[220:223], v[220:223]
    v_mfma_f32_16x16x32_bf16 v[216:219], a[168:171], a[220:223], v[216:219]
    v_mfma_f32_16x16x32_bf16 v[212:215], a[164:167], a[220:223], v[212:215]
    v_mfma_f32_16x16x32_bf16 v[208:211], a[160:163], a[220:223], v[208:211]
    s_waitcnt lgkmcnt(0)
L1_qend:
    s_waitcnt vmcnt(8)
    s_barrier
    v_mfma_f32_16x16x32_bf16 v[112:115], a[128:131], a[224:227], v[112:115]
    s_add_u32 m0, s96, 49152
    ds_read_b128 a[232:235], v44 offset:4096
    v_mfma_f32_16x16x32_bf16 v[116:119], a[132:135], a[224:227], v[116:119]
    ds_read_b128 a[236:239], v44 offset:6144
    v_mfma_f32_16x16x32_bf16 v[120:123], a[136:139], a[224:227], v[120:123]
    buffer_load_dwordx4 v28, s[16:19], s50 offen offset:0 nt lds
    v_mfma_f32_16x16x32_bf16 v[124:127], a[140:143], a[224:227], v[124:127]
    ds_read_b128 a[248:251], v45 offset:4096
    v_mfma_f32_16x16x32_bf16 v[128:131], a[144:147], a[224:227], v[128:131]
    ds_read_b128 a[252:255], v45 offset:6144
    v_mfma_f32_16x16x32_bf16 v[132:135], a[148:151], a[224:227], v[132:135]
    ds_read_b64_tr_b16 a[160:161], v38 offset:24576
    v_mfma_f32_16x16x32_bf16 v[136:139], a[152:155], a[224:227], v[136:139]
    ds_read_b64_tr_b16 a[162:163], v38 offset:25600
    v_mfma_f32_16x16x32_bf16 v[140:143], a[156:159], a[224:227], v[140:143]
    buffer_load_dwordx4 v29, s[16:19], s50 offen offset:1024 nt lds
    v_mfma_f32_16x16x32_bf16 v[172:175], a[156:159], a[228:231], v[172:175]
    ds_read_b64_tr_b16 a[164:165], v38 offset:24584
    v_mfma_f32_16x16x32_bf16 v[168:171], a[152:155], a[228:231], v[168:171]
    ds_read_b64_tr_b16 a[166:167], v38 offset:25608
    v_mfma_f32_16x16x32_bf16 v[164:167], a[148:151], a[228:231], v[164:167]
    ds_read_b64_tr_b16 a[168:169], v39 offset:24576
    v_mfma_f32_16x16x32_bf16 v[160:163], a[144:147], a[228:231], v[160:163]
    ds_read_b64_tr_b16 a[170:171], v39 offset:25600
    v_mfma_f32_16x16x32_bf16 v[156:159], a[140:143], a[228:231], v[156:159]
    buffer_load_dwordx4 v30, s[16:19], s50 offen offset:2048 nt lds
    v_mfma_f32_16x16x32_bf16 v[152:155], a[136:139], a[228:231], v[152:155]
    ds_read_b64_tr_b16 a[172:173], v39 offset:24584
    v_mfma_f32_16x16x32_bf16 v[148:151], a[132:135], a[228:231], v[148:151]
    ds_read_b64_tr_b16 a[174:175], v39 offset:25608
    v_mfma_f32_16x16x32_bf16 v[144:147], a[128:131], a[228:231], v[144:147]
    s_waitcnt lgkmcnt(10)
    ds_read_b64_tr_b16 a[176:177], v40 offset:24576
    v_mfma_f32_16x16x32_bf16 v[176:179], a[128:131], a[232:235], v[176:179]
    ds_read_b64_tr_b16 a[178:179], v40 offset:25600
    v_mfma_f32_16x16x32_bf16 v[180:183], a[132:135], a[232:235], v[180:183]
    buffer_load_dwordx4 v31, s[16:19], s50 offen offset:3072 nt lds
    v_mfma_f32_16x16x32_bf16 v[184:187], a[136:139], a[232:235], v[184:187]
    s_add_u32 s50, s50, 16384
    ds_read_b64_tr_b16 a[180:181], v40 offset:24584
    v_mfma_f32_16x16x32_bf16 v[188:191], a[140:143], a[232:235], v[188:191]
    ds_read_b64_tr_b16 a[182:183], v40 offset:25608
    v_mfma_f32_16x16x32_bf16 v[192:195], a[144:147], a[232:235], v[192:195]
    ds_read_b64_tr_b16 a[184:185], v41 offset:24576
    v_mfma_f32_16x16x32_bf16 v[196:199], a[148:151], a[232:235], v[196:199]
    ds_read_b64_tr_b16 a[186:187], v41 offset:25600
    v_mfma_f32_16x16x32_bf16 v[200:203], a[152:155], a[232:235], v[200:203]
    ds_read_b64_tr_b16 a[188:189], v41 offset:24584
    v_mfma_f32_16x16x32_bf16 v[204:207], a[156:159], a[232:235], v[204:207]
    ds_read_b64_tr_b16 a[190:191], v41 offset:25608
    v_mfma_f32_16x16x32_bf16 v[236:239], a[156:159], a[236:239], v[236:239]
    v_mfma_f32_16x16x32_bf16 v[232:235], a[152:155], a[236:239], v[232:235]
    v_mfma_f32_16x16x32_bf16 v[228:231], a[148:151], a[236:239], v[228:231]
    v_mfma_f32_16x16x32_bf16 v[224:227], a[144:147], a[236:239], v[224:227]
    v_mfma_f32_16x16x32_bf16 v[220:223], a[140:143], a[236:239], v[220:223]
    v_mfma_f32_16x16x32_bf16 v[216:219], a[136:139], a[236:239], v[216:219]
    v_mfma_f32_16x16x32_bf16 v[212:215], a[132:135], a[236:239], v[212:215]
    v_mfma_f32_16x16x32_bf16 v[208:211], a[128:131], a[236:239], v[208:211]
    s_waitcnt lgkmcnt(0)
    v_mfma_f32_16x16x32_bf16 v[112:115], a[160:163], a[240:243], v[112:115]
    ds_read_b128 a[192:195], v16 offset:0
    v_mfma_f32_16x16x32_bf16 v[116:119], a[164:167], a[240:243], v[116:119]
    ds_read_b128 a[196:199], v17 offset:0
    v_mfma_f32_16x16x32_bf16 v[120:123], a[168:171], a[240:243], v[120:123]
    ds_read_b128 a[200:203], v18 offset:0
    v_mfma_f32_16x16x32_bf16 v[124:127], a[172:175], a[240:243], v[124:127]
    ds_read_b128 a[204:207], v19 offset:0
    v_mfma_f32_16x16x32_bf16 v[128:131], a[176:179], a[240:243], v[128:131]
    ds_read_b128 a[208:211], v16 offset:4096
    v_mfma_f32_16x16x32_bf16 v[132:135], a[180:183], a[240:243], v[132:135]
    ds_read_b128 a[212:215], v17 offset:4096
    v_mfma_f32_16x16x32_bf16 v[136:139], a[184:187], a[240:243], v[136:139]
    ds_read_b128 a[216:219], v18 offset:4096
    v_mfma_f32_16x16x32_bf16 v[140:143], a[188:191], a[240:243], v[140:143]
    ds_read_b128 a[220:223], v19 offset:4096
    v_mfma_f32_16x16x32_bf16 v[172:175], a[188:191], a[244:247], v[172:175]
    ds_read_b128 a[128:131], v16 offset:16384
    v_mfma_f32_16x16x32_bf16 v[168:171], a[184:187], a[244:247], v[168:171]
    ds_read_b128 a[132:135], v17 offset:16384
    v_mfma_f32_16x16x32_bf16 v[164:167], a[180:183], a[244:247], v[164:167]
    ds_read_b128 a[136:139], v18 offset:16384
    v_mfma_f32_16x16x32_bf16 v[160:163], a[176:179], a[244:247], v[160:163]
    ds_read_b128 a[140:143], v19 offset:16384
    v_mfma_f32_16x16x32_bf16 v[156:159], a[172:175], a[244:247], v[156:159]
    ds_read_b128 a[144:147], v16 offset:20480
    v_mfma_f32_16x16x32_bf16 v[152:155], a[168:171], a[244:247], v[152:155]
    ds_read_b128 a[148:151], v17 offset:20480
    v_mul_f32 v112, s56, v112
    v_mfma_f32_16x16x32_bf16 v[148:151], a[164:167], a[244:247], v[148:151]
    ds_read_b128 a[152:155], v18 offset:20480
    v_mul_f32 v113, s56, v113
    v_mfma_f32_16x16x32_bf16 v[144:147], a[160:163], a[244:247], v[144:147]
    ds_read_b128 a[156:159], v19 offset:20480
    v_mul_f32 v114, s56, v114
    v_mfma_f32_16x16x32_bf16 v[176:179], a[160:163], a[248:251], v[176:179]
    v_mul_f32 v115, s56, v115
    v_mul_f32 v116, s56, v116
    v_mfma_f32_16x16x32_bf16 v[180:183], a[164:167], a[248:251], v[180:183]
    v_mul_f32 v117, s56, v117
    v_mul_f32 v118, s56, v118
    v_mfma_f32_16x16x32_bf16 v[184:187], a[168:171], a[248:251], v[184:187]
    v_mul_f32 v119, s56, v119
    v_cvt_pk_bf16_f32 v48, v112, v113
    v_mfma_f32_16x16x32_bf16 v[188:191], a[172:175], a[248:251], v[188:191]
    v_cvt_pk_bf16_f32 v49, v114, v115
    v_cvt_pk_bf16_f32 v50, v116, v117
    v_mfma_f32_16x16x32_bf16 v[192:195], a[176:179], a[248:251], v[192:195]
    v_cvt_pk_bf16_f32 v51, v118, v119
    v_mul_f32 v120, s56, v120
    v_mfma_f32_16x16x32_bf16 v[196:199], a[180:183], a[248:251], v[196:199]
    v_mul_f32 v121, s56, v121
    v_mul_f32 v122, s56, v122
    v_mfma_f32_16x16x32_bf16 v[200:203], a[184:187], a[248:251], v[200:203]
    v_mul_f32 v123, s56, v123
    v_mul_f32 v124, s56, v124
    v_mfma_f32_16x16x32_bf16 v[204:207], a[188:191], a[248:251], v[204:207]
    v_mul_f32 v125, s56, v125
    v_mul_f32 v126, s56, v126
    v_mfma_f32_16x16x32_bf16 v[236:239], a[188:191], a[252:255], v[236:239]
    v_mul_f32 v127, s56, v127
    v_cvt_pk_bf16_f32 v52, v120, v121
    v_mfma_f32_16x16x32_bf16 v[232:235], a[184:187], a[252:255], v[232:235]
    v_cvt_pk_bf16_f32 v53, v122, v123
    v_cvt_pk_bf16_f32 v54, v124, v125
    v_mfma_f32_16x16x32_bf16 v[228:231], a[180:183], a[252:255], v[228:231]
    v_cvt_pk_bf16_f32 v55, v126, v127
    v_mul_f32 v128, s56, v128
    v_mfma_f32_16x16x32_bf16 v[224:227], a[176:179], a[252:255], v[224:227]
    v_mul_f32 v129, s56, v129
    v_mul_f32 v130, s56, v130
    v_mfma_f32_16x16x32_bf16 v[220:223], a[172:175], a[252:255], v[220:223]
    v_mul_f32 v131, s56, v131
    v_mul_f32 v132, s56, v132
    v_mfma_f32_16x16x32_bf16 v[216:219], a[168:171], a[252:255], v[216:219]
    v_mul_f32 v133, s56, v133
    v_mul_f32 v134, s56, v134
    v_mfma_f32_16x16x32_bf16 v[212:215], a[164:167], a[252:255], v[212:215]
    v_mul_f32 v135, s56, v135
    v_cvt_pk_bf16_f32 v56, v128, v129
    v_mfma_f32_16x16x32_bf16 v[208:211], a[160:163], a[252:255], v[208:211]
    v_cvt_pk_bf16_f32 v57, v130, v131
    v_cvt_pk_bf16_f32 v58, v132, v133
    ds_read_b128 a[224:227], v16 offset:8192
    ds_read_b128 a[228:231], v17 offset:8192
    ds_read_b128 a[232:235], v18 offset:8192
    ds_read_b128 a[236:239], v19 offset:8192
    ds_read_b128 a[240:243], v16 offset:12288
    ds_read_b128 a[244:247], v17 offset:12288
    ds_read_b128 a[248:251], v18 offset:12288
    ds_read_b128 a[252:255], v19 offset:12288
    v_cvt_pk_bf16_f32 v59, v134, v135
    v_mul_f32 v136, s56, v136
    v_mul_f32 v137, s56, v137
    v_mul_f32 v138, s56, v138
    v_mul_f32 v139, s56, v139
    v_mul_f32 v140, s56, v140
    v_mul_f32 v141, s56, v141
    v_mul_f32 v142, s56, v142
    v_mul_f32 v143, s56, v143
    v_cvt_pk_bf16_f32 v60, v136, v137
    v_cvt_pk_bf16_f32 v61, v138, v139
    v_cvt_pk_bf16_f32 v62, v140, v141
    v_cvt_pk_bf16_f32 v63, v142, v143
    v_pk_mul_f32 v[144:145], v[144:145], s[56:57]
    v_pk_mul_f32 v[146:147], v[146:147], s[56:57]
    v_pk_mul_f32 v[148:149], v[148:149], s[56:57]
    v_pk_mul_f32 v[150:151], v[150:151], s[56:57]
    v_cvt_pk_bf16_f32 v64, v144, v145
    v_cvt_pk_bf16_f32 v65, v146, v147
    v_cvt_pk_bf16_f32 v66, v148, v149
    v_cvt_pk_bf16_f32 v67, v150, v151
    v_pk_mul_f32 v[152:153], v[152:153], s[56:57]
    v_pk_mul_f32 v[154:155], v[154:155], s[56:57]
    v_pk_mul_f32 v[156:157], v[156:157], s[56:57]
    v_pk_mul_f32 v[158:159], v[158:159], s[56:57]
    v_cvt_pk_bf16_f32 v68, v152, v153
    v_cvt_pk_bf16_f32 v69, v154, v155
    v_cvt_pk_bf16_f32 v70, v156, v157
    v_cvt_pk_bf16_f32 v71, v158, v159
    v_pk_mul_f32 v[160:161], v[160:161], s[56:57]
    v_pk_mul_f32 v[162:163], v[162:163], s[56:57]
    v_pk_mul_f32 v[164:165], v[164:165], s[56:57]
    v_pk_mul_f32 v[166:167], v[166:167], s[56:57]
    v_cvt_pk_bf16_f32 v72, v160, v161
    v_cvt_pk_bf16_f32 v73, v162, v163
    v_cvt_pk_bf16_f32 v74, v164, v165
    v_cvt_pk_bf16_f32 v75, v166, v167
    v_pk_mul_f32 v[168:169], v[168:169], s[56:57]
    v_pk_mul_f32 v[170:171], v[170:171], s[56:57]
    v_pk_mul_f32 v[172:173], v[172:173], s[56:57]
    v_pk_mul_f32 v[174:175], v[174:175], s[56:57]
    v_cvt_pk_bf16_f32 v76, v168, v169
    v_cvt_pk_bf16_f32 v77, v170, v171
    v_cvt_pk_bf16_f32 v78, v172, v173
    v_cvt_pk_bf16_f32 v79, v174, v175
    s_waitcnt lgkmcnt(0)
    s_barrier
    s_cmp_ge_u32 s59, 32
    s_cbranch_scc1 L1_norep
    v_mov_b32 v8, 1
    s_mov_b64 exec, 1
    buffer_atomic_add v8, v255, s[80:83], 0 offen offset:128 sc1
    s_mov_b64 exec, -1
L1_norep:
    s_add_u32 m0, s96, 98304
    v_pk_mul_f32 v[176:177], v[176:177], s[56:57]
    v_pk_mul_f32 v[178:179], v[178:179], s[56:57]
    buffer_load_dwordx4 v32, s[20:23], s95 offen offset:0 nt lds
    v_pk_mul_f32 v[180:181], v[180:181], s[56:57]
    v_pk_mul_f32 v[182:183], v[182:183], s[56:57]
    v_cvt_pk_bf16_f32 v80, v176, v177
    v_cvt_pk_bf16_f32 v81, v178, v179
    v_cvt_pk_bf16_f32 v82, v180, v181
    v_cvt_pk_bf16_f32 v83, v182, v183
    v_pk_mul_f32 v[184:185], v[184:185], s[56:57]
    v_pk_mul_f32 v[186:187], v[186:187], s[56:57]
    v_pk_mul_f32 v[188:189], v[188:189], s[56:57]
    v_pk_mul_f32 v[190:191], v[190:191], s[56:57]
    v_cvt_pk_bf16_f32 v84, v184, v185
    v_cvt_pk_bf16_f32 v85, v186, v187
    v_cvt_pk_bf16_f32 v86, v188, v189
    v_cvt_pk_bf16_f32 v87, v190, v191
    buffer_load_dwordx4 v33, s[20:23], s95 offen offset:1024 nt lds
    v_pk_mul_f32 v[192:193], v[192:193], s[56:57]
    v_pk_mul_f32 v[194:195], v[194:195], s[56:57]
    v_pk_mul_f32 v[196:197], v[196:197], s[56:57]
    v_pk_mul_f32 v[198:199], v[198:199], s[56:57]
    v_cvt_pk_bf16_f32 v88, v192, v193
    v_cvt_pk_bf16_f32 v89, v194, v195
    v_cvt_pk_bf16_f32 v90, v196, v197
    v_cvt_pk_bf16_f32 v91, v198, v199
    v_pk_mul_f32 v[200:201], v[200:201], s[56:57]
    v_pk_mul_f32 v[202:203], v[202:203], s[56:57]
    v_pk_mul_f32 v[204:205], v[204:205], s[56:57]
    v_pk_mul_f32 v[206:207], v[206:207], s[56:57]
    v_cvt_pk_bf16_f32 v92, v200, v201
    v_cvt_pk_bf16_f32 v93, v202, v203
    buffer_load_dwordx4 v32, s[20:23], s95 offen offset:2048 nt lds
    v_cvt_pk_bf16_f32 v94, v204, v205
    v_cvt_pk_bf16_f32 v95, v206, v207
    v_pk_mul_f32 v[208:209], v[208:209], s[56:57]
    v_pk_mul_f32 v[210:211], v[210:211], s[56:57]
    v_pk_mul_f32 v[212:213], v[212:213], s[56:57]
    v_pk_mul_f32 v[214:215], v[214:215], s[56:57]
    v_cvt_pk_bf16_f32 v96, v208, v209
    v_cvt_pk_bf16_f32 v97, v210, v211
    v_cvt_pk_bf16_f32 v98, v212, v213
    v_cvt_pk_bf16_f32 v99, v214, v215
    v_pk_mul_f32 v[216:217], v[216:217], s[56:57]
    v_pk_mul_f32 v[218:219], v[218:219], s[56:57]
    v_pk_mul_f32 v[220:221], v[220:221], s[56:57]
    v_pk_mul_f32 v[222:223], v[222:223], s[56:57]
    buffer_load_dwordx4 v33, s[20:23], s95 offen offset:3072 nt lds
    v_cvt_pk_bf16_f32 v100, v216, v217
    v_cvt_pk_bf16_f32 v101, v218, v219
    v_cvt_pk_bf16_f32 v102, v220, v221
    v_cvt_pk_bf16_f32 v103, v222, v223
    v_pk_mul_f32 v[224:225], v[224:225], s[56:57]
    v_pk_mul_f32 v[226:227], v[226:227], s[56:57]
    v_pk_mul_f32 v[228:229], v[228:229], s[56:57]
    v_pk_mul_f32 v[230:231], v[230:231], s[56:57]
    v_cvt_pk_bf16_f32 v104, v224, v225
    v_cvt_pk_bf16_f32 v105, v226, v227
    v_cvt_pk_bf16_f32 v106, v228, v229
    v_cvt_pk_bf16_f32 v107, v230, v231
    v_pk_mul_f32 v[232:233], v[232:233], s[56:57]
    v_pk_mul_f32 v[234:235], v[234:235], s[56:57]
    s_add_u32 s95, s95, 16384
    v_pk_mul_f32 v[236:237], v[236:237], s[56:57]
    v_pk_mul_f32 v[238:239], v[238:239], s[56:57]
    v_cvt_pk_bf16_f32 v108, v232, v233
    v_cvt_pk_bf16_f32 v109, v234, v235
    v_cvt_pk_bf16_f32 v110, v236, v237
    v_cvt_pk_bf16_f32 v111, v238, v239
    s_cmp_eq_u32 s3, 3
    s_cselect_b32 s53, 0x461c4000, 0
    v_mfma_f32_16x16x32_bf16 v[112:115], a[192:195], v[48:51], 0
    v_mov_b32 v224, 0
    v_mov_b32 v225, 0
    v_mfma_f32_16x16x32_bf16 v[112:115], a[196:199], v[52:55], v[112:115]
    v_mov_b32 v226, 0
    v_mov_b32 v227, 0
    v_mfma_f32_16x16x32_bf16 v[112:115], a[200:203], v[56:59], v[112:115]
    v_mov_b32 v228, 0
    v_mov_b32 v229, 0
    v_mfma_f32_16x16x32_bf16 v[112:115], a[204:207], v[60:63], v[112:115]
    v_mov_b32 v230, 0
    v_mov_b32 v231, 0
    v_mfma_f32_16x16x32_bf16 v[116:119], a[220:223], v[60:63], 0
    v_mov_b32 v232, 0
    v_mov_b32 v233, 0
    v_mfma_f32_16x16x32_bf16 v[116:119], a[216:219], v[56:59], v[116:119]
    v_mov_b32 v234, 0
    v_mov_b32 v235, 0
    v_mfma_f32_16x16x32_bf16 v[116:119], a[212:215], v[52:55], v[116:119]
    v_mov_b32 v236, 0
    v_mov_b32 v237, 0
    v_mfma_f32_16x16x32_bf16 v[116:119], a[208:211], v[48:51], v[116:119]
    v_mov_b32 v238, 0
    v_mov_b32 v239, 0
    v_mfma_f32_16x16x32_bf16 v[124:127], a[208:211], v[64:67], 0
    v_lshl_add_u32 v10, v1, 2, v7
    v_bfe_u32 v9, v10, 1, 2
    v_mfma_f32_16x16x32_bf16 v[124:127], a[212:215], v[68:71], v[124:127]
    v_lshlrev_b32 v10, 7, v10
    v_lshl_add_u32 v10, v4, 3, v10
    v_mfma_f32_16x16x32_bf16 v[124:127], a[216:219], v[72:75], v[124:127]
    v_max3_f32 v176, v112, v113, v114
    v_max3_f32 v177, v115, v116, v117
    v_mfma_f32_16x16x32_bf16 v[124:127], a[220:223], v[76:79], v[124:127]
    v_max3_f32 v176, v176, v118, v119
    v_max_f32 v176, v176, v177
    v_mfma_f32_16x16x32_bf16 v[120:123], a[204:207], v[76:79], 0
    s_add_u32 m0, s96, 0
    v_mov_b32 v177, v176
    s_nop 1
    v_mfma_f32_16x16x32_bf16 v[120:123], a[200:203], v[72:75], v[120:123]
    buffer_load_dwordx4 v28, s[16:19], s50 offen offset:0 nt lds
    v_permlane16_swap_b32 v176, v177
    v_max_f32 v176, v176, v177
    v_mfma_f32_16x16x32_bf16 v[120:123], a[196:199], v[68:71], v[120:123]
    v_mov_b32 v177, v176
    s_nop 1
    v_mfma_f32_16x16x32_bf16 v[120:123], a[192:195], v[64:67], v[120:123]
    v_permlane32_swap_b32 v176, v177
    v_max_f32 v176, v176, v177
    v_mfma_f32_16x16x32_bf16 v[128:131], a[192:195], v[80:83], 0
    v_sub_f32 v208, 0, v176
    v_sub_f32 v209, 0, v176
    v_mfma_f32_16x16x32_bf16 v[128:131], a[196:199], v[84:87], v[128:131]
    v_sub_f32 v210, 0, v176
    v_sub_f32 v211, 0, v176
    v_mfma_f32_16x16x32_bf16 v[128:131], a[200:203], v[88:91], v[128:131]
    v_sub_f32 v112, v112, v176
    v_sub_f32 v113, v113, v176
    v_mfma_f32_16x16x32_bf16 v[128:131], a[204:207], v[92:95], v[128:131]
    v_sub_f32 v114, v114, v176
    v_sub_f32 v115, v115, v176
    v_mfma_f32_16x16x32_bf16 v[132:135], a[220:223], v[92:95], 0
    v_sub_f32 v116, v116, v176
    v_sub_f32 v117, v117, v176
    v_mfma_f32_16x16x32_bf16 v[132:135], a[216:219], v[88:91], v[132:135]
    buffer_load_dwordx4 v29, s[16:19], s50 offen offset:1024 nt lds
    v_sub_f32 v118, v118, v176
    v_sub_f32 v119, v119, v176
    v_mfma_f32_16x16x32_bf16 v[132:135], a[212:215], v[84:87], v[132:135]
    v_exp_f32 v112, v112
    v_mfma_f32_16x16x32_bf16 v[132:135], a[208:211], v[80:83], v[132:135]
    v_exp_f32 v113, v113
    v_mfma_f32_16x16x32_bf16 v[140:143], a[208:211], v[96:99], 0
    v_exp_f32 v114, v114
    v_mfma_f32_16x16x32_bf16 v[140:143], a[212:215], v[100:103], v[140:143]
    v_exp_f32 v115, v115
    v_mfma_f32_16x16x32_bf16 v[140:143], a[216:219], v[104:107], v[140:143]
    v_exp_f32 v116, v116
    v_mfma_f32_16x16x32_bf16 v[140:143], a[220:223], v[108:111], v[140:143]
    v_exp_f32 v117, v117
    v_mfma_f32_16x16x32_bf16 v[136:139], a[204:207], v[108:111], 0
    v_exp_f32 v118, v118
    v_mfma_f32_16x16x32_bf16 v[136:139], a[200:203], v[104:107], v[136:139]
    buffer_load_dwordx4 v30, s[16:19], s50 offen offset:2048 nt lds
    v_exp_f32 v119, v119
    v_mfma_f32_16x16x32_bf16 v[136:139], a[196:199], v[100:103], v[136:139]
    v_cvt_pk_bf16_f32 v144, v112, v113
    v_cvt_pk_bf16_f32 v145, v114, v115
    v_mfma_f32_16x16x32_bf16 v[136:139], a[192:195], v[96:99], v[136:139]
    v_cvt_pk_bf16_f32 v146, v116, v117
    v_cvt_pk_bf16_f32 v147, v118, v119
    v_mfma_f32_16x16x32_bf16 v[112:115], a[224:227], v[48:51], v[208:211]
    v_max3_f32 v178, v120, v121, v122
    v_max3_f32 v179, v123, v124, v125
    v_mfma_f32_16x16x32_bf16 v[112:115], a[228:231], v[52:55], v[112:115]
    v_max3_f32 v178, v178, v126, v127
    v_max_f32 v178, v178, v179
    v_mfma_f32_16x16x32_bf16 v[112:115], a[232:235], v[56:59], v[112:115]
    v_mov_b32 v179, v178
    s_nop 1
    v_mfma_f32_16x16x32_bf16 v[112:115], a[236:239], v[60:63], v[112:115]
    v_permlane16_swap_b32 v178, v179
    v_max_f32 v178, v178, v179
    v_mfma_f32_16x16x32_bf16 v[116:119], a[252:255], v[60:63], v[208:211]
    v_mov_b32 v179, v178
    s_nop 1
    v_mfma_f32_16x16x32_bf16 v[116:119], a[248:251], v[56:59], v[116:119]
    buffer_load_dwordx4 v31, s[16:19], s50 offen offset:3072 nt lds
    v_permlane32_swap_b32 v178, v179
    v_max_f32 v178, v178, v179
    v_mfma_f32_16x16x32_bf16 v[116:119], a[244:247], v[52:55], v[116:119]
    v_sub_f32 v212, 0, v178
    v_sub_f32 v213, 0, v178
    v_mfma_f32_16x16x32_bf16 v[116:119], a[240:243], v[48:51], v[116:119]
    v_sub_f32 v214, 0, v178
    v_sub_f32 v215, 0, v178
    v_sub_f32 v120, v120, v178
    v_sub_f32 v121, v121, v178
    v_sub_f32 v122, v122, v178
    v_sub_f32 v123, v123, v178
    v_sub_f32 v124, v124, v178
    v_sub_f32 v125, v125, v178
    v_sub_f32 v126, v126, v178
    v_sub_f32 v127, v127, v178
    v_exp_f32 v120, v120
    v_exp_f32 v121, v121
    v_exp_f32 v122, v122
    v_exp_f32 v123, v123
    v_exp_f32 v124, v124
    v_exp_f32 v125, v125
    v_exp_f32 v126, v126
    v_exp_f32 v127, v127
    v_cvt_pk_bf16_f32 v148, v120, v121
    v_cvt_pk_bf16_f32 v149, v122, v123
    v_cvt_pk_bf16_f32 v150, v124, v125
    v_cvt_pk_bf16_f32 v151, v126, v127
    v_mfma_f32_16x16x32_bf16 v[124:127], a[240:243], v[64:67], v[212:215]
    v_max3_f32 v180, v128, v129, v130
    v_max3_f32 v181, v131, v132, v133
    v_mfma_f32_16x16x32_bf16 v[124:127], a[244:247], v[68:71], v[124:127]
    v_max3_f32 v180, v180, v134, v135
    v_max_f32 v180, v180, v181
    v_mfma_f32_16x16x32_bf16 v[124:127], a[248:251], v[72:75], v[124:127]
    v_mov_b32 v181, v180
    s_nop 1
    v_mfma_f32_16x16x32_bf16 v[124:127], a[252:255], v[76:79], v[124:127]
    v_permlane16_swap_b32 v180, v181
    v_max_f32 v180, v180, v181
    v_mfma_f32_16x16x32_bf16 v[120:123], a[236:239], v[76:79], v[212:215]
    v_mov_b32 v181, v180
    s_nop 1
    v_mfma_f32_16x16x32_bf16 v[120:123], a[232:235], v[72:75], v[120:123]
    s_add_u32 s50, s50, 16384
    v_permlane32_swap_b32 v180, v181
    v_max_f32 v180, v180, v181
    v_mfma_f32_16x16x32_bf16 v[120:123], a[228:231], v[68:71], v[120:123]
    v_sub_f32 v216, 0, v180
    v_sub_f32 v217, 0, v180
    v_mfma_f32_16x16x32_bf16 v[120:123], a[224:227], v[64:67], v[120:123]
    v_sub_f32 v218, 0, v180
    v_sub_f32 v219, 0, v180
    v_sub_f32 v128, v128, v180
    v_sub_f32 v129, v129, v180
    v_sub_f32 v130, v130, v180
    v_sub_f32 v131, v131, v180
    v_sub_f32 v132, v132, v180
    v_sub_f32 v133, v133, v180
    v_sub_f32 v134, v134, v180
    v_sub_f32 v135, v135, v180
    v_exp_f32 v128, v128
    v_exp_f32 v129, v129
    v_exp_f32 v130, v130
    v_exp_f32 v131, v131
    v_exp_f32 v132, v132
    v_exp_f32 v133, v133
    v_exp_f32 v134, v134
    v_exp_f32 v135, v135
    v_cvt_pk_bf16_f32 v152, v128, v129
    v_cvt_pk_bf16_f32 v153, v130, v131
    v_cvt_pk_bf16_f32 v154, v132, v133
    v_cvt_pk_bf16_f32 v155, v134, v135
    v_mfma_f32_16x16x32_bf16 v[128:131], a[224:227], v[80:83], v[216:219]
    v_max3_f32 v182, v136, v137, v138
    v_max3_f32 v183, v139, v140, v141
    v_mfma_f32_16x16x32_bf16 v[128:131], a[228:231], v[84:87], v[128:131]
    v_max3_f32 v182, v182, v142, v143
    v_max_f32 v182, v182, v183
    v_mfma_f32_16x16x32_bf16 v[128:131], a[232:235], v[88:91], v[128:131]
    v_mov_b32 v183, v182
    s_nop 1
    v_mfma_f32_16x16x32_bf16 v[128:131], a[236:239], v[92:95], v[128:131]
    v_permlane16_swap_b32 v182, v183
    v_max_f32 v182, v182, v183
    v_mfma_f32_16x16x32_bf16 v[132:135], a[252:255], v[92:95], v[216:219]
    v_mov_b32 v183, v182
    s_nop 1
    v_mfma_f32_16x16x32_bf16 v[132:135], a[248:251], v[88:91], v[132:135]
    v_permlane32_swap_b32 v182, v183
    v_max_f32 v182, v182, v183
    v_mfma_f32_16x16x32_bf16 v[132:135], a[244:247], v[84:87], v[132:135]
    v_add_f32 v182, s53, v182
    v_sub_f32 v220, 0, v182
    v_mfma_f32_16x16x32_bf16 v[132:135], a[240:243], v[80:83], v[132:135]
    v_sub_f32 v221, 0, v182
    v_sub_f32 v222, 0, v182
    v_sub_f32 v223, 0, v182
    v_sub_f32 v136, v136, v182
    v_sub_f32 v137, v137, v182
    v_sub_f32 v138, v138, v182
    v_sub_f32 v139, v139, v182
    v_sub_f32 v140, v140, v182
    v_sub_f32 v141, v141, v182
    v_sub_f32 v142, v142, v182
    v_sub_f32 v143, v143, v182
    v_exp_f32 v136, v136
    v_exp_f32 v137, v137
    v_exp_f32 v138, v138
    v_exp_f32 v139, v139
    v_exp_f32 v140, v140
    v_exp_f32 v141, v141
    v_exp_f32 v142, v142
    v_exp_f32 v143, v143
    v_cvt_pk_bf16_f32 v156, v136, v137
    v_cvt_pk_bf16_f32 v157, v138, v139
    v_cvt_pk_bf16_f32 v158, v140, v141
    v_cvt_pk_bf16_f32 v159, v142, v143
    v_mfma_f32_16x16x32_bf16 v[140:143], a[240:243], v[96:99], v[220:223]
    v_exp_f32 v112, v112
    v_mfma_f32_16x16x32_bf16 v[140:143], a[244:247], v[100:103], v[140:143]
    v_exp_f32 v113, v113
    v_mfma_f32_16x16x32_bf16 v[140:143], a[248:251], v[104:107], v[140:143]
    v_exp_f32 v114, v114
    v_mfma_f32_16x16x32_bf16 v[140:143], a[252:255], v[108:111], v[140:143]
    v_exp_f32 v115, v115
    v_mfma_f32_16x16x32_bf16 v[136:139], a[236:239], v[108:111], v[220:223]
    v_exp_f32 v116, v116
    v_mfma_f32_16x16x32_bf16 v[136:139], a[232:235], v[104:107], v[136:139]
    v_exp_f32 v117, v117
    v_mfma_f32_16x16x32_bf16 v[136:139], a[228:231], v[100:103], v[136:139]
    v_exp_f32 v118, v118
    v_mfma_f32_16x16x32_bf16 v[136:139], a[224:227], v[96:99], v[136:139]
    v_exp_f32 v119, v119
    v_cvt_pk_bf16_f32 v160, v112, v113
    v_cvt_pk_bf16_f32 v161, v114, v115
    v_cvt_pk_bf16_f32 v162, v116, v117
    v_cvt_pk_bf16_f32 v163, v118, v119
    v_exp_f32 v120, v120
    v_exp_f32 v121, v121
    v_exp_f32 v122, v122
    v_exp_f32 v123, v123
    v_exp_f32 v124, v124
    v_exp_f32 v125, v125
    v_exp_f32 v126, v126
    v_exp_f32 v127, v127
    v_cvt_pk_bf16_f32 v164, v120, v121
    v_cvt_pk_bf16_f32 v165, v122, v123
    v_cvt_pk_bf16_f32 v166, v124, v125
    v_cvt_pk_bf16_f32 v167, v126, v127
    v_exp_f32 v128, v128
    v_exp_f32 v129, v129
    v_exp_f32 v130, v130
    v_exp_f32 v131, v131
    v_exp_f32 v132, v132
    v_exp_f32 v133, v133
    v_exp_f32 v134, v134
    v_exp_f32 v135, v135
    v_cvt_pk_bf16_f32 v168, v128, v129
    v_cvt_pk_bf16_f32 v169, v130, v131
    v_cvt_pk_bf16_f32 v170, v132, v133
    v_cvt_pk_bf16_f32 v171, v134, v135
    v_exp_f32 v136, v136
    v_exp_f32 v137, v137
    v_exp_f32 v138, v138
    v_exp_f32 v139, v139
    v_exp_f32 v140, v140
    v_cvt_pk_bf16_f32 v172, v136, v137
    v_cvt_pk_bf16_f32 v173, v138, v139
    v_lshl_add_u32 v10, v9, 5, v10
    v_add_u32 v34, s96, v10
    v_add_u32 v38, 65536, v34
    v_add_u32 v42, s47, v10
    v_xor_b32 v35, 32, v34
    v_xor_b32 v36, 64, v34
    v_xor_b32 v37, 96, v34
    v_xor_b32 v39, 32, v38
    v_xor_b32 v40, 64, v38
    v_xor_b32 v41, 96, v38
    v_xor_b32 v43, 32, v42
    v_xor_b32 v44, 64, v42
    v_xor_b32 v45, 96, v42
    s_mov_b32 s51, 7
    s_branch L1_it2
.p2align 6
L1_loop:
    v_mfma_f32_16x16x32_bf16 v[112:115], a[128:131], v[48:51], v[208:211]
    v_exp_f32 v141, v141
    v_mfma_f32_16x16x32_bf16 v[112:115], a[132:135], v[52:55], v[112:115]
    ds_read_b64_tr_b16 a[160:161], v20 offset:49152
    v_cvt_pk_bf16_f32 v206, v140, v141
    v_mfma_f32_16x16x32_bf16 v[112:115], a[136:139], v[56:59], v[112:115]
    v_exp_f32 v142, v142
    v_mfma_f32_16x16x32_bf16 v[112:115], a[140:143], v[60:63], v[112:115]
    ds_read_b64_tr_b16 a[162:163], v20 offset:53248
    v_mfma_f32_16x16x32_bf16 v[116:119], a[156:159], v[60:63], v[208:211]
    v_exp_f32 v143, v143
    v_mfma_f32_16x16x32_bf16 v[116:119], a[152:155], v[56:59], v[116:119]
    ds_read_b64_tr_b16 a[164:165], v20 offset:57344
    v_cvt_pk_bf16_f32 v207, v142, v143
    v_mfma_f32_16x16x32_bf16 v[116:119], a[148:151], v[52:55], v[116:119]
    v_mfma_f32_16x16x32_bf16 v[116:119], a[144:147], v[48:51], v[116:119]
    ds_read_b64_tr_b16 a[166:167], v20 offset:61440
    v_mfma_f32_16x16x32_bf16 v[124:127], a[144:147], v[64:67], v[212:215]
    v_mfma_f32_16x16x32_bf16 v[124:127], a[148:151], v[68:71], v[124:127]
    ds_read_b64_tr_b16 a[168:169], v21 offset:49152
    v_mfma_f32_16x16x32_bf16 v[124:127], a[152:155], v[72:75], v[124:127]
    v_exp_f32 v112, v112
    v_mfma_f32_16x16x32_bf16 v[124:127], a[156:159], v[76:79], v[124:127]
    ds_read_b64_tr_b16 a[170:171], v21 offset:53248
    v_mfma_f32_16x16x32_bf16 v[120:123], a[140:143], v[76:79], v[212:215]
    v_exp_f32 v113, v113
    v_mfma_f32_16x16x32_bf16 v[120:123], a[136:139], v[72:75], v[120:123]
    ds_read_b64_tr_b16 a[172:173], v21 offset:57344
    v_cvt_pk_bf16_f32 v144, v112, v113
    v_mfma_f32_16x16x32_bf16 v[120:123], a[132:135], v[68:71], v[120:123]
    v_exp_f32 v114, v114
    v_mfma_f32_16x16x32_bf16 v[120:123], a[128:131], v[64:67], v[120:123]
    ds_read_b64_tr_b16 a[174:175], v21 offset:61440
    v_mfma_f32_16x16x32_bf16 v[128:131], a[128:131], v[80:83], v[216:219]
    v_exp_f32 v115, v115
    v_mfma_f32_16x16x32_bf16 v[128:131], a[132:135], v[84:87], v[128:131]
    ds_read_b64_tr_b16 a[176:177], v22 offset:49152
    v_cvt_pk_bf16_f32 v145, v114, v115
    v_mfma_f32_16x16x32_bf16 v[128:131], a[136:139], v[88:91], v[128:131]
    v_exp_f32 v116, v116
    v_mfma_f32_16x16x32_bf16 v[128:131], a[140:143], v[92:95], v[128:131]
    ds_read_b64_tr_b16 a[178:179], v22 offset:53248
    v_mfma_f32_16x16x32_bf16 v[132:135], a[156:159], v[92:95], v[216:219]
    v_exp_f32 v117, v117
    v_mfma_f32_16x16x32_bf16 v[132:135], a[152:155], v[88:91], v[132:135]
    ds_read_b64_tr_b16 a[180:181], v22 offset:57344
    v_cvt_pk_bf16_f32 v146, v116, v117
    v_mfma_f32_16x16x32_bf16 v[132:135], a[148:151], v[84:87], v[132:135]
    v_exp_f32 v118, v118
    v_mfma_f32_16x16x32_bf16 v[132:135], a[144:147], v[80:83], v[132:135]
    ds_read_b64_tr_b16 a[182:183], v22 offset:61440
    v_mfma_f32_16x16x32_bf16 v[140:143], a[144:147], v[96:99], v[220:223]
    v_exp_f32 v119, v119
    v_mfma_f32_16x16x32_bf16 v[140:143], a[148:151], v[100:103], v[140:143]
    ds_read_b64_tr_b16 a[184:185], v23 offset:49152
    v_cvt_pk_bf16_f32 v147, v118, v119
    v_mfma_f32_16x16x32_bf16 v[140:143], a[152:155], v[104:107], v[140:143]
    v_exp_f32 v120, v120
    v_mfma_f32_16x16x32_bf16 v[140:143], a[156:159], v[108:111], v[140:143]
    ds_read_b64_tr_b16 a[186:187], v23 offset:53248
    v_mfma_f32_16x16x32_bf16 v[136:139], a[140:143], v[108:111], v[220:223]
    v_exp_f32 v121, v121
    v_mfma_f32_16x16x32_bf16 v[136:139], a[136:139], v[104:107], v[136:139]
    ds_read_b64_tr_b16 a[188:189], v23 offset:57344
    v_cvt_pk_bf16_f32 v148, v120, v121
    v_mfma_f32_16x16x32_bf16 v[136:139], a[132:135], v[100:103], v[136:139]
    s_waitcnt lgkmcnt(2)
    v_exp_f32 v122, v122
    v_mfma_f32_16x16x32_bf16 v[136:139], a[128:131], v[96:99], v[136:139]
    ds_read_b64_tr_b16 a[190:191], v23 offset:61440
    v_mfma_f32_16x16x32_bf16 a[0:3], v[176:179], a[160:163], a[0:3]
    v_exp_f32 v123, v123
    v_mfma_f32_16x16x32_bf16 a[0:3], v[192:195], a[164:167], a[0:3]
    v_cvt_pk_bf16_f32 v149, v122, v123
    v_mfma_f32_16x16x32_bf16 a[32:35], v[196:199], a[164:167], a[32:35]
    v_exp_f32 v124, v124
    v_mfma_f32_16x16x32_bf16 a[32:35], v[180:183], a[160:163], a[32:35]
    v_mfma_f32_16x16x32_bf16 a[64:67], v[184:187], a[160:163], a[64:67]
    s_waitcnt lgkmcnt(0)
    v_exp_f32 v125, v125
    v_mfma_f32_16x16x32_bf16 a[64:67], v[200:203], a[164:167], a[64:67]
    v_cvt_pk_bf16_f32 v150, v124, v125
    v_mfma_f32_16x16x32_bf16 a[96:99], v[204:207], a[164:167], a[96:99]
    s_add_u32 m0, s96, 98304
    v_exp_f32 v126, v126
    v_mfma_f32_16x16x32_bf16 a[96:99], v[188:191], a[160:163], a[96:99]
    buffer_load_dwordx4 v32, s[20:23], s95 offen offset:0 nt lds
    v_mfma_f32_16x16x32_bf16 a[100:103], v[188:191], a[168:171], a[100:103]
    v_exp_f32 v127, v127
    v_mfma_f32_16x16x32_bf16 a[100:103], v[204:207], a[172:175], a[100:103]
    ds_read_b128 a[128:131], v16 offset:8192
    v_cvt_pk_bf16_f32 v151, v126, v127
    v_mfma_f32_16x16x32_bf16 a[68:71], v[200:203], a[172:175], a[68:71]
    v_exp_f32 v128, v128
    v_mfma_f32_16x16x32_bf16 a[68:71], v[184:187], a[168:171], a[68:71]
    ds_read_b128 a[132:135], v17 offset:8192
    v_mfma_f32_16x16x32_bf16 a[36:39], v[180:183], a[168:171], a[36:39]
    v_exp_f32 v129, v129
    v_mfma_f32_16x16x32_bf16 a[36:39], v[196:199], a[172:175], a[36:39]
    buffer_load_dwordx4 v33, s[20:23], s95 offen offset:1024 nt lds
    v_mfma_f32_16x16x32_bf16 a[4:7], v[192:195], a[172:175], a[4:7]
    v_exp_f32 v130, v130
    v_mfma_f32_16x16x32_bf16 a[4:7], v[176:179], a[168:171], a[4:7]
    ds_read_b128 a[136:139], v18 offset:8192
    v_cvt_pk_bf16_f32 v152, v128, v129
    v_mfma_f32_16x16x32_bf16 a[8:11], v[176:179], a[176:179], a[8:11]
    v_exp_f32 v131, v131
    v_mfma_f32_16x16x32_bf16 a[8:11], v[192:195], a[180:183], a[8:11]
    ds_read_b128 a[140:143], v19 offset:8192
    v_cvt_pk_bf16_f32 v153, v130, v131
    v_mfma_f32_16x16x32_bf16 a[40:43], v[196:199], a[180:183], a[40:43]
    v_exp_f32 v132, v132
    v_mfma_f32_16x16x32_bf16 a[40:43], v[180:183], a[176:179], a[40:43]
    buffer_load_dwordx4 v32, s[20:23], s95 offen offset:2048 nt lds
    v_mfma_f32_16x16x32_bf16 a[72:75], v[184:187], a[176:179], a[72:75]
    v_exp_f32 v133, v133
    v_mfma_f32_16x16x32_bf16 a[72:75], v[200:203], a[180:183], a[72:75]
    ds_read_b128 a[144:147], v16 offset:12288
    v_cvt_pk_bf16_f32 v154, v132, v133
    v_mfma_f32_16x16x32_bf16 a[104:107], v[204:207], a[180:183], a[104:107]
    v_exp_f32 v134, v134
    v_mfma_f32_16x16x32_bf16 a[104:107], v[188:191], a[176:179], a[104:107]
    ds_read_b128 a[148:151], v17 offset:12288
    v_mfma_f32_16x16x32_bf16 a[108:111], v[188:191], a[184:187], a[108:111]
    v_exp_f32 v135, v135
    v_mfma_f32_16x16x32_bf16 a[108:111], v[204:207], a[188:191], a[108:111]
    buffer_load_dwordx4 v33, s[20:23], s95 offen offset:3072 nt lds
    v_mfma_f32_16x16x32_bf16 a[76:79], v[200:203], a[188:191], a[76:79]
    s_add_u32 s95, s95, 16384
    v_exp_f32 v136, v136
    v_mfma_f32_16x16x32_bf16 a[76:79], v[184:187], a[184:187], a[76:79]
    ds_read_b128 a[152:155], v18 offset:12288
    v_cvt_pk_bf16_f32 v155, v134, v135
    v_mfma_f32_16x16x32_bf16 a[44:47], v[180:183], a[184:187], a[44:47]
    v_exp_f32 v137, v137
    v_mfma_f32_16x16x32_bf16 a[44:47], v[196:199], a[188:191], a[44:47]
    ds_read_b128 a[156:159], v19 offset:12288
    v_cvt_pk_bf16_f32 v156, v136, v137
    v_mfma_f32_16x16x32_bf16 a[12:15], v[192:195], a[188:191], a[12:15]
    v_exp_f32 v138, v138
    v_mfma_f32_16x16x32_bf16 a[12:15], v[176:179], a[184:187], a[12:15]
    v_mfma_f32_16x16x32_bf16 v[224:227], v[176:179], v[248:251], v[224:227]
    v_exp_f32 v139, v139
    v_mfma_f32_16x16x32_bf16 v[224:227], v[192:195], v[248:251], v[224:227]
    v_cvt_pk_bf16_f32 v157, v138, v139
    v_mfma_f32_16x16x32_bf16 v[228:231], v[196:199], v[248:251], v[228:231]
    v_exp_f32 v140, v140
    v_mfma_f32_16x16x32_bf16 v[228:231], v[180:183], v[248:251], v[228:231]
    s_waitcnt lgkmcnt(0)
    v_mfma_f32_16x16x32_bf16 v[112:115], a[128:131], v[48:51], v[208:211]
    v_exp_f32 v141, v141
    v_mfma_f32_16x16x32_bf16 v[112:115], a[132:135], v[52:55], v[112:115]
    ds_read_b64_tr_b16 a[160:161], v24 offset:49152
    v_cvt_pk_bf16_f32 v158, v140, v141
    v_mfma_f32_16x16x32_bf16 v[112:115], a[136:139], v[56:59], v[112:115]
    v_exp_f32 v142, v142
    v_mfma_f32_16x16x32_bf16 v[112:115], a[140:143], v[60:63], v[112:115]
    ds_read_b64_tr_b16 a[162:163], v24 offset:53248
    v_mfma_f32_16x16x32_bf16 v[116:119], a[156:159], v[60:63], v[208:211]
    v_exp_f32 v143, v143
    v_mfma_f32_16x16x32_bf16 v[116:119], a[152:155], v[56:59], v[116:119]
    ds_read_b64_tr_b16 a[164:165], v24 offset:57344
    v_cvt_pk_bf16_f32 v159, v142, v143
    v_mfma_f32_16x16x32_bf16 v[116:119], a[148:151], v[52:55], v[116:119]
    v_mfma_f32_16x16x32_bf16 v[116:119], a[144:147], v[48:51], v[116:119]
    ds_read_b64_tr_b16 a[166:167], v24 offset:61440
    v_mfma_f32_16x16x32_bf16 v[124:127], a[144:147], v[64:67], v[212:215]
    v_mfma_f32_16x16x32_bf16 v[124:127], a[148:151], v[68:71], v[124:127]
    ds_read_b64_tr_b16 a[168:169], v25 offset:49152
    v_mfma_f32_16x16x32_bf16 v[124:127], a[152:155], v[72:75], v[124:127]
    v_exp_f32 v112, v112
    v_mfma_f32_16x16x32_bf16 v[124:127], a[156:159], v[76:79], v[124:127]
    ds_read_b64_tr_b16 a[170:171], v25 offset:53248
    v_mfma_f32_16x16x32_bf16 v[120:123], a[140:143], v[76:79], v[212:215]
    v_exp_f32 v113, v113
    v_mfma_f32_16x16x32_bf16 v[120:123], a[136:139], v[72:75], v[120:123]
    ds_read_b64_tr_b16 a[172:173], v25 offset:57344
    v_cvt_pk_bf16_f32 v160, v112, v113
    v_mfma_f32_16x16x32_bf16 v[120:123], a[132:135], v[68:71], v[120:123]
    v_exp_f32 v114, v114
    v_mfma_f32_16x16x32_bf16 v[120:123], a[128:131], v[64:67], v[120:123]
    ds_read_b64_tr_b16 a[174:175], v25 offset:61440
    v_mfma_f32_16x16x32_bf16 v[128:131], a[128:131], v[80:83], v[216:219]
    v_exp_f32 v115, v115
    v_mfma_f32_16x16x32_bf16 v[128:131], a[132:135], v[84:87], v[128:131]
    ds_read_b64_tr_b16 a[176:177], v26 offset:49152
    v_cvt_pk_bf16_f32 v161, v114, v115
    v_mfma_f32_16x16x32_bf16 v[128:131], a[136:139], v[88:91], v[128:131]
    v_exp_f32 v116, v116
    v_mfma_f32_16x16x32_bf16 v[128:131], a[140:143], v[92:95], v[128:131]
    ds_read_b64_tr_b16 a[178:179], v26 offset:53248
    v_mfma_f32_16x16x32_bf16 v[132:135], a[156:159], v[92:95], v[216:219]
    v_exp_f32 v117, v117
    v_mfma_f32_16x16x32_bf16 v[132:135], a[152:155], v[88:91], v[132:135]
    ds_read_b64_tr_b16 a[180:181], v26 offset:57344
    v_cvt_pk_bf16_f32 v162, v116, v117
    v_mfma_f32_16x16x32_bf16 v[132:135], a[148:151], v[84:87], v[132:135]
    v_exp_f32 v118, v118
    v_mfma_f32_16x16x32_bf16 v[132:135], a[144:147], v[80:83], v[132:135]
    ds_read_b64_tr_b16 a[182:183], v26 offset:61440
    v_mfma_f32_16x16x32_bf16 v[140:143], a[144:147], v[96:99], v[220:223]
    v_exp_f32 v119, v119
    v_mfma_f32_16x16x32_bf16 v[140:143], a[148:151], v[100:103], v[140:143]
    ds_read_b64_tr_b16 a[184:185], v27 offset:49152
    v_cvt_pk_bf16_f32 v163, v118, v119
    v_mfma_f32_16x16x32_bf16 v[140:143], a[152:155], v[104:107], v[140:143]
    v_exp_f32 v120, v120
    v_mfma_f32_16x16x32_bf16 v[140:143], a[156:159], v[108:111], v[140:143]
    ds_read_b64_tr_b16 a[186:187], v27 offset:53248
    v_mfma_f32_16x16x32_bf16 v[136:139], a[140:143], v[108:111], v[220:223]
    v_exp_f32 v121, v121
    v_mfma_f32_16x16x32_bf16 v[136:139], a[136:139], v[104:107], v[136:139]
    ds_read_b64_tr_b16 a[188:189], v27 offset:57344
    v_cvt_pk_bf16_f32 v164, v120, v121
    v_mfma_f32_16x16x32_bf16 v[136:139], a[132:135], v[100:103], v[136:139]
    s_waitcnt lgkmcnt(2)
    v_exp_f32 v122, v122
    v_mfma_f32_16x16x32_bf16 v[136:139], a[128:131], v[96:99], v[136:139]
    ds_read_b64_tr_b16 a[190:191], v27 offset:61440
    v_mfma_f32_16x16x32_bf16 a[16:19], v[176:179], a[160:163], a[16:19]
    v_exp_f32 v123, v123
    v_mfma_f32_16x16x32_bf16 a[16:19], v[192:195], a[164:167], a[16:19]
    v_cvt_pk_bf16_f32 v165, v122, v123
    v_mfma_f32_16x16x32_bf16 a[48:51], v[196:199], a[164:167], a[48:51]
    v_exp_f32 v124, v124
    v_mfma_f32_16x16x32_bf16 a[48:51], v[180:183], a[160:163], a[48:51]
    v_mfma_f32_16x16x32_bf16 a[80:83], v[184:187], a[160:163], a[80:83]
    s_waitcnt vmcnt(16) lgkmcnt(0)
    v_exp_f32 v125, v125
    v_mfma_f32_16x16x32_bf16 a[80:83], v[200:203], a[164:167], a[80:83]
    s_barrier
    v_cvt_pk_bf16_f32 v166, v124, v125
    v_mfma_f32_16x16x32_bf16 a[112:115], v[204:207], a[164:167], a[112:115]
    s_add_u32 m0, s96, 0
    v_exp_f32 v126, v126
    v_mfma_f32_16x16x32_bf16 a[112:115], v[188:191], a[160:163], a[112:115]
    buffer_load_dwordx4 v28, s[16:19], s50 offen offset:0 nt lds
    v_mfma_f32_16x16x32_bf16 a[116:119], v[188:191], a[168:171], a[116:119]
    v_exp_f32 v127, v127
    v_mfma_f32_16x16x32_bf16 a[116:119], v[204:207], a[172:175], a[116:119]
    ds_read_b128 a[128:131], v16 offset:16384
    v_cvt_pk_bf16_f32 v167, v126, v127
    v_mfma_f32_16x16x32_bf16 a[84:87], v[200:203], a[172:175], a[84:87]
    v_exp_f32 v128, v128
    v_mfma_f32_16x16x32_bf16 a[84:87], v[184:187], a[168:171], a[84:87]
    ds_read_b128 a[132:135], v17 offset:16384
    v_mfma_f32_16x16x32_bf16 a[52:55], v[180:183], a[168:171], a[52:55]
    v_exp_f32 v129, v129
    v_mfma_f32_16x16x32_bf16 a[52:55], v[196:199], a[172:175], a[52:55]
    buffer_load_dwordx4 v29, s[16:19], s50 offen offset:1024 nt lds
    v_mfma_f32_16x16x32_bf16 a[20:23], v[192:195], a[172:175], a[20:23]
    v_exp_f32 v130, v130
    v_mfma_f32_16x16x32_bf16 a[20:23], v[176:179], a[168:171], a[20:23]
    ds_read_b128 a[136:139], v18 offset:16384
    v_cvt_pk_bf16_f32 v168, v128, v129
    v_mfma_f32_16x16x32_bf16 a[24:27], v[176:179], a[176:179], a[24:27]
    v_exp_f32 v131, v131
    v_mfma_f32_16x16x32_bf16 a[24:27], v[192:195], a[180:183], a[24:27]
    ds_read_b128 a[140:143], v19 offset:16384
    v_cvt_pk_bf16_f32 v169, v130, v131
    v_mfma_f32_16x16x32_bf16 a[56:59], v[196:199], a[180:183], a[56:59]
    v_exp_f32 v132, v132
    v_mfma_f32_16x16x32_bf16 a[56:59], v[180:183], a[176:179], a[56:59]
    buffer_load_dwordx4 v30, s[16:19], s50 offen offset:2048 nt lds
    v_mfma_f32_16x16x32_bf16 a[88:91], v[184:187], a[176:179], a[88:91]
    v_exp_f32 v133, v133
    v_mfma_f32_16x16x32_bf16 a[88:91], v[200:203], a[180:183], a[88:91]
    ds_read_b128 a[144:147], v16 offset:20480
    v_cvt_pk_bf16_f32 v170, v132, v133
    v_mfma_f32_16x16x32_bf16 a[120:123], v[204:207], a[180:183], a[120:123]
    v_exp_f32 v134, v134
    v_mfma_f32_16x16x32_bf16 a[120:123], v[188:191], a[176:179], a[120:123]
    ds_read_b128 a[148:151], v17 offset:20480
    v_mfma_f32_16x16x32_bf16 a[124:127], v[188:191], a[184:187], a[124:127]
    v_exp_f32 v135, v135
    v_mfma_f32_16x16x32_bf16 a[124:127], v[204:207], a[188:191], a[124:127]
    buffer_load_dwordx4 v31, s[16:19], s50 offen offset:3072 nt lds
    v_mfma_f32_16x16x32_bf16 a[92:95], v[200:203], a[188:191], a[92:95]
    s_add_u32 s50, s50, 16384
    v_exp_f32 v136, v136
    v_mfma_f32_16x16x32_bf16 a[92:95], v[184:187], a[184:187], a[92:95]
    ds_read_b128 a[152:155], v18 offset:20480
    v_cvt_pk_bf16_f32 v171, v134, v135
    v_mfma_f32_16x16x32_bf16 a[60:63], v[180:183], a[184:187], a[60:63]
    v_exp_f32 v137, v137
    v_mfma_f32_16x16x32_bf16 a[60:63], v[196:199], a[188:191], a[60:63]
    ds_read_b128 a[156:159], v19 offset:20480
    v_cvt_pk_bf16_f32 v172, v136, v137
    v_mfma_f32_16x16x32_bf16 a[28:31], v[192:195], a[188:191], a[28:31]
    v_exp_f32 v138, v138
    v_mfma_f32_16x16x32_bf16 a[28:31], v[176:179], a[184:187], a[28:31]
    v_mfma_f32_16x16x32_bf16 v[232:235], v[184:187], v[248:251], v[232:235]
    v_exp_f32 v139, v139
    v_mfma_f32_16x16x32_bf16 v[232:235], v[200:203], v[248:251], v[232:235]
    v_cvt_pk_bf16_f32 v173, v138, v139
    v_mfma_f32_16x16x32_bf16 v[236:239], v[204:207], v[248:251], v[236:239]
    v_exp_f32 v140, v140
    v_mfma_f32_16x16x32_bf16 v[236:239], v[188:191], v[248:251], v[236:239]
    s_waitcnt lgkmcnt(0)
L1_it2:
    v_mfma_f32_16x16x32_bf16 v[112:115], a[128:131], v[48:51], v[208:211]
    v_exp_f32 v141, v141
    v_mfma_f32_16x16x32_bf16 v[112:115], a[132:135], v[52:55], v[112:115]
    ds_read_b64_tr_b16 a[160:161], v20 offset:0
    v_cvt_pk_bf16_f32 v174, v140, v141
    v_mfma_f32_16x16x32_bf16 v[112:115], a[136:139], v[56:59], v[112:115]
    v_exp_f32 v142, v142
    v_mfma_f32_16x16x32_bf16 v[112:115], a[140:143], v[60:63], v[112:115]
    ds_read_b64_tr_b16 a[162:163], v20 offset:4096
    v_mfma_f32_16x16x32_bf16 v[116:119], a[156:159], v[60:63], v[208:211]
    v_exp_f32 v143, v143
    v_mfma_f32_16x16x32_bf16 v[116:119], a[152:155], v[56:59], v[116:119]
    ds_read_b64_tr_b16 a[164:165], v20 offset:8192
    v_cvt_pk_bf16_f32 v175, v142, v143
    v_mfma_f32_16x16x32_bf16 v[116:119], a[148:151], v[52:55], v[116:119]
    v_mfma_f32_16x16x32_bf16 v[116:119], a[144:147], v[48:51], v[116:119]
    ds_read_b64_tr_b16 a[166:167], v20 offset:12288
    v_mfma_f32_16x16x32_bf16 v[124:127], a[144:147], v[64:67], v[212:215]
    v_mfma_f32_16x16x32_bf16 v[124:127], a[148:151], v[68:71], v[124:127]
    ds_read_b64_tr_b16 a[168:169], v21 offset:0
    v_mfma_f32_16x16x32_bf16 v[124:127], a[152:155], v[72:75], v[124:127]
    v_exp_f32 v112, v112
    v_mfma_f32_16x16x32_bf16 v[124:127], a[156:159], v[76:79], v[124:127]
    ds_read_b64_tr_b16 a[170:171], v21 offset:4096
    v_mfma_f32_16x16x32_bf16 v[120:123], a[140:143], v[76:79], v[212:215]
    v_exp_f32 v113, v113
    v_mfma_f32_16x16x32_bf16 v[120:123], a[136:139], v[72:75], v[120:123]
    ds_read_b64_tr_b16 a[172:173], v21 offset:8192
    v_cvt_pk_bf16_f32 v176, v112, v113
    v_mfma_f32_16x16x32_bf16 v[120:123], a[132:135], v[68:71], v[120:123]
    v_exp_f32 v114, v114
    v_mfma_f32_16x16x32_bf16 v[120:123], a[128:131], v[64:67], v[120:123]
    ds_read_b64_tr_b16 a[174:175], v21 offset:12288
    v_mfma_f32_16x16x32_bf16 v[128:131], a[128:131], v[80:83], v[216:219]
    v_exp_f32 v115, v115
    v_mfma_f32_16x16x32_bf16 v[128:131], a[132:135], v[84:87], v[128:131]
    ds_read_b64_tr_b16 a[176:177], v22 offset:0
    v_cvt_pk_bf16_f32 v177, v114, v115
    v_mfma_f32_16x16x32_bf16 v[128:131], a[136:139], v[88:91], v[128:131]
    v_exp_f32 v116, v116
    v_mfma_f32_16x16x32_bf16 v[128:131], a[140:143], v[92:95], v[128:131]
    ds_read_b64_tr_b16 a[178:179], v22 offset:4096
    v_mfma_f32_16x16x32_bf16 v[132:135], a[156:159], v[92:95], v[216:219]
    v_exp_f32 v117, v117
    v_mfma_f32_16x16x32_bf16 v[132:135], a[152:155], v[88:91], v[132:135]
    ds_read_b64_tr_b16 a[180:181], v22 offset:8192
    v_cvt_pk_bf16_f32 v178, v116, v117
    v_mfma_f32_16x16x32_bf16 v[132:135], a[148:151], v[84:87], v[132:135]
    v_exp_f32 v118, v118
    v_mfma_f32_16x16x32_bf16 v[132:135], a[144:147], v[80:83], v[132:135]
    ds_read_b64_tr_b16 a[182:183], v22 offset:12288
    v_mfma_f32_16x16x32_bf16 v[140:143], a[144:147], v[96:99], v[220:223]
    v_exp_f32 v119, v119
    v_mfma_f32_16x16x32_bf16 v[140:143], a[148:151], v[100:103], v[140:143]
    ds_read_b64_tr_b16 a[184:185], v23 offset:0
    v_cvt_pk_bf16_f32 v179, v118, v119
    v_mfma_f32_16x16x32_bf16 v[140:143], a[152:155], v[104:107], v[140:143]
    v_exp_f32 v120, v120
    v_mfma_f32_16x16x32_bf16 v[140:143], a[156:159], v[108:111], v[140:143]
    ds_read_b64_tr_b16 a[186:187], v23 offset:4096
    v_mfma_f32_16x16x32_bf16 v[136:139], a[140:143], v[108:111], v[220:223]
    v_exp_f32 v121, v121
    v_mfma_f32_16x16x32_bf16 v[136:139], a[136:139], v[104:107], v[136:139]
    ds_read_b64_tr_b16 a[188:189], v23 offset:8192
    v_cvt_pk_bf16_f32 v180, v120, v121
    v_mfma_f32_16x16x32_bf16 v[136:139], a[132:135], v[100:103], v[136:139]
    s_waitcnt lgkmcnt(2)
    v_exp_f32 v122, v122
    v_mfma_f32_16x16x32_bf16 v[136:139], a[128:131], v[96:99], v[136:139]
    ds_read_b64_tr_b16 a[190:191], v23 offset:12288
    v_mfma_f32_16x16x32_bf16 a[0:3], v[144:147], a[160:163], a[0:3]
    v_exp_f32 v123, v123
    v_mfma_f32_16x16x32_bf16 a[0:3], v[160:163], a[164:167], a[0:3]
    v_cvt_pk_bf16_f32 v181, v122, v123
    v_mfma_f32_16x16x32_bf16 a[32:35], v[164:167], a[164:167], a[32:35]
    v_exp_f32 v124, v124
    v_mfma_f32_16x16x32_bf16 a[32:35], v[148:151], a[160:163], a[32:35]
    v_mfma_f32_16x16x32_bf16 a[64:67], v[152:155], a[160:163], a[64:67]
    s_waitcnt lgkmcnt(0)
    v_exp_f32 v125, v125
    v_mfma_f32_16x16x32_bf16 a[64:67], v[168:171], a[164:167], a[64:67]
    v_cvt_pk_bf16_f32 v182, v124, v125
    v_mfma_f32_16x16x32_bf16 a[96:99], v[172:175], a[164:167], a[96:99]
    s_add_u32 m0, s96, 114688
    v_exp_f32 v126, v126
    v_mfma_f32_16x16x32_bf16 a[96:99], v[156:159], a[160:163], a[96:99]
    buffer_load_dwordx4 v32, s[20:23], s95 offen offset:0 nt lds
    v_mfma_f32_16x16x32_bf16 a[100:103], v[156:159], a[168:171], a[100:103]
    v_exp_f32 v127, v127
    v_mfma_f32_16x16x32_bf16 a[100:103], v[172:175], a[172:175], a[100:103]
    ds_read_b128 a[128:131], v16 offset:24576
    v_cvt_pk_bf16_f32 v183, v126, v127
    v_mfma_f32_16x16x32_bf16 a[68:71], v[168:171], a[172:175], a[68:71]
    v_exp_f32 v128, v128
    v_mfma_f32_16x16x32_bf16 a[68:71], v[152:155], a[168:171], a[68:71]
    ds_read_b128 a[132:135], v17 offset:24576
    v_mfma_f32_16x16x32_bf16 a[36:39], v[148:151], a[168:171], a[36:39]
    v_exp_f32 v129, v129
    v_mfma_f32_16x16x32_bf16 a[36:39], v[164:167], a[172:175], a[36:39]
    buffer_load_dwordx4 v33, s[20:23], s95 offen offset:1024 nt lds
    v_mfma_f32_16x16x32_bf16 a[4:7], v[160:163], a[172:175], a[4:7]
    v_exp_f32 v130, v130
    v_mfma_f32_16x16x32_bf16 a[4:7], v[144:147], a[168:171], a[4:7]
    ds_read_b128 a[136:139], v18 offset:24576
    v_cvt_pk_bf16_f32 v184, v128, v129
    v_mfma_f32_16x16x32_bf16 a[8:11], v[144:147], a[176:179], a[8:11]
    v_exp_f32 v131, v131
    v_mfma_f32_16x16x32_bf16 a[8:11], v[160:163], a[180:183], a[8:11]
    ds_read_b128 a[140:143], v19 offset:24576
    v_cvt_pk_bf16_f32 v185, v130, v131
    v_mfma_f32_16x16x32_bf16 a[40:43], v[164:167], a[180:183], a[40:43]
    v_exp_f32 v132, v132
    v_mfma_f32_16x16x32_bf16 a[40:43], v[148:151], a[176:179], a[40:43]
    buffer_load_dwordx4 v32, s[20:23], s95 offen offset:2048 nt lds
    v_mfma_f32_16x16x32_bf16 a[72:75], v[152:155], a[176:179], a[72:75]
    v_exp_f32 v133, v133
    v_mfma_f32_16x16x32_bf16 a[72:75], v[168:171], a[180:183], a[72:75]
    ds_read_b128 a[144:147], v16 offset:28672
    v_cvt_pk_bf16_f32 v186, v132, v133
    v_mfma_f32_16x16x32_bf16 a[104:107], v[172:175], a[180:183], a[104:107]
    v_exp_f32 v134, v134
    v_mfma_f32_16x16x32_bf16 a[104:107], v[156:159], a[176:179], a[104:107]
    ds_read_b128 a[148:151], v17 offset:28672
    v_mfma_f32_16x16x32_bf16 a[108:111], v[156:159], a[184:187], a[108:111]
    v_exp_f32 v135, v135
    v_mfma_f32_16x16x32_bf16 a[108:111], v[172:175], a[188:191], a[108:111]
    buffer_load_dwordx4 v33, s[20:23], s95 offen offset:3072 nt lds
    v_mfma_f32_16x16x32_bf16 a[76:79], v[168:171], a[188:191], a[76:79]
    s_add_u32 s95, s95, 16384
    v_exp_f32 v136, v136
    v_mfma_f32_16x16x32_bf16 a[76:79], v[152:155], a[184:187], a[76:79]
    ds_read_b128 a[152:155], v18 offset:28672
    v_cvt_pk_bf16_f32 v187, v134, v135
    v_mfma_f32_16x16x32_bf16 a[44:47], v[148:151], a[184:187], a[44:47]
    v_exp_f32 v137, v137
    v_mfma_f32_16x16x32_bf16 a[44:47], v[164:167], a[188:191], a[44:47]
    ds_read_b128 a[156:159], v19 offset:28672
    v_cvt_pk_bf16_f32 v188, v136, v137
    v_mfma_f32_16x16x32_bf16 a[12:15], v[160:163], a[188:191], a[12:15]
    v_exp_f32 v138, v138
    v_mfma_f32_16x16x32_bf16 a[12:15], v[144:147], a[184:187], a[12:15]
    v_mfma_f32_16x16x32_bf16 v[224:227], v[144:147], v[248:251], v[224:227]
    v_exp_f32 v139, v139
    v_mfma_f32_16x16x32_bf16 v[224:227], v[160:163], v[248:251], v[224:227]
    v_cvt_pk_bf16_f32 v189, v138, v139
    v_mfma_f32_16x16x32_bf16 v[228:231], v[164:167], v[248:251], v[228:231]
    v_exp_f32 v140, v140
    v_mfma_f32_16x16x32_bf16 v[228:231], v[148:151], v[248:251], v[228:231]
    s_waitcnt lgkmcnt(0)
    v_mfma_f32_16x16x32_bf16 v[112:115], a[128:131], v[48:51], v[208:211]
    v_exp_f32 v141, v141
    v_mfma_f32_16x16x32_bf16 v[112:115], a[132:135], v[52:55], v[112:115]
    ds_read_b64_tr_b16 a[160:161], v24 offset:0
    v_cvt_pk_bf16_f32 v190, v140, v141
    v_mfma_f32_16x16x32_bf16 v[112:115], a[136:139], v[56:59], v[112:115]
    v_exp_f32 v142, v142
    v_mfma_f32_16x16x32_bf16 v[112:115], a[140:143], v[60:63], v[112:115]
    ds_read_b64_tr_b16 a[162:163], v24 offset:4096
    v_mfma_f32_16x16x32_bf16 v[116:119], a[156:159], v[60:63], v[208:211]
    v_exp_f32 v143, v143
    v_mfma_f32_16x16x32_bf16 v[116:119], a[152:155], v[56:59], v[116:119]
    ds_read_b64_tr_b16 a[164:165], v24 offset:8192
    v_cvt_pk_bf16_f32 v191, v142, v143
    v_mfma_f32_16x16x32_bf16 v[116:119], a[148:151], v[52:55], v[116:119]
    v_mfma_f32_16x16x32_bf16 v[116:119], a[144:147], v[48:51], v[116:119]
    ds_read_b64_tr_b16 a[166:167], v24 offset:12288
    v_mfma_f32_16x16x32_bf16 v[124:127], a[144:147], v[64:67], v[212:215]
    v_mfma_f32_16x16x32_bf16 v[124:127], a[148:151], v[68:71], v[124:127]
    ds_read_b64_tr_b16 a[168:169], v25 offset:0
    v_mfma_f32_16x16x32_bf16 v[124:127], a[152:155], v[72:75], v[124:127]
    v_exp_f32 v112, v112
    v_mfma_f32_16x16x32_bf16 v[124:127], a[156:159], v[76:79], v[124:127]
    ds_read_b64_tr_b16 a[170:171], v25 offset:4096
    v_mfma_f32_16x16x32_bf16 v[120:123], a[140:143], v[76:79], v[212:215]
    v_exp_f32 v113, v113
    v_mfma_f32_16x16x32_bf16 v[120:123], a[136:139], v[72:75], v[120:123]
    ds_read_b64_tr_b16 a[172:173], v25 offset:8192
    v_cvt_pk_bf16_f32 v192, v112, v113
    v_mfma_f32_16x16x32_bf16 v[120:123], a[132:135], v[68:71], v[120:123]
    v_exp_f32 v114, v114
    v_mfma_f32_16x16x32_bf16 v[120:123], a[128:131], v[64:67], v[120:123]
    ds_read_b64_tr_b16 a[174:175], v25 offset:12288
    v_mfma_f32_16x16x32_bf16 v[128:131], a[128:131], v[80:83], v[216:219]
    v_exp_f32 v115, v115
    v_mfma_f32_16x16x32_bf16 v[128:131], a[132:135], v[84:87], v[128:131]
    ds_read_b64_tr_b16 a[176:177], v26 offset:0
    v_cvt_pk_bf16_f32 v193, v114, v115
    v_mfma_f32_16x16x32_bf16 v[128:131], a[136:139], v[88:91], v[128:131]
    v_exp_f32 v116, v116
    v_mfma_f32_16x16x32_bf16 v[128:131], a[140:143], v[92:95], v[128:131]
    ds_read_b64_tr_b16 a[178:179], v26 offset:4096
    v_mfma_f32_16x16x32_bf16 v[132:135], a[156:159], v[92:95], v[216:219]
    v_exp_f32 v117, v117
    v_mfma_f32_16x16x32_bf16 v[132:135], a[152:155], v[88:91], v[132:135]
    ds_read_b64_tr_b16 a[180:181], v26 offset:8192
    v_cvt_pk_bf16_f32 v194, v116, v117
    v_mfma_f32_16x16x32_bf16 v[132:135], a[148:151], v[84:87], v[132:135]
    v_exp_f32 v118, v118
    v_mfma_f32_16x16x32_bf16 v[132:135], a[144:147], v[80:83], v[132:135]
    ds_read_b64_tr_b16 a[182:183], v26 offset:12288
    v_mfma_f32_16x16x32_bf16 v[140:143], a[144:147], v[96:99], v[220:223]
    v_exp_f32 v119, v119
    v_mfma_f32_16x16x32_bf16 v[140:143], a[148:151], v[100:103], v[140:143]
    ds_read_b64_tr_b16 a[184:185], v27 offset:0
    v_cvt_pk_bf16_f32 v195, v118, v119
    v_mfma_f32_16x16x32_bf16 v[140:143], a[152:155], v[104:107], v[140:143]
    v_exp_f32 v120, v120
    v_mfma_f32_16x16x32_bf16 v[140:143], a[156:159], v[108:111], v[140:143]
    ds_read_b64_tr_b16 a[186:187], v27 offset:4096
    v_mfma_f32_16x16x32_bf16 v[136:139], a[140:143], v[108:111], v[220:223]
    v_exp_f32 v121, v121
    v_mfma_f32_16x16x32_bf16 v[136:139], a[136:139], v[104:107], v[136:139]
    ds_read_b64_tr_b16 a[188:189], v27 offset:8192
    v_cvt_pk_bf16_f32 v196, v120, v121
    v_mfma_f32_16x16x32_bf16 v[136:139], a[132:135], v[100:103], v[136:139]
    s_waitcnt lgkmcnt(2)
    v_exp_f32 v122, v122
    v_mfma_f32_16x16x32_bf16 v[136:139], a[128:131], v[96:99], v[136:139]
    ds_read_b64_tr_b16 a[190:191], v27 offset:12288
    v_mfma_f32_16x16x32_bf16 a[16:19], v[144:147], a[160:163], a[16:19]
    v_exp_f32 v123, v123
    v_mfma_f32_16x16x32_bf16 a[16:19], v[160:163], a[164:167], a[16:19]
    v_cvt_pk_bf16_f32 v197, v122, v123
    v_mfma_f32_16x16x32_bf16 a[48:51], v[164:167], a[164:167], a[48:51]
    v_exp_f32 v124, v124
    v_mfma_f32_16x16x32_bf16 a[48:51], v[148:151], a[160:163], a[48:51]
    v_mfma_f32_16x16x32_bf16 a[80:83], v[152:155], a[160:163], a[80:83]
    s_waitcnt vmcnt(16) lgkmcnt(0)
    v_exp_f32 v125, v125
    v_mfma_f32_16x16x32_bf16 a[80:83], v[168:171], a[164:167], a[80:83]
    s_barrier
    v_cvt_pk_bf16_f32 v198, v124, v125
    v_mfma_f32_16x16x32_bf16 a[112:115], v[172:175], a[164:167], a[112:115]
    s_add_u32 m0, s96, 16384
    v_exp_f32 v126, v126
    v_mfma_f32_16x16x32_bf16 a[112:115], v[156:159], a[160:163], a[112:115]
    buffer_load_dwordx4 v28, s[16:19], s50 offen offset:0 nt lds
    v_mfma_f32_16x16x32_bf16 a[116:119], v[156:159], a[168:171], a[116:119]
    v_exp_f32 v127, v127
    v_mfma_f32_16x16x32_bf16 a[116:119], v[172:175], a[172:175], a[116:119]
    ds_read_b128 a[128:131], v16 offset:32768
    v_cvt_pk_bf16_f32 v199, v126, v127
    v_mfma_f32_16x16x32_bf16 a[84:87], v[168:171], a[172:175], a[84:87]
    v_exp_f32 v128, v128
    v_mfma_f32_16x16x32_bf16 a[84:87], v[152:155], a[168:171], a[84:87]
    ds_read_b128 a[132:135], v17 offset:32768
    v_mfma_f32_16x16x32_bf16 a[52:55], v[148:151], a[168:171], a[52:55]
    v_exp_f32 v129, v129
    v_mfma_f32_16x16x32_bf16 a[52:55], v[164:167], a[172:175], a[52:55]
    buffer_load_dwordx4 v29, s[16:19], s50 offen offset:1024 nt lds
    v_mfma_f32_16x16x32_bf16 a[20:23], v[160:163], a[172:175], a[20:23]
    v_exp_f32 v130, v130
    v_mfma_f32_16x16x32_bf16 a[20:23], v[144:147], a[168:171], a[20:23]
    ds_read_b128 a[136:139], v18 offset:32768
    v_cvt_pk_bf16_f32 v200, v128, v129
    v_mfma_f32_16x16x32_bf16 a[24:27], v[144:147], a[176:179], a[24:27]
    v_exp_f32 v131, v131
    v_mfma_f32_16x16x32_bf16 a[24:27], v[160:163], a[180:183], a[24:27]
    ds_read_b128 a[140:143], v19 offset:32768
    v_cvt_pk_bf16_f32 v201, v130, v131
    v_mfma_f32_16x16x32_bf16 a[56:59], v[164:167], a[180:183], a[56:59]
    v_exp_f32 v132, v132
    v_mfma_f32_16x16x32_bf16 a[56:59], v[148:151], a[176:179], a[56:59]
    buffer_load_dwordx4 v30, s[16:19], s50 offen offset:2048 nt lds
    v_mfma_f32_16x16x32_bf16 a[88:91], v[152:155], a[176:179], a[88:91]
    v_exp_f32 v133, v133
    v_mfma_f32_16x16x32_bf16 a[88:91], v[168:171], a[180:183], a[88:91]
    ds_read_b128 a[144:147], v16 offset:36864
    v_cvt_pk_bf16_f32 v202, v132, v133
    v_mfma_f32_16x16x32_bf16 a[120:123], v[172:175], a[180:183], a[120:123]
    v_exp_f32 v134, v134
    v_mfma_f32_16x16x32_bf16 a[120:123], v[156:159], a[176:179], a[120:123]
    ds_read_b128 a[148:151], v17 offset:36864
    v_mfma_f32_16x16x32_bf16 a[124:127], v[156:159], a[184:187], a[124:127]
    v_exp_f32 v135, v135
    v_mfma_f32_16x16x32_bf16 a[124:127], v[172:175], a[188:191], a[124:127]
    buffer_load_dwordx4 v31, s[16:19], s50 offen offset:3072 nt lds
    v_mfma_f32_16x16x32_bf16 a[92:95], v[168:171], a[188:191], a[92:95]
    s_add_u32 s50, s50, 16384
    v_exp_f32 v136, v136
    v_mfma_f32_16x16x32_bf16 a[92:95], v[152:155], a[184:187], a[92:95]
    ds_read_b128 a[152:155], v18 offset:36864
    v_cvt_pk_bf16_f32 v203, v134, v135
    v_mfma_f32_16x16x32_bf16 a[60:63], v[148:151], a[184:187], a[60:63]
    v_exp_f32 v137, v137
    v_mfma_f32_16x16x32_bf16 a[60:63], v[164:167], a[188:191], a[60:63]
    ds_read_b128 a[156:159], v19 offset:36864
    v_cvt_pk_bf16_f32 v204, v136, v137
    v_mfma_f32_16x16x32_bf16 a[28:31], v[160:163], a[188:191], a[28:31]
    v_exp_f32 v138, v138
    v_mfma_f32_16x16x32_bf16 a[28:31], v[144:147], a[184:187], a[28:31]
    v_mfma_f32_16x16x32_bf16 v[232:235], v[152:155], v[248:251], v[232:235]
    v_exp_f32 v139, v139
    v_mfma_f32_16x16x32_bf16 v[232:235], v[168:171], v[248:251], v[232:235]
    global_load_dword v6, v[12:13], off
    v_cvt_pk_bf16_f32 v205, v138, v139
    v_mfma_f32_16x16x32_bf16 v[236:239], v[172:175], v[248:251], v[236:239]
    v_exp_f32 v140, v140
    v_mfma_f32_16x16x32_bf16 v[236:239], v[156:159], v[248:251], v[236:239]
    s_waitcnt lgkmcnt(0)
    v_mfma_f32_16x16x32_bf16 v[112:115], a[128:131], v[48:51], v[208:211]
    v_exp_f32 v141, v141
    v_mfma_f32_16x16x32_bf16 v[112:115], a[132:135], v[52:55], v[112:115]
    ds_read_b64_tr_b16 a[160:161], v20 offset:16384
    v_cvt_pk_bf16_f32 v206, v140, v141
    v_mfma_f32_16x16x32_bf16 v[112:115], a[136:139], v[56:59], v[112:115]
    v_exp_f32 v142, v142
    v_mfma_f32_16x16x32_bf16 v[112:115], a[140:143], v[60:63], v[112:115]
    ds_read_b64_tr_b16 a[162:163], v20 offset:20480
    v_mfma_f32_16x16x32_bf16 v[116:119], a[156:159], v[60:63], v[208:211]
    v_exp_f32 v143, v143
    v_mfma_f32_16x16x32_bf16 v[116:119], a[152:155], v[56:59], v[116:119]
    ds_read_b64_tr_b16 a[164:165], v20 offset:24576
    v_cvt_pk_bf16_f32 v207, v142, v143
    v_mfma_f32_16x16x32_bf16 v[116:119], a[148:151], v[52:55], v[116:119]
    v_mfma_f32_16x16x32_bf16 v[116:119], a[144:147], v[48:51], v[116:119]
    ds_read_b64_tr_b16 a[166:167], v20 offset:28672
    v_mfma_f32_16x16x32_bf16 v[124:127], a[144:147], v[64:67], v[212:215]
    v_mfma_f32_16x16x32_bf16 v[124:127], a[148:151], v[68:71], v[124:127]
    ds_read_b64_tr_b16 a[168:169], v21 offset:16384
    v_mfma_f32_16x16x32_bf16 v[124:127], a[152:155], v[72:75], v[124:127]
    v_exp_f32 v112, v112
    v_mfma_f32_16x16x32_bf16 v[124:127], a[156:159], v[76:79], v[124:127]
    ds_read_b64_tr_b16 a[170:171], v21 offset:20480
    v_mfma_f32_16x16x32_bf16 v[120:123], a[140:143], v[76:79], v[212:215]
    v_exp_f32 v113, v113
    v_mfma_f32_16x16x32_bf16 v[120:123], a[136:139], v[72:75], v[120:123]
    ds_read_b64_tr_b16 a[172:173], v21 offset:24576
    v_cvt_pk_bf16_f32 v144, v112, v113
    v_mfma_f32_16x16x32_bf16 v[120:123], a[132:135], v[68:71], v[120:123]
    v_exp_f32 v114, v114
    v_mfma_f32_16x16x32_bf16 v[120:123], a[128:131], v[64:67], v[120:123]
    ds_read_b64_tr_b16 a[174:175], v21 offset:28672
    v_mfma_f32_16x16x32_bf16 v[128:131], a[128:131], v[80:83], v[216:219]
    v_exp_f32 v115, v115
    v_mfma_f32_16x16x32_bf16 v[128:131], a[132:135], v[84:87], v[128:131]
    ds_read_b64_tr_b16 a[176:177], v22 offset:16384
    v_cvt_pk_bf16_f32 v145, v114, v115
    v_mfma_f32_16x16x32_bf16 v[128:131], a[136:139], v[88:91], v[128:131]
    v_exp_f32 v116, v116
    v_mfma_f32_16x16x32_bf16 v[128:131], a[140:143], v[92:95], v[128:131]
    ds_read_b64_tr_b16 a[178:179], v22 offset:20480
    v_mfma_f32_16x16x32_bf16 v[132:135], a[156:159], v[92:95], v[216:219]
    v_exp_f32 v117, v117
    v_mfma_f32_16x16x32_bf16 v[132:135], a[152:155], v[88:91], v[132:135]
    ds_read_b64_tr_b16 a[180:181], v22 offset:24576
    v_cvt_pk_bf16_f32 v146, v116, v117
    v_mfma_f32_16x16x32_bf16 v[132:135], a[148:151], v[84:87], v[132:135]
    v_exp_f32 v118, v118
    v_mfma_f32_16x16x32_bf16 v[132:135], a[144:147], v[80:83], v[132:135]
    ds_read_b64_tr_b16 a[182:183], v22 offset:28672
    v_mfma_f32_16x16x32_bf16 v[140:143], a[144:147], v[96:99], v[220:223]
    v_exp_f32 v119, v119
    v_mfma_f32_16x16x32_bf16 v[140:143], a[148:151], v[100:103], v[140:143]
    ds_read_b64_tr_b16 a[184:185], v23 offset:16384
    v_cvt_pk_bf16_f32 v147, v118, v119
    v_mfma_f32_16x16x32_bf16 v[140:143], a[152:155], v[104:107], v[140:143]
    v_exp_f32 v120, v120
    v_mfma_f32_16x16x32_bf16 v[140:143], a[156:159], v[108:111], v[140:143]
    ds_read_b64_tr_b16 a[186:187], v23 offset:20480
    v_mfma_f32_16x16x32_bf16 v[136:139], a[140:143], v[108:111], v[220:223]
    v_exp_f32 v121, v121
    v_mfma_f32_16x16x32_bf16 v[136:139], a[136:139], v[104:107], v[136:139]
    ds_read_b64_tr_b16 a[188:189], v23 offset:24576
    v_cvt_pk_bf16_f32 v148, v120, v121
    v_mfma_f32_16x16x32_bf16 v[136:139], a[132:135], v[100:103], v[136:139]
    s_waitcnt lgkmcnt(2)
    v_exp_f32 v122, v122
    v_mfma_f32_16x16x32_bf16 v[136:139], a[128:131], v[96:99], v[136:139]
    ds_read_b64_tr_b16 a[190:191], v23 offset:28672
    v_mfma_f32_16x16x32_bf16 a[0:3], v[176:179], a[160:163], a[0:3]
    v_exp_f32 v123, v123
    v_mfma_f32_16x16x32_bf16 a[0:3], v[192:195], a[164:167], a[0:3]
    v_cvt_pk_bf16_f32 v149, v122, v123
    v_mfma_f32_16x16x32_bf16 a[32:35], v[196:199], a[164:167], a[32:35]
    v_exp_f32 v124, v124
    v_mfma_f32_16x16x32_bf16 a[32:35], v[180:183], a[160:163], a[32:35]
    v_mfma_f32_16x16x32_bf16 a[64:67], v[184:187], a[160:163], a[64:67]
    s_waitcnt lgkmcnt(0)
    v_exp_f32 v125, v125
    v_mfma_f32_16x16x32_bf16 a[64:67], v[200:203], a[164:167], a[64:67]
    v_cvt_pk_bf16_f32 v150, v124, v125
    v_mfma_f32_16x16x32_bf16 a[96:99], v[204:207], a[164:167], a[96:99]
    s_add_u32 m0, s96, 65536
    v_exp_f32 v126, v126
    v_mfma_f32_16x16x32_bf16 a[96:99], v[188:191], a[160:163], a[96:99]
    buffer_load_dwordx4 v32, s[20:23], s95 offen offset:0 nt lds
    v_mfma_f32_16x16x32_bf16 a[100:103], v[188:191], a[168:171], a[100:103]
    v_exp_f32 v127, v127
    v_mfma_f32_16x16x32_bf16 a[100:103], v[204:207], a[172:175], a[100:103]
    ds_read_b128 a[128:131], v16 offset:40960
    v_cvt_pk_bf16_f32 v151, v126, v127
    v_mfma_f32_16x16x32_bf16 a[68:71], v[200:203], a[172:175], a[68:71]
    v_exp_f32 v128, v128
    v_mfma_f32_16x16x32_bf16 a[68:71], v[184:187], a[168:171], a[68:71]
    ds_read_b128 a[132:135], v17 offset:40960
    v_mfma_f32_16x16x32_bf16 a[36:39], v[180:183], a[168:171], a[36:39]
    v_exp_f32 v129, v129
    v_mfma_f32_16x16x32_bf16 a[36:39], v[196:199], a[172:175], a[36:39]
    buffer_load_dwordx4 v33, s[20:23], s95 offen offset:1024 nt lds
    v_mfma_f32_16x16x32_bf16 a[4:7], v[192:195], a[172:175], a[4:7]
    v_exp_f32 v130, v130
    v_mfma_f32_16x16x32_bf16 a[4:7], v[176:179], a[168:171], a[4:7]
    ds_read_b128 a[136:139], v18 offset:40960
    v_cvt_pk_bf16_f32 v152, v128, v129
    v_mfma_f32_16x16x32_bf16 a[8:11], v[176:179], a[176:179], a[8:11]
    v_exp_f32 v131, v131
    v_mfma_f32_16x16x32_bf16 a[8:11], v[192:195], a[180:183], a[8:11]
    ds_read_b128 a[140:143], v19 offset:40960
    v_cvt_pk_bf16_f32 v153, v130, v131
    v_mfma_f32_16x16x32_bf16 a[40:43], v[196:199], a[180:183], a[40:43]
    v_exp_f32 v132, v132
    v_mfma_f32_16x16x32_bf16 a[40:43], v[180:183], a[176:179], a[40:43]
    buffer_load_dwordx4 v32, s[20:23], s95 offen offset:2048 nt lds
    v_mfma_f32_16x16x32_bf16 a[72:75], v[184:187], a[176:179], a[72:75]
    v_exp_f32 v133, v133
    v_mfma_f32_16x16x32_bf16 a[72:75], v[200:203], a[180:183], a[72:75]
    ds_read_b128 a[144:147], v16 offset:45056
    v_cvt_pk_bf16_f32 v154, v132, v133
    v_mfma_f32_16x16x32_bf16 a[104:107], v[204:207], a[180:183], a[104:107]
    v_exp_f32 v134, v134
    v_mfma_f32_16x16x32_bf16 a[104:107], v[188:191], a[176:179], a[104:107]
    ds_read_b128 a[148:151], v17 offset:45056
    v_mfma_f32_16x16x32_bf16 a[108:111], v[188:191], a[184:187], a[108:111]
    v_exp_f32 v135, v135
    v_mfma_f32_16x16x32_bf16 a[108:111], v[204:207], a[188:191], a[108:111]
    buffer_load_dwordx4 v33, s[20:23], s95 offen offset:3072 nt lds
    v_mfma_f32_16x16x32_bf16 a[76:79], v[200:203], a[188:191], a[76:79]
    s_add_u32 s95, s95, 16384
    v_exp_f32 v136, v136
    v_mfma_f32_16x16x32_bf16 a[76:79], v[184:187], a[184:187], a[76:79]
    ds_read_b128 a[152:155], v18 offset:45056
    v_cvt_pk_bf16_f32 v155, v134, v135
    v_mfma_f32_16x16x32_bf16 a[44:47], v[180:183], a[184:187], a[44:47]
    v_exp_f32 v137, v137
    v_mfma_f32_16x16x32_bf16 a[44:47], v[196:199], a[188:191], a[44:47]
    ds_read_b128 a[156:159], v19 offset:45056
    v_cvt_pk_bf16_f32 v156, v136, v137
    v_mfma_f32_16x16x32_bf16 a[12:15], v[192:195], a[188:191], a[12:15]
    v_exp_f32 v138, v138
    v_mfma_f32_16x16x32_bf16 a[12:15], v[176:179], a[184:187], a[12:15]
    v_mfma_f32_16x16x32_bf16 v[224:227], v[176:179], v[248:251], v[224:227]
    v_exp_f32 v139, v139
    v_mfma_f32_16x16x32_bf16 v[224:227], v[192:195], v[248:251], v[224:227]
    v_cvt_pk_bf16_f32 v157, v138, v139
    v_mfma_f32_16x16x32_bf16 v[228:231], v[196:199], v[248:251], v[228:231]
    v_exp_f32 v140, v140
    v_mfma_f32_16x16x32_bf16 v[228:231], v[180:183], v[248:251], v[228:231]
    s_waitcnt lgkmcnt(0)
    v_mfma_f32_16x16x32_bf16 v[112:115], a[128:131], v[48:51], v[208:211]
    v_exp_f32 v141, v141
    v_mfma_f32_16x16x32_bf16 v[112:115], a[132:135], v[52:55], v[112:115]
    ds_read_b64_tr_b16 a[160:161], v24 offset:16384
    v_cvt_pk_bf16_f32 v158, v140, v141
    v_mfma_f32_16x16x32_bf16 v[112:115], a[136:139], v[56:59], v[112:115]
    v_exp_f32 v142, v142
    v_mfma_f32_16x16x32_bf16 v[112:115], a[140:143], v[60:63], v[112:115]
    ds_read_b64_tr_b16 a[162:163], v24 offset:20480
    v_mfma_f32_16x16x32_bf16 v[116:119], a[156:159], v[60:63], v[208:211]
    v_exp_f32 v143, v143
    v_mfma_f32_16x16x32_bf16 v[116:119], a[152:155], v[56:59], v[116:119]
    ds_read_b64_tr_b16 a[164:165], v24 offset:24576
    v_cvt_pk_bf16_f32 v159, v142, v143
    v_mfma_f32_16x16x32_bf16 v[116:119], a[148:151], v[52:55], v[116:119]
    v_mfma_f32_16x16x32_bf16 v[116:119], a[144:147], v[48:51], v[116:119]
    ds_read_b64_tr_b16 a[166:167], v24 offset:28672
    v_mfma_f32_16x16x32_bf16 v[124:127], a[144:147], v[64:67], v[212:215]
    v_mfma_f32_16x16x32_bf16 v[124:127], a[148:151], v[68:71], v[124:127]
    ds_read_b64_tr_b16 a[168:169], v25 offset:16384
    v_mfma_f32_16x16x32_bf16 v[124:127], a[152:155], v[72:75], v[124:127]
    v_exp_f32 v112, v112
    v_mfma_f32_16x16x32_bf16 v[124:127], a[156:159], v[76:79], v[124:127]
    ds_read_b64_tr_b16 a[170:171], v25 offset:20480
    v_mfma_f32_16x16x32_bf16 v[120:123], a[140:143], v[76:79], v[212:215]
    v_exp_f32 v113, v113
    v_mfma_f32_16x16x32_bf16 v[120:123], a[136:139], v[72:75], v[120:123]
    ds_read_b64_tr_b16 a[172:173], v25 offset:24576
    v_cvt_pk_bf16_f32 v160, v112, v113
    v_mfma_f32_16x16x32_bf16 v[120:123], a[132:135], v[68:71], v[120:123]
    v_exp_f32 v114, v114
    v_mfma_f32_16x16x32_bf16 v[120:123], a[128:131], v[64:67], v[120:123]
    ds_read_b64_tr_b16 a[174:175], v25 offset:28672
    v_mfma_f32_16x16x32_bf16 v[128:131], a[128:131], v[80:83], v[216:219]
    v_exp_f32 v115, v115
    v_mfma_f32_16x16x32_bf16 v[128:131], a[132:135], v[84:87], v[128:131]
    ds_read_b64_tr_b16 a[176:177], v26 offset:16384
    v_cvt_pk_bf16_f32 v161, v114, v115
    v_mfma_f32_16x16x32_bf16 v[128:131], a[136:139], v[88:91], v[128:131]
    v_exp_f32 v116, v116
    v_mfma_f32_16x16x32_bf16 v[128:131], a[140:143], v[92:95], v[128:131]
    ds_read_b64_tr_b16 a[178:179], v26 offset:20480
    v_mfma_f32_16x16x32_bf16 v[132:135], a[156:159], v[92:95], v[216:219]
    v_exp_f32 v117, v117
    v_mfma_f32_16x16x32_bf16 v[132:135], a[152:155], v[88:91], v[132:135]
    ds_read_b64_tr_b16 a[180:181], v26 offset:24576
    v_cvt_pk_bf16_f32 v162, v116, v117
    v_mfma_f32_16x16x32_bf16 v[132:135], a[148:151], v[84:87], v[132:135]
    v_exp_f32 v118, v118
    v_mfma_f32_16x16x32_bf16 v[132:135], a[144:147], v[80:83], v[132:135]
    ds_read_b64_tr_b16 a[182:183], v26 offset:28672
    v_mfma_f32_16x16x32_bf16 v[140:143], a[144:147], v[96:99], v[220:223]
    v_exp_f32 v119, v119
    v_mfma_f32_16x16x32_bf16 v[140:143], a[148:151], v[100:103], v[140:143]
    ds_read_b64_tr_b16 a[184:185], v27 offset:16384
    v_cvt_pk_bf16_f32 v163, v118, v119
    v_mfma_f32_16x16x32_bf16 v[140:143], a[152:155], v[104:107], v[140:143]
    v_exp_f32 v120, v120
    v_mfma_f32_16x16x32_bf16 v[140:143], a[156:159], v[108:111], v[140:143]
    ds_read_b64_tr_b16 a[186:187], v27 offset:20480
    v_mfma_f32_16x16x32_bf16 v[136:139], a[140:143], v[108:111], v[220:223]
    v_exp_f32 v121, v121
    v_mfma_f32_16x16x32_bf16 v[136:139], a[136:139], v[104:107], v[136:139]
    ds_read_b64_tr_b16 a[188:189], v27 offset:24576
    v_cvt_pk_bf16_f32 v164, v120, v121
    v_mfma_f32_16x16x32_bf16 v[136:139], a[132:135], v[100:103], v[136:139]
    s_waitcnt lgkmcnt(2)
    v_exp_f32 v122, v122
    v_mfma_f32_16x16x32_bf16 v[136:139], a[128:131], v[96:99], v[136:139]
    ds_read_b64_tr_b16 a[190:191], v27 offset:28672
    v_mfma_f32_16x16x32_bf16 a[16:19], v[176:179], a[160:163], a[16:19]
    v_exp_f32 v123, v123
    v_mfma_f32_16x16x32_bf16 a[16:19], v[192:195], a[164:167], a[16:19]
    v_cvt_pk_bf16_f32 v165, v122, v123
    v_mfma_f32_16x16x32_bf16 a[48:51], v[196:199], a[164:167], a[48:51]
    v_exp_f32 v124, v124
    v_mfma_f32_16x16x32_bf16 a[48:51], v[180:183], a[160:163], a[48:51]
    v_mfma_f32_16x16x32_bf16 a[80:83], v[184:187], a[160:163], a[80:83]
    s_waitcnt vmcnt(16) lgkmcnt(0)
    v_exp_f32 v125, v125
    v_mfma_f32_16x16x32_bf16 a[80:83], v[200:203], a[164:167], a[80:83]
    s_barrier
    v_cvt_pk_bf16_f32 v166, v124, v125
    v_mfma_f32_16x16x32_bf16 a[112:115], v[204:207], a[164:167], a[112:115]
    s_add_u32 m0, s96, 32768
    v_exp_f32 v126, v126
    v_mfma_f32_16x16x32_bf16 a[112:115], v[188:191], a[160:163], a[112:115]
    buffer_load_dwordx4 v28, s[16:19], s50 offen offset:0 nt lds
    v_mfma_f32_16x16x32_bf16 a[116:119], v[188:191], a[168:171], a[116:119]
    v_exp_f32 v127, v127
    v_mfma_f32_16x16x32_bf16 a[116:119], v[204:207], a[172:175], a[116:119]
    ds_read_b128 a[128:131], v16 offset:49152
    v_cvt_pk_bf16_f32 v167, v126, v127
    v_mfma_f32_16x16x32_bf16 a[84:87], v[200:203], a[172:175], a[84:87]
    v_exp_f32 v128, v128
    v_mfma_f32_16x16x32_bf16 a[84:87], v[184:187], a[168:171], a[84:87]
    ds_read_b128 a[132:135], v17 offset:49152
    v_mfma_f32_16x16x32_bf16 a[52:55], v[180:183], a[168:171], a[52:55]
    v_exp_f32 v129, v129
    v_mfma_f32_16x16x32_bf16 a[52:55], v[196:199], a[172:175], a[52:55]
    buffer_load_dwordx4 v29, s[16:19], s50 offen offset:1024 nt lds
    v_mfma_f32_16x16x32_bf16 a[20:23], v[192:195], a[172:175], a[20:23]
    v_exp_f32 v130, v130
    v_mfma_f32_16x16x32_bf16 a[20:23], v[176:179], a[168:171], a[20:23]
    ds_read_b128 a[136:139], v18 offset:49152
    v_cvt_pk_bf16_f32 v168, v128, v129
    v_mfma_f32_16x16x32_bf16 a[24:27], v[176:179], a[176:179], a[24:27]
    v_exp_f32 v131, v131
    v_mfma_f32_16x16x32_bf16 a[24:27], v[192:195], a[180:183], a[24:27]
    ds_read_b128 a[140:143], v19 offset:49152
    v_cvt_pk_bf16_f32 v169, v130, v131
    v_mfma_f32_16x16x32_bf16 a[56:59], v[196:199], a[180:183], a[56:59]
    v_exp_f32 v132, v132
    v_mfma_f32_16x16x32_bf16 a[56:59], v[180:183], a[176:179], a[56:59]
    buffer_load_dwordx4 v30, s[16:19], s50 offen offset:2048 nt lds
    v_mfma_f32_16x16x32_bf16 a[88:91], v[184:187], a[176:179], a[88:91]
    v_exp_f32 v133, v133
    v_mfma_f32_16x16x32_bf16 a[88:91], v[200:203], a[180:183], a[88:91]
    ds_read_b128 a[144:147], v16 offset:53248
    v_cvt_pk_bf16_f32 v170, v132, v133
    v_mfma_f32_16x16x32_bf16 a[120:123], v[204:207], a[180:183], a[120:123]
    v_exp_f32 v134, v134
    v_mfma_f32_16x16x32_bf16 a[120:123], v[188:191], a[176:179], a[120:123]
    ds_read_b128 a[148:151], v17 offset:53248
    v_mfma_f32_16x16x32_bf16 a[124:127], v[188:191], a[184:187], a[124:127]
    v_exp_f32 v135, v135
    v_mfma_f32_16x16x32_bf16 a[124:127], v[204:207], a[188:191], a[124:127]
    buffer_load_dwordx4 v31, s[16:19], s50 offen offset:3072 nt lds
    v_mfma_f32_16x16x32_bf16 a[92:95], v[200:203], a[188:191], a[92:95]
    s_add_u32 s50, s50, 16384
    v_exp_f32 v136, v136
    v_mfma_f32_16x16x32_bf16 a[92:95], v[184:187], a[184:187], a[92:95]
    ds_read_b128 a[152:155], v18 offset:53248
    v_cvt_pk_bf16_f32 v171, v134, v135
    v_mfma_f32_16x16x32_bf16 a[60:63], v[180:183], a[184:187], a[60:63]
    v_exp_f32 v137, v137
    v_mfma_f32_16x16x32_bf16 a[60:63], v[196:199], a[188:191], a[60:63]
    ds_read_b128 a[156:159], v19 offset:53248
    v_cvt_pk_bf16_f32 v172, v136, v137
    v_mfma_f32_16x16x32_bf16 a[28:31], v[192:195], a[188:191], a[28:31]
    v_exp_f32 v138, v138
    v_mfma_f32_16x16x32_bf16 a[28:31], v[176:179], a[184:187], a[28:31]
    v_mfma_f32_16x16x32_bf16 v[232:235], v[184:187], v[248:251], v[232:235]
    v_exp_f32 v139, v139
    v_mfma_f32_16x16x32_bf16 v[232:235], v[200:203], v[248:251], v[232:235]
    v_cvt_pk_bf16_f32 v173, v138, v139
    v_mfma_f32_16x16x32_bf16 v[236:239], v[204:207], v[248:251], v[236:239]
    v_exp_f32 v140, v140
    v_mfma_f32_16x16x32_bf16 v[236:239], v[188:191], v[248:251], v[236:239]
    s_waitcnt lgkmcnt(0)
    v_mfma_f32_16x16x32_bf16 v[112:115], a[128:131], v[48:51], v[208:211]
    v_exp_f32 v141, v141
    v_mfma_f32_16x16x32_bf16 v[112:115], a[132:135], v[52:55], v[112:115]
    ds_read_b64_tr_b16 a[160:161], v20 offset:32768
    v_cvt_pk_bf16_f32 v174, v140, v141
    v_mfma_f32_16x16x32_bf16 v[112:115], a[136:139], v[56:59], v[112:115]
    v_exp_f32 v142, v142
    v_mfma_f32_16x16x32_bf16 v[112:115], a[140:143], v[60:63], v[112:115]
    ds_read_b64_tr_b16 a[162:163], v20 offset:36864
    v_mfma_f32_16x16x32_bf16 v[116:119], a[156:159], v[60:63], v[208:211]
    v_exp_f32 v143, v143
    v_mfma_f32_16x16x32_bf16 v[116:119], a[152:155], v[56:59], v[116:119]
    ds_read_b64_tr_b16 a[164:165], v20 offset:40960
    v_cvt_pk_bf16_f32 v175, v142, v143
    v_mfma_f32_16x16x32_bf16 v[116:119], a[148:151], v[52:55], v[116:119]
    v_mfma_f32_16x16x32_bf16 v[116:119], a[144:147], v[48:51], v[116:119]
    ds_read_b64_tr_b16 a[166:167], v20 offset:45056
    v_mfma_f32_16x16x32_bf16 v[124:127], a[144:147], v[64:67], v[212:215]
    v_mfma_f32_16x16x32_bf16 v[124:127], a[148:151], v[68:71], v[124:127]
    ds_read_b64_tr_b16 a[168:169], v21 offset:32768
    v_mfma_f32_16x16x32_bf16 v[124:127], a[152:155], v[72:75], v[124:127]
    v_exp_f32 v112, v112
    v_mfma_f32_16x16x32_bf16 v[124:127], a[156:159], v[76:79], v[124:127]
    ds_read_b64_tr_b16 a[170:171], v21 offset:36864
    v_mfma_f32_16x16x32_bf16 v[120:123], a[140:143], v[76:79], v[212:215]
    v_exp_f32 v113, v113
    v_mfma_f32_16x16x32_bf16 v[120:123], a[136:139], v[72:75], v[120:123]
    ds_read_b64_tr_b16 a[172:173], v21 offset:40960
    v_cvt_pk_bf16_f32 v176, v112, v113
    v_mfma_f32_16x16x32_bf16 v[120:123], a[132:135], v[68:71], v[120:123]
    v_exp_f32 v114, v114
    v_mfma_f32_16x16x32_bf16 v[120:123], a[128:131], v[64:67], v[120:123]
    ds_read_b64_tr_b16 a[174:175], v21 offset:45056
    v_mfma_f32_16x16x32_bf16 v[128:131], a[128:131], v[80:83], v[216:219]
    v_exp_f32 v115, v115
    v_mfma_f32_16x16x32_bf16 v[128:131], a[132:135], v[84:87], v[128:131]
    ds_read_b64_tr_b16 a[176:177], v22 offset:32768
    v_cvt_pk_bf16_f32 v177, v114, v115
    v_mfma_f32_16x16x32_bf16 v[128:131], a[136:139], v[88:91], v[128:131]
    v_exp_f32 v116, v116
    v_mfma_f32_16x16x32_bf16 v[128:131], a[140:143], v[92:95], v[128:131]
    ds_read_b64_tr_b16 a[178:179], v22 offset:36864
    v_mfma_f32_16x16x32_bf16 v[132:135], a[156:159], v[92:95], v[216:219]
    v_exp_f32 v117, v117
    v_mfma_f32_16x16x32_bf16 v[132:135], a[152:155], v[88:91], v[132:135]
    ds_read_b64_tr_b16 a[180:181], v22 offset:40960
    v_cvt_pk_bf16_f32 v178, v116, v117
    v_mfma_f32_16x16x32_bf16 v[132:135], a[148:151], v[84:87], v[132:135]
    v_exp_f32 v118, v118
    v_mfma_f32_16x16x32_bf16 v[132:135], a[144:147], v[80:83], v[132:135]
    ds_read_b64_tr_b16 a[182:183], v22 offset:45056
    v_mfma_f32_16x16x32_bf16 v[140:143], a[144:147], v[96:99], v[220:223]
    v_exp_f32 v119, v119
    v_mfma_f32_16x16x32_bf16 v[140:143], a[148:151], v[100:103], v[140:143]
    ds_read_b64_tr_b16 a[184:185], v23 offset:32768
    v_cvt_pk_bf16_f32 v179, v118, v119
    v_mfma_f32_16x16x32_bf16 v[140:143], a[152:155], v[104:107], v[140:143]
    v_exp_f32 v120, v120
    v_mfma_f32_16x16x32_bf16 v[140:143], a[156:159], v[108:111], v[140:143]
    ds_read_b64_tr_b16 a[186:187], v23 offset:36864
    v_mfma_f32_16x16x32_bf16 v[136:139], a[140:143], v[108:111], v[220:223]
    v_exp_f32 v121, v121
    v_mfma_f32_16x16x32_bf16 v[136:139], a[136:139], v[104:107], v[136:139]
    ds_read_b64_tr_b16 a[188:189], v23 offset:40960
    v_cvt_pk_bf16_f32 v180, v120, v121
    v_mfma_f32_16x16x32_bf16 v[136:139], a[132:135], v[100:103], v[136:139]
    s_waitcnt lgkmcnt(2)
    v_exp_f32 v122, v122
    v_mfma_f32_16x16x32_bf16 v[136:139], a[128:131], v[96:99], v[136:139]
    ds_read_b64_tr_b16 a[190:191], v23 offset:45056
    v_mfma_f32_16x16x32_bf16 a[0:3], v[144:147], a[160:163], a[0:3]
    v_exp_f32 v123, v123
    v_mfma_f32_16x16x32_bf16 a[0:3], v[160:163], a[164:167], a[0:3]
    v_cvt_pk_bf16_f32 v181, v122, v123
    v_mfma_f32_16x16x32_bf16 a[32:35], v[164:167], a[164:167], a[32:35]
    v_exp_f32 v124, v124
    v_mfma_f32_16x16x32_bf16 a[32:35], v[148:151], a[160:163], a[32:35]
    v_mfma_f32_16x16x32_bf16 a[64:67], v[152:155], a[160:163], a[64:67]
    s_waitcnt lgkmcnt(0)
    v_exp_f32 v125, v125
    v_mfma_f32_16x16x32_bf16 a[64:67], v[168:171], a[164:167], a[64:67]
    v_cvt_pk_bf16_f32 v182, v124, v125
    v_mfma_f32_16x16x32_bf16 a[96:99], v[172:175], a[164:167], a[96:99]
    s_add_u32 m0, s96, 81920
    v_exp_f32 v126, v126
    v_mfma_f32_16x16x32_bf16 a[96:99], v[156:159], a[160:163], a[96:99]
    buffer_load_dwordx4 v32, s[20:23], s95 offen offset:0 nt lds
    v_mfma_f32_16x16x32_bf16 a[100:103], v[156:159], a[168:171], a[100:103]
    v_exp_f32 v127, v127
    v_mfma_f32_16x16x32_bf16 a[100:103], v[172:175], a[172:175], a[100:103]
    ds_read_b128 a[128:131], v16 offset:57344
    v_cvt_pk_bf16_f32 v183, v126, v127
    v_mfma_f32_16x16x32_bf16 a[68:71], v[168:171], a[172:175], a[68:71]
    v_exp_f32 v128, v128
    v_mfma_f32_16x16x32_bf16 a[68:71], v[152:155], a[168:171], a[68:71]
    ds_read_b128 a[132:135], v17 offset:57344
    v_mfma_f32_16x16x32_bf16 a[36:39], v[148:151], a[168:171], a[36:39]
    v_exp_f32 v129, v129
    v_mfma_f32_16x16x32_bf16 a[36:39], v[164:167], a[172:175], a[36:39]
    buffer_load_dwordx4 v33, s[20:23], s95 offen offset:1024 nt lds
    v_mfma_f32_16x16x32_bf16 a[4:7], v[160:163], a[172:175], a[4:7]
    v_exp_f32 v130, v130
    v_mfma_f32_16x16x32_bf16 a[4:7], v[144:147], a[168:171], a[4:7]
    ds_read_b128 a[136:139], v18 offset:57344
    v_cvt_pk_bf16_f32 v184, v128, v129
    v_mfma_f32_16x16x32_bf16 a[8:11], v[144:147], a[176:179], a[8:11]
    v_exp_f32 v131, v131
    v_mfma_f32_16x16x32_bf16 a[8:11], v[160:163], a[180:183], a[8:11]
    ds_read_b128 a[140:143], v19 offset:57344
    v_cvt_pk_bf16_f32 v185, v130, v131
    v_mfma_f32_16x16x32_bf16 a[40:43], v[164:167], a[180:183], a[40:43]
    v_exp_f32 v132, v132
    v_mfma_f32_16x16x32_bf16 a[40:43], v[148:151], a[176:179], a[40:43]
    buffer_load_dwordx4 v32, s[20:23], s95 offen offset:2048 nt lds
    v_mfma_f32_16x16x32_bf16 a[72:75], v[152:155], a[176:179], a[72:75]
    v_exp_f32 v133, v133
    v_mfma_f32_16x16x32_bf16 a[72:75], v[168:171], a[180:183], a[72:75]
    ds_read_b128 a[144:147], v16 offset:61440
    v_cvt_pk_bf16_f32 v186, v132, v133
    v_mfma_f32_16x16x32_bf16 a[104:107], v[172:175], a[180:183], a[104:107]
    v_exp_f32 v134, v134
    v_mfma_f32_16x16x32_bf16 a[104:107], v[156:159], a[176:179], a[104:107]
    ds_read_b128 a[148:151], v17 offset:61440
    v_mfma_f32_16x16x32_bf16 a[108:111], v[156:159], a[184:187], a[108:111]
    v_exp_f32 v135, v135
    v_mfma_f32_16x16x32_bf16 a[108:111], v[172:175], a[188:191], a[108:111]
    buffer_load_dwordx4 v33, s[20:23], s95 offen offset:3072 nt lds
    v_mfma_f32_16x16x32_bf16 a[76:79], v[168:171], a[188:191], a[76:79]
    s_add_u32 s95, s95, 16384
    v_exp_f32 v136, v136
    v_mfma_f32_16x16x32_bf16 a[76:79], v[152:155], a[184:187], a[76:79]
    ds_read_b128 a[152:155], v18 offset:61440
    v_cvt_pk_bf16_f32 v187, v134, v135
    v_mfma_f32_16x16x32_bf16 a[44:47], v[148:151], a[184:187], a[44:47]
    v_exp_f32 v137, v137
    v_mfma_f32_16x16x32_bf16 a[44:47], v[164:167], a[188:191], a[44:47]
    ds_read_b128 a[156:159], v19 offset:61440
    v_cvt_pk_bf16_f32 v188, v136, v137
    v_mfma_f32_16x16x32_bf16 a[12:15], v[160:163], a[188:191], a[12:15]
    v_exp_f32 v138, v138
    v_mfma_f32_16x16x32_bf16 a[12:15], v[144:147], a[184:187], a[12:15]
    v_mfma_f32_16x16x32_bf16 v[224:227], v[144:147], v[248:251], v[224:227]
    v_exp_f32 v139, v139
    v_mfma_f32_16x16x32_bf16 v[224:227], v[160:163], v[248:251], v[224:227]
    v_cvt_pk_bf16_f32 v189, v138, v139
    v_mfma_f32_16x16x32_bf16 v[228:231], v[164:167], v[248:251], v[228:231]
    v_exp_f32 v140, v140
    v_mfma_f32_16x16x32_bf16 v[228:231], v[148:151], v[248:251], v[228:231]
    s_waitcnt lgkmcnt(0)
    v_mfma_f32_16x16x32_bf16 v[112:115], a[128:131], v[48:51], v[208:211]
    v_exp_f32 v141, v141
    v_mfma_f32_16x16x32_bf16 v[112:115], a[132:135], v[52:55], v[112:115]
    ds_read_b64_tr_b16 a[160:161], v24 offset:32768
    v_cvt_pk_bf16_f32 v190, v140, v141
    v_mfma_f32_16x16x32_bf16 v[112:115], a[136:139], v[56:59], v[112:115]
    v_exp_f32 v142, v142
    v_mfma_f32_16x16x32_bf16 v[112:115], a[140:143], v[60:63], v[112:115]
    ds_read_b64_tr_b16 a[162:163], v24 offset:36864
    v_mfma_f32_16x16x32_bf16 v[116:119], a[156:159], v[60:63], v[208:211]
    v_exp_f32 v143, v143
    v_mfma_f32_16x16x32_bf16 v[116:119], a[152:155], v[56:59], v[116:119]
    ds_read_b64_tr_b16 a[164:165], v24 offset:40960
    v_cvt_pk_bf16_f32 v191, v142, v143
    v_mfma_f32_16x16x32_bf16 v[116:119], a[148:151], v[52:55], v[116:119]
    v_mfma_f32_16x16x32_bf16 v[116:119], a[144:147], v[48:51], v[116:119]
    ds_read_b64_tr_b16 a[166:167], v24 offset:45056
    v_mfma_f32_16x16x32_bf16 v[124:127], a[144:147], v[64:67], v[212:215]
    v_mfma_f32_16x16x32_bf16 v[124:127], a[148:151], v[68:71], v[124:127]
    ds_read_b64_tr_b16 a[168:169], v25 offset:32768
    v_mfma_f32_16x16x32_bf16 v[124:127], a[152:155], v[72:75], v[124:127]
    v_exp_f32 v112, v112
    v_mfma_f32_16x16x32_bf16 v[124:127], a[156:159], v[76:79], v[124:127]
    ds_read_b64_tr_b16 a[170:171], v25 offset:36864
    v_mfma_f32_16x16x32_bf16 v[120:123], a[140:143], v[76:79], v[212:215]
    v_exp_f32 v113, v113
    v_mfma_f32_16x16x32_bf16 v[120:123], a[136:139], v[72:75], v[120:123]
    ds_read_b64_tr_b16 a[172:173], v25 offset:40960
    v_cvt_pk_bf16_f32 v192, v112, v113
    v_mfma_f32_16x16x32_bf16 v[120:123], a[132:135], v[68:71], v[120:123]
    v_exp_f32 v114, v114
    v_mfma_f32_16x16x32_bf16 v[120:123], a[128:131], v[64:67], v[120:123]
    ds_read_b64_tr_b16 a[174:175], v25 offset:45056
    v_mfma_f32_16x16x32_bf16 v[128:131], a[128:131], v[80:83], v[216:219]
    v_exp_f32 v115, v115
    v_mfma_f32_16x16x32_bf16 v[128:131], a[132:135], v[84:87], v[128:131]
    ds_read_b64_tr_b16 a[176:177], v26 offset:32768
    v_cvt_pk_bf16_f32 v193, v114, v115
    v_mfma_f32_16x16x32_bf16 v[128:131], a[136:139], v[88:91], v[128:131]
    v_exp_f32 v116, v116
    v_mfma_f32_16x16x32_bf16 v[128:131], a[140:143], v[92:95], v[128:131]
    ds_read_b64_tr_b16 a[178:179], v26 offset:36864
    v_mfma_f32_16x16x32_bf16 v[132:135], a[156:159], v[92:95], v[216:219]
    v_exp_f32 v117, v117
    v_mfma_f32_16x16x32_bf16 v[132:135], a[152:155], v[88:91], v[132:135]
    ds_read_b64_tr_b16 a[180:181], v26 offset:40960
    v_cvt_pk_bf16_f32 v194, v116, v117
    v_mfma_f32_16x16x32_bf16 v[132:135], a[148:151], v[84:87], v[132:135]
    v_exp_f32 v118, v118
    v_mfma_f32_16x16x32_bf16 v[132:135], a[144:147], v[80:83], v[132:135]
    ds_read_b64_tr_b16 a[182:183], v26 offset:45056
    v_mfma_f32_16x16x32_bf16 v[140:143], a[144:147], v[96:99], v[220:223]
    v_exp_f32 v119, v119
    v_mfma_f32_16x16x32_bf16 v[140:143], a[148:151], v[100:103], v[140:143]
    ds_read_b64_tr_b16 a[184:185], v27 offset:32768
    v_cvt_pk_bf16_f32 v195, v118, v119
    v_mfma_f32_16x16x32_bf16 v[140:143], a[152:155], v[104:107], v[140:143]
    v_exp_f32 v120, v120
    v_mfma_f32_16x16x32_bf16 v[140:143], a[156:159], v[108:111], v[140:143]
    ds_read_b64_tr_b16 a[186:187], v27 offset:36864
    v_mfma_f32_16x16x32_bf16 v[136:139], a[140:143], v[108:111], v[220:223]
    v_exp_f32 v121, v121
    v_mfma_f32_16x16x32_bf16 v[136:139], a[136:139], v[104:107], v[136:139]
    ds_read_b64_tr_b16 a[188:189], v27 offset:40960
    v_cvt_pk_bf16_f32 v196, v120, v121
    v_mfma_f32_16x16x32_bf16 v[136:139], a[132:135], v[100:103], v[136:139]
    s_waitcnt lgkmcnt(2)
    v_exp_f32 v122, v122
    v_mfma_f32_16x16x32_bf16 v[136:139], a[128:131], v[96:99], v[136:139]
    ds_read_b64_tr_b16 a[190:191], v27 offset:45056
    v_mfma_f32_16x16x32_bf16 a[16:19], v[144:147], a[160:163], a[16:19]
    v_exp_f32 v123, v123
    v_mfma_f32_16x16x32_bf16 a[16:19], v[160:163], a[164:167], a[16:19]
    v_cvt_pk_bf16_f32 v197, v122, v123
    v_mfma_f32_16x16x32_bf16 a[48:51], v[164:167], a[164:167], a[48:51]
    v_exp_f32 v124, v124
    v_mfma_f32_16x16x32_bf16 a[48:51], v[148:151], a[160:163], a[48:51]
    v_mfma_f32_16x16x32_bf16 a[80:83], v[152:155], a[160:163], a[80:83]
    s_waitcnt vmcnt(16) lgkmcnt(0)
    v_exp_f32 v125, v125
    v_mfma_f32_16x16x32_bf16 a[80:83], v[168:171], a[164:167], a[80:83]
    s_barrier
    v_cvt_pk_bf16_f32 v198, v124, v125
    v_mfma_f32_16x16x32_bf16 a[112:115], v[172:175], a[164:167], a[112:115]
    s_add_u32 m0, s96, 49152
    v_exp_f32 v126, v126
    v_mfma_f32_16x16x32_bf16 a[112:115], v[156:159], a[160:163], a[112:115]
    buffer_load_dwordx4 v28, s[16:19], s50 offen offset:0 nt lds
    v_mfma_f32_16x16x32_bf16 a[116:119], v[156:159], a[168:171], a[116:119]
    v_exp_f32 v127, v127
    v_mfma_f32_16x16x32_bf16 a[116:119], v[172:175], a[172:175], a[116:119]
    ds_read_b128 a[128:131], v16 offset:0
    v_cvt_pk_bf16_f32 v199, v126, v127
    v_mfma_f32_16x16x32_bf16 a[84:87], v[168:171], a[172:175], a[84:87]
    v_exp_f32 v128, v128
    v_mfma_f32_16x16x32_bf16 a[84:87], v[152:155], a[168:171], a[84:87]
    ds_read_b128 a[132:135], v17 offset:0
    v_mfma_f32_16x16x32_bf16 a[52:55], v[148:151], a[168:171], a[52:55]
    v_exp_f32 v129, v129
    v_mfma_f32_16x16x32_bf16 a[52:55], v[164:167], a[172:175], a[52:55]
    buffer_load_dwordx4 v29, s[16:19], s50 offen offset:1024 nt lds
    v_mfma_f32_16x16x32_bf16 a[20:23], v[160:163], a[172:175], a[20:23]
    v_exp_f32 v130, v130
    v_mfma_f32_16x16x32_bf16 a[20:23], v[144:147], a[168:171], a[20:23]
    ds_read_b128 a[136:139], v18 offset:0
    v_cvt_pk_bf16_f32 v200, v128, v129
    v_mfma_f32_16x16x32_bf16 a[24:27], v[144:147], a[176:179], a[24:27]
    v_exp_f32 v131, v131
    v_mfma_f32_16x16x32_bf16 a[24:27], v[160:163], a[180:183], a[24:27]
    ds_read_b128 a[140:143], v19 offset:0
    v_cvt_pk_bf16_f32 v201, v130, v131
    v_mfma_f32_16x16x32_bf16 a[56:59], v[164:167], a[180:183], a[56:59]
    v_exp_f32 v132, v132
    v_mfma_f32_16x16x32_bf16 a[56:59], v[148:151], a[176:179], a[56:59]
    buffer_load_dwordx4 v30, s[16:19], s50 offen offset:2048 nt lds
    v_mfma_f32_16x16x32_bf16 a[88:91], v[152:155], a[176:179], a[88:91]
    v_exp_f32 v133, v133
    v_mfma_f32_16x16x32_bf16 a[88:91], v[168:171], a[180:183], a[88:91]
    ds_read_b128 a[144:147], v16 offset:4096
    v_cvt_pk_bf16_f32 v202, v132, v133
    v_mfma_f32_16x16x32_bf16 a[120:123], v[172:175], a[180:183], a[120:123]
    v_exp_f32 v134, v134
    v_mfma_f32_16x16x32_bf16 a[120:123], v[156:159], a[176:179], a[120:123]
    ds_read_b128 a[148:151], v17 offset:4096
    v_mfma_f32_16x16x32_bf16 a[124:127], v[156:159], a[184:187], a[124:127]
    v_exp_f32 v135, v135
    v_mfma_f32_16x16x32_bf16 a[124:127], v[172:175], a[188:191], a[124:127]
    buffer_load_dwordx4 v31, s[16:19], s50 offen offset:3072 nt lds
    v_mfma_f32_16x16x32_bf16 a[92:95], v[168:171], a[188:191], a[92:95]
    s_add_u32 s50, s50, 16384
    v_exp_f32 v136, v136
    v_mfma_f32_16x16x32_bf16 a[92:95], v[152:155], a[184:187], a[92:95]
    ds_read_b128 a[152:155], v18 offset:4096
    v_cvt_pk_bf16_f32 v203, v134, v135
    v_mfma_f32_16x16x32_bf16 a[60:63], v[148:151], a[184:187], a[60:63]
    v_exp_f32 v137, v137
    v_mfma_f32_16x16x32_bf16 a[60:63], v[164:167], a[188:191], a[60:63]
    ds_read_b128 a[156:159], v19 offset:4096
    v_cvt_pk_bf16_f32 v204, v136, v137
    v_mfma_f32_16x16x32_bf16 a[28:31], v[160:163], a[188:191], a[28:31]
    s_sub_u32 s51, s51, 1
    v_exp_f32 v138, v138
    v_mfma_f32_16x16x32_bf16 a[28:31], v[144:147], a[184:187], a[28:31]
    v_mfma_f32_16x16x32_bf16 v[232:235], v[152:155], v[248:251], v[232:235]
    s_cmp_gt_u32 s51, 0
    v_exp_f32 v139, v139
    v_mfma_f32_16x16x32_bf16 v[232:235], v[168:171], v[248:251], v[232:235]
    v_cvt_pk_bf16_f32 v205, v138, v139
    v_mfma_f32_16x16x32_bf16 v[236:239], v[172:175], v[248:251], v[236:239]
    v_exp_f32 v140, v140
    v_mfma_f32_16x16x32_bf16 v[236:239], v[156:159], v[248:251], v[236:239]
    s_waitcnt lgkmcnt(0)
    s_cbranch_scc1 L1_loop
L1_last:
    v_mfma_f32_16x16x32_bf16 v[112:115], a[128:131], v[48:51], v[208:211]
    v_exp_f32 v141, v141
    v_mfma_f32_16x16x32_bf16 v[112:115], a[132:135], v[52:55], v[112:115]
    ds_read_b64_tr_b16 a[160:161], v20 offset:49152
    v_cvt_pk_bf16_f32 v206, v140, v141
    v_mfma_f32_16x16x32_bf16 v[112:115], a[136:139], v[56:59], v[112:115]
    s_add_u32 s33, s98, 1146880
    v_exp_f32 v142, v142
    v_mfma_f32_16x16x32_bf16 v[112:115], a[140:143], v[60:63], v[112:115]
    ds_read_b64_tr_b16 a[162:163], v20 offset:53248
    v_mfma_f32_16x16x32_bf16 v[116:119], a[156:159], v[60:63], v[208:211]
    s_add_u32 m0, s47, 0
    v_exp_f32 v143, v143
    v_mfma_f32_16x16x32_bf16 v[116:119], a[152:155], v[56:59], v[116:119]
    ds_read_b64_tr_b16 a[164:165], v20 offset:57344
    v_cvt_pk_bf16_f32 v207, v142, v143
    v_mfma_f32_16x16x32_bf16 v[116:119], a[148:151], v[52:55], v[116:119]
    buffer_load_dwordx4 v244, s[64:67], s33 offen offset:0 lds
    v_mfma_f32_16x16x32_bf16 v[116:119], a[144:147], v[48:51], v[116:119]
    ds_read_b64_tr_b16 a[166:167], v20 offset:61440
    v_mfma_f32_16x16x32_bf16 v[124:127], a[144:147], v[64:67], v[212:215]
    v_mfma_f32_16x16x32_bf16 v[124:127], a[148:151], v[68:71], v[124:127]
    ds_read_b64_tr_b16 a[168:169], v21 offset:49152
    v_mfma_f32_16x16x32_bf16 v[124:127], a[152:155], v[72:75], v[124:127]
    v_exp_f32 v112, v112
    v_mfma_f32_16x16x32_bf16 v[124:127], a[156:159], v[76:79], v[124:127]
    ds_read_b64_tr_b16 a[170:171], v21 offset:53248
    v_mfma_f32_16x16x32_bf16 v[120:123], a[140:143], v[76:79], v[212:215]
    buffer_load_dwordx4 v245, s[64:67], s33 offen offset:1024 lds
    v_exp_f32 v113, v113
    v_mfma_f32_16x16x32_bf16 v[120:123], a[136:139], v[72:75], v[120:123]
    ds_read_b64_tr_b16 a[172:173], v21 offset:57344
    v_cvt_pk_bf16_f32 v144, v112, v113
    v_mfma_f32_16x16x32_bf16 v[120:123], a[132:135], v[68:71], v[120:123]
    v_exp_f32 v114, v114
    v_mfma_f32_16x16x32_bf16 v[120:123], a[128:131], v[64:67], v[120:123]
    ds_read_b64_tr_b16 a[174:175], v21 offset:61440
    v_mfma_f32_16x16x32_bf16 v[128:131], a[128:131], v[80:83], v[216:219]
    v_exp_f32 v115, v115
    v_mfma_f32_16x16x32_bf16 v[128:131], a[132:135], v[84:87], v[128:131]
    ds_read_b64_tr_b16 a[176:177], v22 offset:49152
    v_cvt_pk_bf16_f32 v145, v114, v115
    v_mfma_f32_16x16x32_bf16 v[128:131], a[136:139], v[88:91], v[128:131]
    buffer_load_dwordx4 v246, s[64:67], s33 offen offset:2048 lds
    v_exp_f32 v116, v116
    v_mfma_f32_16x16x32_bf16 v[128:131], a[140:143], v[92:95], v[128:131]
    ds_read_b64_tr_b16 a[178:179], v22 offset:53248
    v_mfma_f32_16x16x32_bf16 v[132:135], a[156:159], v[92:95], v[216:219]
    v_exp_f32 v117, v117
    v_mfma_f32_16x16x32_bf16 v[132:135], a[152:155], v[88:91], v[132:135]
    ds_read_b64_tr_b16 a[180:181], v22 offset:57344
    v_cvt_pk_bf16_f32 v146, v116, v117
    v_mfma_f32_16x16x32_bf16 v[132:135], a[148:151], v[84:87], v[132:135]
    v_exp_f32 v118, v118
    v_mfma_f32_16x16x32_bf16 v[132:135], a[144:147], v[80:83], v[132:135]
    ds_read_b64_tr_b16 a[182:183], v22 offset:61440
    v_mfma_f32_16x16x32_bf16 v[140:143], a[144:147], v[96:99], v[220:223]
    buffer_load_dwordx4 v247, s[64:67], s33 offen offset:3072 lds
    v_exp_f32 v119, v119
    v_mfma_f32_16x16x32_bf16 v[140:143], a[148:151], v[100:103], v[140:143]
    ds_read_b64_tr_b16 a[184:185], v23 offset:49152
    v_cvt_pk_bf16_f32 v147, v118, v119
    v_mfma_f32_16x16x32_bf16 v[140:143], a[152:155], v[104:107], v[140:143]
    v_exp_f32 v120, v120
    v_mfma_f32_16x16x32_bf16 v[140:143], a[156:159], v[108:111], v[140:143]
    ds_read_b64_tr_b16 a[186:187], v23 offset:53248
    v_mfma_f32_16x16x32_bf16 v[136:139], a[140:143], v[108:111], v[220:223]
    buffer_load_dword v14, v255, s[80:83], 0 offen offset:128 sc1
    v_exp_f32 v121, v121
    v_mfma_f32_16x16x32_bf16 v[136:139], a[136:139], v[104:107], v[136:139]
    ds_read_b64_tr_b16 a[188:189], v23 offset:57344
    v_cvt_pk_bf16_f32 v148, v120, v121
    v_mfma_f32_16x16x32_bf16 v[136:139], a[132:135], v[100:103], v[136:139]
    s_waitcnt lgkmcnt(2)
    v_exp_f32 v122, v122
    v_mfma_f32_16x16x32_bf16 v[136:139], a[128:131], v[96:99], v[136:139]
    ds_read_b64_tr_b16 a[190:191], v23 offset:61440
    v_mfma_f32_16x16x32_bf16 a[0:3], v[176:179], a[160:163], a[0:3]
    s_add_u32 s52, s45, 327680
    v_exp_f32 v123, v123
    v_mfma_f32_16x16x32_bf16 a[0:3], v[192:195], a[164:167], a[0:3]
    buffer_load_dword v46, v15, s[64:67], s52 offen
    v_cvt_pk_bf16_f32 v149, v122, v123
    v_mfma_f32_16x16x32_bf16 a[32:35], v[196:199], a[164:167], a[32:35]
    v_exp_f32 v124, v124
    v_mfma_f32_16x16x32_bf16 a[32:35], v[180:183], a[160:163], a[32:35]
    v_mfma_f32_16x16x32_bf16 a[64:67], v[184:187], a[160:163], a[64:67]
    s_waitcnt lgkmcnt(0)
    v_exp_f32 v125, v125
    v_mfma_f32_16x16x32_bf16 a[64:67], v[200:203], a[164:167], a[64:67]
    v_cvt_pk_bf16_f32 v150, v124, v125
    v_mfma_f32_16x16x32_bf16 a[96:99], v[204:207], a[164:167], a[96:99]
    s_add_u32 m0, s96, 98304
    v_exp_f32 v126, v126
    v_mfma_f32_16x16x32_bf16 a[96:99], v[188:191], a[160:163], a[96:99]
    buffer_load_dwordx4 v32, s[20:23], s95 offen offset:0 nt lds
    v_mfma_f32_16x16x32_bf16 a[100:103], v[188:191], a[168:171], a[100:103]
    v_exp_f32 v127, v127
    v_mfma_f32_16x16x32_bf16 a[100:103], v[204:207], a[172:175], a[100:103]
    ds_read_b128 a[128:131], v16 offset:8192
    v_cvt_pk_bf16_f32 v151, v126, v127
    v_mfma_f32_16x16x32_bf16 a[68:71], v[200:203], a[172:175], a[68:71]
    v_exp_f32 v128, v128
    v_mfma_f32_16x16x32_bf16 a[68:71], v[184:187], a[168:171], a[68:71]
    ds_read_b128 a[132:135], v17 offset:8192
    v_mfma_f32_16x16x32_bf16 a[36:39], v[180:183], a[168:171], a[36:39]
    v_exp_f32 v129, v129
    v_mfma_f32_16x16x32_bf16 a[36:39], v[196:199], a[172:175], a[36:39]
    buffer_load_dwordx4 v33, s[20:23], s95 offen offset:1024 nt lds
    v_mfma_f32_16x16x32_bf16 a[4:7], v[192:195], a[172:175], a[4:7]
    v_exp_f32 v130, v130
    v_mfma_f32_16x16x32_bf16 a[4:7], v[176:179], a[168:171], a[4:7]
    ds_read_b128 a[136:139], v18 offset:8192
    v_cvt_pk_bf16_f32 v152, v128, v129
    v_mfma_f32_16x16x32_bf16 a[8:11], v[176:179], a[176:179], a[8:11]
    v_exp_f32 v131, v131
    v_mfma_f32_16x16x32_bf16 a[8:11], v[192:195], a[180:183], a[8:11]
    ds_read_b128 a[140:143], v19 offset:8192
    v_cvt_pk_bf16_f32 v153, v130, v131
    v_mfma_f32_16x16x32_bf16 a[40:43], v[196:199], a[180:183], a[40:43]
    v_exp_f32 v132, v132
    v_mfma_f32_16x16x32_bf16 a[40:43], v[180:183], a[176:179], a[40:43]
    buffer_load_dwordx4 v32, s[20:23], s95 offen offset:2048 nt lds
    v_mfma_f32_16x16x32_bf16 a[72:75], v[184:187], a[176:179], a[72:75]
    v_exp_f32 v133, v133
    v_mfma_f32_16x16x32_bf16 a[72:75], v[200:203], a[180:183], a[72:75]
    ds_read_b128 a[144:147], v16 offset:12288
    v_cvt_pk_bf16_f32 v154, v132, v133
    v_mfma_f32_16x16x32_bf16 a[104:107], v[204:207], a[180:183], a[104:107]
    v_exp_f32 v134, v134
    v_mfma_f32_16x16x32_bf16 a[104:107], v[188:191], a[176:179], a[104:107]
    ds_read_b128 a[148:151], v17 offset:12288
    v_mfma_f32_16x16x32_bf16 a[108:111], v[188:191], a[184:187], a[108:111]
    v_exp_f32 v135, v135
    v_mfma_f32_16x16x32_bf16 a[108:111], v[204:207], a[188:191], a[108:111]
    buffer_load_dwordx4 v33, s[20:23], s95 offen offset:3072 nt lds
    v_mfma_f32_16x16x32_bf16 a[76:79], v[200:203], a[188:191], a[76:79]
    s_add_u32 s95, s95, 16384
    v_exp_f32 v136, v136
    v_mfma_f32_16x16x32_bf16 a[76:79], v[184:187], a[184:187], a[76:79]
    ds_read_b128 a[152:155], v18 offset:12288
    v_cvt_pk_bf16_f32 v155, v134, v135
    v_mfma_f32_16x16x32_bf16 a[44:47], v[180:183], a[184:187], a[44:47]
    v_exp_f32 v137, v137
    v_mfma_f32_16x16x32_bf16 a[44:47], v[196:199], a[188:191], a[44:47]
    ds_read_b128 a[156:159], v19 offset:12288
    v_cvt_pk_bf16_f32 v156, v136, v137
    v_mfma_f32_16x16x32_bf16 a[12:15], v[192:195], a[188:191], a[12:15]
    v_exp_f32 v138, v138
    v_mfma_f32_16x16x32_bf16 a[12:15], v[176:179], a[184:187], a[12:15]
    v_mfma_f32_16x16x32_bf16 v[224:227], v[176:179], v[248:251], v[224:227]
    v_exp_f32 v139, v139
    v_mfma_f32_16x16x32_bf16 v[224:227], v[192:195], v[248:251], v[224:227]
    v_cvt_pk_bf16_f32 v157, v138, v139
    v_mfma_f32_16x16x32_bf16 v[228:231], v[196:199], v[248:251], v[228:231]
    v_exp_f32 v140, v140
    v_mfma_f32_16x16x32_bf16 v[228:231], v[180:183], v[248:251], v[228:231]
    s_waitcnt lgkmcnt(0)
    v_mfma_f32_16x16x32_bf16 v[112:115], a[128:131], v[48:51], v[208:211]
    v_exp_f32 v141, v141
    v_mfma_f32_16x16x32_bf16 v[112:115], a[132:135], v[52:55], v[112:115]
    ds_read_b64_tr_b16 a[160:161], v24 offset:49152
    v_cvt_pk_bf16_f32 v158, v140, v141
    v_mfma_f32_16x16x32_bf16 v[112:115], a[136:139], v[56:59], v[112:115]
    s_add_u32 s33, s98, 1152000
    v_exp_f32 v142, v142
    v_mfma_f32_16x16x32_bf16 v[112:115], a[140:143], v[60:63], v[112:115]
    ds_read_b64_tr_b16 a[162:163], v24 offset:53248
    v_mfma_f32_16x16x32_bf16 v[116:119], a[156:159], v[60:63], v[208:211]
    s_add_u32 m0, s47, 4096
    v_exp_f32 v143, v143
    v_mfma_f32_16x16x32_bf16 v[116:119], a[152:155], v[56:59], v[116:119]
    ds_read_b64_tr_b16 a[164:165], v24 offset:57344
    v_cvt_pk_bf16_f32 v159, v142, v143
    v_mfma_f32_16x16x32_bf16 v[116:119], a[148:151], v[52:55], v[116:119]
    buffer_load_dwordx4 v244, s[64:67], s33 offen offset:0 lds
    v_mfma_f32_16x16x32_bf16 v[116:119], a[144:147], v[48:51], v[116:119]
    ds_read_b64_tr_b16 a[166:167], v24 offset:61440
    v_mfma_f32_16x16x32_bf16 v[124:127], a[144:147], v[64:67], v[212:215]
    v_mfma_f32_16x16x32_bf16 v[124:127], a[148:151], v[68:71], v[124:127]
    ds_read_b64_tr_b16 a[168:169], v25 offset:49152
    v_mfma_f32_16x16x32_bf16 v[124:127], a[152:155], v[72:75], v[124:127]
    v_exp_f32 v112, v112
    v_mfma_f32_16x16x32_bf16 v[124:127], a[156:159], v[76:79], v[124:127]
    ds_read_b64_tr_b16 a[170:171], v25 offset:53248
    v_mfma_f32_16x16x32_bf16 v[120:123], a[140:143], v[76:79], v[212:215]
    buffer_load_dwordx4 v245, s[64:67], s33 offen offset:1024 lds
    v_exp_f32 v113, v113
    v_mfma_f32_16x16x32_bf16 v[120:123], a[136:139], v[72:75], v[120:123]
    ds_read_b64_tr_b16 a[172:173], v25 offset:57344
    v_cvt_pk_bf16_f32 v160, v112, v113
    v_mfma_f32_16x16x32_bf16 v[120:123], a[132:135], v[68:71], v[120:123]
    v_exp_f32 v114, v114
    v_mfma_f32_16x16x32_bf16 v[120:123], a[128:131], v[64:67], v[120:123]
    ds_read_b64_tr_b16 a[174:175], v25 offset:61440
    v_mfma_f32_16x16x32_bf16 v[128:131], a[128:131], v[80:83], v[216:219]
    v_exp_f32 v115, v115
    v_mfma_f32_16x16x32_bf16 v[128:131], a[132:135], v[84:87], v[128:131]
    ds_read_b64_tr_b16 a[176:177], v26 offset:49152
    v_cvt_pk_bf16_f32 v161, v114, v115
    v_mfma_f32_16x16x32_bf16 v[128:131], a[136:139], v[88:91], v[128:131]
    buffer_load_dwordx4 v246, s[64:67], s33 offen offset:2048 lds
    v_exp_f32 v116, v116
    v_mfma_f32_16x16x32_bf16 v[128:131], a[140:143], v[92:95], v[128:131]
    ds_read_b64_tr_b16 a[178:179], v26 offset:53248
    v_mfma_f32_16x16x32_bf16 v[132:135], a[156:159], v[92:95], v[216:219]
    v_exp_f32 v117, v117
    v_mfma_f32_16x16x32_bf16 v[132:135], a[152:155], v[88:91], v[132:135]
    ds_read_b64_tr_b16 a[180:181], v26 offset:57344
    v_cvt_pk_bf16_f32 v162, v116, v117
    v_mfma_f32_16x16x32_bf16 v[132:135], a[148:151], v[84:87], v[132:135]
    v_exp_f32 v118, v118
    v_mfma_f32_16x16x32_bf16 v[132:135], a[144:147], v[80:83], v[132:135]
    ds_read_b64_tr_b16 a[182:183], v26 offset:61440
    v_mfma_f32_16x16x32_bf16 v[140:143], a[144:147], v[96:99], v[220:223]
    buffer_load_dwordx4 v247, s[64:67], s33 offen offset:3072 lds
    v_exp_f32 v119, v119
    v_mfma_f32_16x16x32_bf16 v[140:143], a[148:151], v[100:103], v[140:143]
    ds_read_b64_tr_b16 a[184:185], v27 offset:49152
    v_cvt_pk_bf16_f32 v163, v118, v119
    v_mfma_f32_16x16x32_bf16 v[140:143], a[152:155], v[104:107], v[140:143]
    v_exp_f32 v120, v120
    v_mfma_f32_16x16x32_bf16 v[140:143], a[156:159], v[108:111], v[140:143]
    ds_read_b64_tr_b16 a[186:187], v27 offset:53248
    v_mfma_f32_16x16x32_bf16 v[136:139], a[140:143], v[108:111], v[220:223]
    v_exp_f32 v121, v121
    v_mfma_f32_16x16x32_bf16 v[136:139], a[136:139], v[104:107], v[136:139]
    ds_read_b64_tr_b16 a[188:189], v27 offset:57344
    v_cvt_pk_bf16_f32 v164, v120, v121
    v_mfma_f32_16x16x32_bf16 v[136:139], a[132:135], v[100:103], v[136:139]
    s_waitcnt lgkmcnt(2)
    v_exp_f32 v122, v122
    v_mfma_f32_16x16x32_bf16 v[136:139], a[128:131], v[96:99], v[136:139]
    ds_read_b64_tr_b16 a[190:191], v27 offset:61440
    v_mfma_f32_16x16x32_bf16 a[16:19], v[176:179], a[160:163], a[16:19]
    s_add_u32 s52, s45, 373760
    v_exp_f32 v123, v123
    v_mfma_f32_16x16x32_bf16 a[16:19], v[192:195], a[164:167], a[16:19]
    buffer_load_dword v47, v15, s[64:67], s52 offen
    v_cvt_pk_bf16_f32 v165, v122, v123
    v_mfma_f32_16x16x32_bf16 a[48:51], v[196:199], a[164:167], a[48:51]
    s_add_u32 s33, s98, 1157120
    v_exp_f32 v124, v124
    v_mfma_f32_16x16x32_bf16 a[48:51], v[180:183], a[160:163], a[48:51]
    v_mfma_f32_16x16x32_bf16 a[80:83], v[184:187], a[160:163], a[80:83]
    s_waitcnt vmcnt(27) lgkmcnt(0)
    v_exp_f32 v125, v125
    v_mfma_f32_16x16x32_bf16 a[80:83], v[200:203], a[164:167], a[80:83]
    s_barrier
    v_cvt_pk_bf16_f32 v166, v124, v125
    v_mfma_f32_16x16x32_bf16 a[112:115], v[204:207], a[164:167], a[112:115]
    s_add_u32 m0, s96, 0
    v_exp_f32 v126, v126
    v_mfma_f32_16x16x32_bf16 a[112:115], v[188:191], a[160:163], a[112:115]
    buffer_load_dwordx4 v244, s[64:67], s33 offen offset:0 lds
    v_mfma_f32_16x16x32_bf16 a[116:119], v[188:191], a[168:171], a[116:119]
    v_exp_f32 v127, v127
    v_mfma_f32_16x16x32_bf16 a[116:119], v[204:207], a[172:175], a[116:119]
    ds_read_b128 a[128:131], v16 offset:16384
    v_cvt_pk_bf16_f32 v167, v126, v127
    v_mfma_f32_16x16x32_bf16 a[84:87], v[200:203], a[172:175], a[84:87]
    v_exp_f32 v128, v128
    v_mfma_f32_16x16x32_bf16 a[84:87], v[184:187], a[168:171], a[84:87]
    ds_read_b128 a[132:135], v17 offset:16384
    v_mfma_f32_16x16x32_bf16 a[52:55], v[180:183], a[168:171], a[52:55]
    v_exp_f32 v129, v129
    v_mfma_f32_16x16x32_bf16 a[52:55], v[196:199], a[172:175], a[52:55]
    buffer_load_dwordx4 v245, s[64:67], s33 offen offset:1024 lds
    v_mfma_f32_16x16x32_bf16 a[20:23], v[192:195], a[172:175], a[20:23]
    v_exp_f32 v130, v130
    v_mfma_f32_16x16x32_bf16 a[20:23], v[176:179], a[168:171], a[20:23]
    ds_read_b128 a[136:139], v18 offset:16384
    v_cvt_pk_bf16_f32 v168, v128, v129
    v_mfma_f32_16x16x32_bf16 a[24:27], v[176:179], a[176:179], a[24:27]
    v_exp_f32 v131, v131
    v_mfma_f32_16x16x32_bf16 a[24:27], v[192:195], a[180:183], a[24:27]
    ds_read_b128 a[140:143], v19 offset:16384
    v_cvt_pk_bf16_f32 v169, v130, v131
    v_mfma_f32_16x16x32_bf16 a[56:59], v[196:199], a[180:183], a[56:59]
    v_exp_f32 v132, v132
    v_mfma_f32_16x16x32_bf16 a[56:59], v[180:183], a[176:179], a[56:59]
    buffer_load_dwordx4 v246, s[64:67], s33 offen offset:2048 lds
    v_mfma_f32_16x16x32_bf16 a[88:91], v[184:187], a[176:179], a[88:91]
    v_exp_f32 v133, v133
    v_mfma_f32_16x16x32_bf16 a[88:91], v[200:203], a[180:183], a[88:91]
    ds_read_b128 a[144:147], v16 offset:20480
    v_cvt_pk_bf16_f32 v170, v132, v133
    v_mfma_f32_16x16x32_bf16 a[120:123], v[204:207], a[180:183], a[120:123]
    v_exp_f32 v134, v134
    v_mfma_f32_16x16x32_bf16 a[120:123], v[188:191], a[176:179], a[120:123]
    ds_read_b128 a[148:151], v17 offset:20480
    v_mfma_f32_16x16x32_bf16 a[124:127], v[188:191], a[184:187], a[124:127]
    v_exp_f32 v135, v135
    v_mfma_f32_16x16x32_bf16 a[124:127], v[204:207], a[188:191], a[124:127]
    buffer_load_dwordx4 v247, s[64:67], s33 offen offset:3072 lds
    v_mfma_f32_16x16x32_bf16 a[92:95], v[200:203], a[188:191], a[92:95]
    v_exp_f32 v136, v136
    v_mfma_f32_16x16x32_bf16 a[92:95], v[184:187], a[184:187], a[92:95]
    ds_read_b128 a[152:155], v18 offset:20480
    v_cvt_pk_bf16_f32 v171, v134, v135
    v_mfma_f32_16x16x32_bf16 a[60:63], v[180:183], a[184:187], a[60:63]
    v_exp_f32 v137, v137
    v_mfma_f32_16x16x32_bf16 a[60:63], v[196:199], a[188:191], a[60:63]
    ds_read_b128 a[156:159], v19 offset:20480
    v_cvt_pk_bf16_f32 v172, v136, v137
    v_mfma_f32_16x16x32_bf16 a[28:31], v[192:195], a[188:191], a[28:31]
    v_exp_f32 v138, v138
    v_mfma_f32_16x16x32_bf16 a[28:31], v[176:179], a[184:187], a[28:31]
    v_mfma_f32_16x16x32_bf16 v[232:235], v[184:187], v[248:251], v[232:235]
    v_exp_f32 v139, v139
    v_mfma_f32_16x16x32_bf16 v[232:235], v[200:203], v[248:251], v[232:235]
    v_cvt_pk_bf16_f32 v173, v138, v139
    v_mfma_f32_16x16x32_bf16 v[236:239], v[204:207], v[248:251], v[236:239]
    v_exp_f32 v140, v140
    v_mfma_f32_16x16x32_bf16 v[236:239], v[188:191], v[248:251], v[236:239]
    s_waitcnt lgkmcnt(0)
    v_mfma_f32_16x16x32_bf16 v[112:115], a[128:131], v[48:51], v[208:211]
    v_exp_f32 v141, v141
    v_mfma_f32_16x16x32_bf16 v[112:115], a[132:135], v[52:55], v[112:115]
    ds_read_b64_tr_b16 a[160:161], v20 offset:0
    v_cvt_pk_bf16_f32 v174, v140, v141
    v_mfma_f32_16x16x32_bf16 v[112:115], a[136:139], v[56:59], v[112:115]
    v_exp_f32 v142, v142
    v_mfma_f32_16x16x32_bf16 v[112:115], a[140:143], v[60:63], v[112:115]
    ds_read_b64_tr_b16 a[162:163], v20 offset:4096
    v_mfma_f32_16x16x32_bf16 v[116:119], a[156:159], v[60:63], v[208:211]
    v_exp_f32 v143, v143
    v_mfma_f32_16x16x32_bf16 v[116:119], a[152:155], v[56:59], v[116:119]
    ds_read_b64_tr_b16 a[164:165], v20 offset:8192
    v_cvt_pk_bf16_f32 v175, v142, v143
    v_mfma_f32_16x16x32_bf16 v[116:119], a[148:151], v[52:55], v[116:119]
    v_mfma_f32_16x16x32_bf16 v[116:119], a[144:147], v[48:51], v[116:119]
    ds_read_b64_tr_b16 a[166:167], v20 offset:12288
    v_mfma_f32_16x16x32_bf16 v[124:127], a[144:147], v[64:67], v[212:215]
    v_mfma_f32_16x16x32_bf16 v[124:127], a[148:151], v[68:71], v[124:127]
    ds_read_b64_tr_b16 a[168:169], v21 offset:0
    v_mfma_f32_16x16x32_bf16 v[124:127], a[152:155], v[72:75], v[124:127]
    v_exp_f32 v112, v112
    v_mfma_f32_16x16x32_bf16 v[124:127], a[156:159], v[76:79], v[124:127]
    ds_read_b64_tr_b16 a[170:171], v21 offset:4096
    v_mfma_f32_16x16x32_bf16 v[120:123], a[140:143], v[76:79], v[212:215]
    v_exp_f32 v113, v113
    v_mfma_f32_16x16x32_bf16 v[120:123], a[136:139], v[72:75], v[120:123]
    ds_read_b64_tr_b16 a[172:173], v21 offset:8192
    v_cvt_pk_bf16_f32 v176, v112, v113
    v_mfma_f32_16x16x32_bf16 v[120:123], a[132:135], v[68:71], v[120:123]
    v_exp_f32 v114, v114
    v_mfma_f32_16x16x32_bf16 v[120:123], a[128:131], v[64:67], v[120:123]
    ds_read_b64_tr_b16 a[174:175], v21 offset:12288
    v_mfma_f32_16x16x32_bf16 v[128:131], a[128:131], v[80:83], v[216:219]
    v_exp_f32 v115, v115
    v_mfma_f32_16x16x32_bf16 v[128:131], a[132:135], v[84:87], v[128:131]
    ds_read_b64_tr_b16 a[176:177], v22 offset:0
    v_cvt_pk_bf16_f32 v177, v114, v115
    v_mfma_f32_16x16x32_bf16 v[128:131], a[136:139], v[88:91], v[128:131]
    v_exp_f32 v116, v116
    v_mfma_f32_16x16x32_bf16 v[128:131], a[140:143], v[92:95], v[128:131]
    ds_read_b64_tr_b16 a[178:179], v22 offset:4096
    v_mfma_f32_16x16x32_bf16 v[132:135], a[156:159], v[92:95], v[216:219]
    v_exp_f32 v117, v117
    v_mfma_f32_16x16x32_bf16 v[132:135], a[152:155], v[88:91], v[132:135]
    ds_read_b64_tr_b16 a[180:181], v22 offset:8192
    v_cvt_pk_bf16_f32 v178, v116, v117
    v_mfma_f32_16x16x32_bf16 v[132:135], a[148:151], v[84:87], v[132:135]
    v_exp_f32 v118, v118
    v_mfma_f32_16x16x32_bf16 v[132:135], a[144:147], v[80:83], v[132:135]
    ds_read_b64_tr_b16 a[182:183], v22 offset:12288
    v_mfma_f32_16x16x32_bf16 v[140:143], a[144:147], v[96:99], v[220:223]
    v_exp_f32 v119, v119
    v_mfma_f32_16x16x32_bf16 v[140:143], a[148:151], v[100:103], v[140:143]
    ds_read_b64_tr_b16 a[184:185], v23 offset:0
    v_cvt_pk_bf16_f32 v179, v118, v119
    v_mfma_f32_16x16x32_bf16 v[140:143], a[152:155], v[104:107], v[140:143]
    v_exp_f32 v120, v120
    v_mfma_f32_16x16x32_bf16 v[140:143], a[156:159], v[108:111], v[140:143]
    ds_read_b64_tr_b16 a[186:187], v23 offset:4096
    v_mfma_f32_16x16x32_bf16 v[136:139], a[140:143], v[108:111], v[220:223]
    v_exp_f32 v121, v121
    v_mfma_f32_16x16x32_bf16 v[136:139], a[136:139], v[104:107], v[136:139]
    ds_read_b64_tr_b16 a[188:189], v23 offset:8192
    v_cvt_pk_bf16_f32 v180, v120, v121
    v_mfma_f32_16x16x32_bf16 v[136:139], a[132:135], v[100:103], v[136:139]
    s_waitcnt lgkmcnt(2)
    v_exp_f32 v122, v122
    v_mfma_f32_16x16x32_bf16 v[136:139], a[128:131], v[96:99], v[136:139]
    ds_read_b64_tr_b16 a[190:191], v23 offset:12288
    v_mfma_f32_16x16x32_bf16 a[0:3], v[144:147], a[160:163], a[0:3]
    s_add_u32 s52, s45, 419840
    v_exp_f32 v123, v123
    v_mfma_f32_16x16x32_bf16 a[0:3], v[160:163], a[164:167], a[0:3]
    buffer_load_dword v242, v15, s[64:67], s52 offen
    v_cvt_pk_bf16_f32 v181, v122, v123
    v_mfma_f32_16x16x32_bf16 a[32:35], v[164:167], a[164:167], a[32:35]
    v_exp_f32 v124, v124
    v_mfma_f32_16x16x32_bf16 a[32:35], v[148:151], a[160:163], a[32:35]
    v_mfma_f32_16x16x32_bf16 a[64:67], v[152:155], a[160:163], a[64:67]
    s_waitcnt lgkmcnt(0)
    v_exp_f32 v125, v125
    v_mfma_f32_16x16x32_bf16 a[64:67], v[168:171], a[164:167], a[64:67]
    v_cvt_pk_bf16_f32 v182, v124, v125
    v_mfma_f32_16x16x32_bf16 a[96:99], v[172:175], a[164:167], a[96:99]
    s_add_u32 m0, s96, 114688
    v_exp_f32 v126, v126
    v_mfma_f32_16x16x32_bf16 a[96:99], v[156:159], a[160:163], a[96:99]
    buffer_load_dwordx4 v32, s[20:23], s95 offen offset:0 nt lds
    v_mfma_f32_16x16x32_bf16 a[100:103], v[156:159], a[168:171], a[100:103]
    v_exp_f32 v127, v127
    v_mfma_f32_16x16x32_bf16 a[100:103], v[172:175], a[172:175], a[100:103]
    ds_read_b128 a[128:131], v16 offset:24576
    v_cvt_pk_bf16_f32 v183, v126, v127
    v_mfma_f32_16x16x32_bf16 a[68:71], v[168:171], a[172:175], a[68:71]
    v_exp_f32 v128, v128
    v_mfma_f32_16x16x32_bf16 a[68:71], v[152:155], a[168:171], a[68:71]
    ds_read_b128 a[132:135], v17 offset:24576
    v_mfma_f32_16x16x32_bf16 a[36:39], v[148:151], a[168:171], a[36:39]
    v_exp_f32 v129, v129
    v_mfma_f32_16x16x32_bf16 a[36:39], v[164:167], a[172:175], a[36:39]
    buffer_load_dwordx4 v33, s[20:23], s95 offen offset:1024 nt lds
    v_mfma_f32_16x16x32_bf16 a[4:7], v[160:163], a[172:175], a[4:7]
    v_exp_f32 v130, v130
    v_mfma_f32_16x16x32_bf16 a[4:7], v[144:147], a[168:171], a[4:7]
    ds_read_b128 a[136:139], v18 offset:24576
    v_cvt_pk_bf16_f32 v184, v128, v129
    v_mfma_f32_16x16x32_bf16 a[8:11], v[144:147], a[176:179], a[8:11]
    v_exp_f32 v131, v131
    v_mfma_f32_16x16x32_bf16 a[8:11], v[160:163], a[180:183], a[8:11]
    ds_read_b128 a[140:143], v19 offset:24576
    v_cvt_pk_bf16_f32 v185, v130, v131
    v_mfma_f32_16x16x32_bf16 a[40:43], v[164:167], a[180:183], a[40:43]
    v_exp_f32 v132, v132
    v_mfma_f32_16x16x32_bf16 a[40:43], v[148:151], a[176:179], a[40:43]
    buffer_load_dwordx4 v32, s[20:23], s95 offen offset:2048 nt lds
    v_mfma_f32_16x16x32_bf16 a[72:75], v[152:155], a[176:179], a[72:75]
    v_exp_f32 v133, v133
    v_mfma_f32_16x16x32_bf16 a[72:75], v[168:171], a[180:183], a[72:75]
    ds_read_b128 a[144:147], v16 offset:28672
    v_cvt_pk_bf16_f32 v186, v132, v133
    v_mfma_f32_16x16x32_bf16 a[104:107], v[172:175], a[180:183], a[104:107]
    v_exp_f32 v134, v134
    v_mfma_f32_16x16x32_bf16 a[104:107], v[156:159], a[176:179], a[104:107]
    ds_read_b128 a[148:151], v17 offset:28672
    v_mfma_f32_16x16x32_bf16 a[108:111], v[156:159], a[184:187], a[108:111]
    v_exp_f32 v135, v135
    v_mfma_f32_16x16x32_bf16 a[108:111], v[172:175], a[188:191], a[108:111]
    buffer_load_dwordx4 v33, s[20:23], s95 offen offset:3072 nt lds
    v_mfma_f32_16x16x32_bf16 a[76:79], v[168:171], a[188:191], a[76:79]
    s_add_u32 s95, s95, 16384
    v_exp_f32 v136, v136
    v_mfma_f32_16x16x32_bf16 a[76:79], v[152:155], a[184:187], a[76:79]
    ds_read_b128 a[152:155], v18 offset:28672
    v_cvt_pk_bf16_f32 v187, v134, v135
    v_mfma_f32_16x16x32_bf16 a[44:47], v[148:151], a[184:187], a[44:47]
    v_exp_f32 v137, v137
    v_mfma_f32_16x16x32_bf16 a[44:47], v[164:167], a[188:191], a[44:47]
    ds_read_b128 a[156:159], v19 offset:28672
    v_cvt_pk_bf16_f32 v188, v136, v137
    v_mfma_f32_16x16x32_bf16 a[12:15], v[160:163], a[188:191], a[12:15]
    v_exp_f32 v138, v138
    v_mfma_f32_16x16x32_bf16 a[12:15], v[144:147], a[184:187], a[12:15]
    v_mfma_f32_16x16x32_bf16 v[224:227], v[144:147], v[248:251], v[224:227]
    v_exp_f32 v139, v139
    v_mfma_f32_16x16x32_bf16 v[224:227], v[160:163], v[248:251], v[224:227]
    v_cvt_pk_bf16_f32 v189, v138, v139
    v_mfma_f32_16x16x32_bf16 v[228:231], v[164:167], v[248:251], v[228:231]
    v_exp_f32 v140, v140
    v_mfma_f32_16x16x32_bf16 v[228:231], v[148:151], v[248:251], v[228:231]
    s_waitcnt lgkmcnt(0)
    v_mfma_f32_16x16x32_bf16 v[112:115], a[128:131], v[48:51], v[208:211]
    v_exp_f32 v141, v141
    v_mfma_f32_16x16x32_bf16 v[112:115], a[132:135], v[52:55], v[112:115]
    ds_read_b64_tr_b16 a[160:161], v24 offset:0
    v_cvt_pk_bf16_f32 v190, v140, v141
    v_mfma_f32_16x16x32_bf16 v[112:115], a[136:139], v[56:59], v[112:115]
    v_exp_f32 v142, v142
    v_mfma_f32_16x16x32_bf16 v[112:115], a[140:143], v[60:63], v[112:115]
    ds_read_b64_tr_b16 a[162:163], v24 offset:4096
    v_mfma_f32_16x16x32_bf16 v[116:119], a[156:159], v[60:63], v[208:211]
    v_exp_f32 v143, v143
    v_mfma_f32_16x16x32_bf16 v[116:119], a[152:155], v[56:59], v[116:119]
    ds_read_b64_tr_b16 a[164:165], v24 offset:8192
    v_cvt_pk_bf16_f32 v191, v142, v143
    v_mfma_f32_16x16x32_bf16 v[116:119], a[148:151], v[52:55], v[116:119]
    v_mfma_f32_16x16x32_bf16 v[116:119], a[144:147], v[48:51], v[116:119]
    ds_read_b64_tr_b16 a[166:167], v24 offset:12288
    v_mfma_f32_16x16x32_bf16 v[124:127], a[144:147], v[64:67], v[212:215]
    v_mfma_f32_16x16x32_bf16 v[124:127], a[148:151], v[68:71], v[124:127]
    ds_read_b64_tr_b16 a[168:169], v25 offset:0
    v_mfma_f32_16x16x32_bf16 v[124:127], a[152:155], v[72:75], v[124:127]
    v_exp_f32 v112, v112
    v_mfma_f32_16x16x32_bf16 v[124:127], a[156:159], v[76:79], v[124:127]
    ds_read_b64_tr_b16 a[170:171], v25 offset:4096
    v_mfma_f32_16x16x32_bf16 v[120:123], a[140:143], v[76:79], v[212:215]
    v_exp_f32 v113, v113
    v_mfma_f32_16x16x32_bf16 v[120:123], a[136:139], v[72:75], v[120:123]
    ds_read_b64_tr_b16 a[172:173], v25 offset:8192
    v_cvt_pk_bf16_f32 v192, v112, v113
    v_mfma_f32_16x16x32_bf16 v[120:123], a[132:135], v[68:71], v[120:123]
    v_exp_f32 v114, v114
    v_mfma_f32_16x16x32_bf16 v[120:123], a[128:131], v[64:67], v[120:123]
    ds_read_b64_tr_b16 a[174:175], v25 offset:12288
    v_mfma_f32_16x16x32_bf16 v[128:131], a[128:131], v[80:83], v[216:219]
    v_exp_f32 v115, v115
    v_mfma_f32_16x16x32_bf16 v[128:131], a[132:135], v[84:87], v[128:131]
    ds_read_b64_tr_b16 a[176:177], v26 offset:0
    v_cvt_pk_bf16_f32 v193, v114, v115
    v_mfma_f32_16x16x32_bf16 v[128:131], a[136:139], v[88:91], v[128:131]
    v_exp_f32 v116, v116
    v_mfma_f32_16x16x32_bf16 v[128:131], a[140:143], v[92:95], v[128:131]
    ds_read_b64_tr_b16 a[178:179], v26 offset:4096
    v_mfma_f32_16x16x32_bf16 v[132:135], a[156:159], v[92:95], v[216:219]
    v_exp_f32 v117, v117
    v_mfma_f32_16x16x32_bf16 v[132:135], a[152:155], v[88:91], v[132:135]
    ds_read_b64_tr_b16 a[180:181], v26 offset:8192
    v_cvt_pk_bf16_f32 v194, v116, v117
    v_mfma_f32_16x16x32_bf16 v[132:135], a[148:151], v[84:87], v[132:135]
    v_exp_f32 v118, v118
    v_mfma_f32_16x16x32_bf16 v[132:135], a[144:147], v[80:83], v[132:135]
    ds_read_b64_tr_b16 a[182:183], v26 offset:12288
    v_mfma_f32_16x16x32_bf16 v[140:143], a[144:147], v[96:99], v[220:223]
    v_exp_f32 v119, v119
    v_mfma_f32_16x16x32_bf16 v[140:143], a[148:151], v[100:103], v[140:143]
    ds_read_b64_tr_b16 a[184:185], v27 offset:0
    v_cvt_pk_bf16_f32 v195, v118, v119
    v_mfma_f32_16x16x32_bf16 v[140:143], a[152:155], v[104:107], v[140:143]
    v_exp_f32 v120, v120
    v_mfma_f32_16x16x32_bf16 v[140:143], a[156:159], v[108:111], v[140:143]
    ds_read_b64_tr_b16 a[186:187], v27 offset:4096
    v_mfma_f32_16x16x32_bf16 v[136:139], a[140:143], v[108:111], v[220:223]
    v_exp_f32 v121, v121
    v_mfma_f32_16x16x32_bf16 v[136:139], a[136:139], v[104:107], v[136:139]
    ds_read_b64_tr_b16 a[188:189], v27 offset:8192
    v_cvt_pk_bf16_f32 v196, v120, v121
    v_mfma_f32_16x16x32_bf16 v[136:139], a[132:135], v[100:103], v[136:139]
    s_waitcnt lgkmcnt(2)
    v_exp_f32 v122, v122
    v_mfma_f32_16x16x32_bf16 v[136:139], a[128:131], v[96:99], v[136:139]
    ds_read_b64_tr_b16 a[190:191], v27 offset:12288
    v_mfma_f32_16x16x32_bf16 a[16:19], v[144:147], a[160:163], a[16:19]
    s_add_u32 s52, s45, 465920
    v_exp_f32 v123, v123
    v_mfma_f32_16x16x32_bf16 a[16:19], v[160:163], a[164:167], a[16:19]
    buffer_load_dword v252, v15, s[64:67], s52 offen
    v_cvt_pk_bf16_f32 v197, v122, v123
    v_mfma_f32_16x16x32_bf16 a[48:51], v[164:167], a[164:167], a[48:51]
    s_add_u32 s33, s98, 1162240
    v_exp_f32 v124, v124
    v_mfma_f32_16x16x32_bf16 a[48:51], v[148:151], a[160:163], a[48:51]
    v_mfma_f32_16x16x32_bf16 a[80:83], v[152:155], a[160:163], a[80:83]
    s_waitcnt vmcnt(21) lgkmcnt(0)
    v_exp_f32 v125, v125
    v_mfma_f32_16x16x32_bf16 a[80:83], v[168:171], a[164:167], a[80:83]
    s_barrier
    v_cvt_pk_bf16_f32 v198, v124, v125
    v_mfma_f32_16x16x32_bf16 a[112:115], v[172:175], a[164:167], a[112:115]
    s_add_u32 m0, s96, 16384
    v_exp_f32 v126, v126
    v_mfma_f32_16x16x32_bf16 a[112:115], v[156:159], a[160:163], a[112:115]
    buffer_load_dwordx4 v244, s[64:67], s33 offen offset:0 lds
    v_mfma_f32_16x16x32_bf16 a[116:119], v[156:159], a[168:171], a[116:119]
    ds_read_b64_tr_b16 a[192:193], v42 offset:0
    v_exp_f32 v127, v127
    v_mfma_f32_16x16x32_bf16 a[116:119], v[172:175], a[172:175], a[116:119]
    ds_read_b128 a[128:131], v16 offset:32768
    v_cvt_pk_bf16_f32 v199, v126, v127
    v_mfma_f32_16x16x32_bf16 a[84:87], v[168:171], a[172:175], a[84:87]
    ds_read_b64_tr_b16 a[194:195], v42 offset:2048
    v_exp_f32 v128, v128
    v_mfma_f32_16x16x32_bf16 a[84:87], v[152:155], a[168:171], a[84:87]
    ds_read_b128 a[132:135], v17 offset:32768
    v_mfma_f32_16x16x32_bf16 a[52:55], v[148:151], a[168:171], a[52:55]
    ds_read_b64_tr_b16 a[196:197], v43 offset:0
    v_exp_f32 v129, v129
    v_mfma_f32_16x16x32_bf16 a[52:55], v[164:167], a[172:175], a[52:55]
    buffer_load_dwordx4 v245, s[64:67], s33 offen offset:1024 lds
    v_mfma_f32_16x16x32_bf16 a[20:23], v[160:163], a[172:175], a[20:23]
    v_exp_f32 v130, v130
    v_mfma_f32_16x16x32_bf16 a[20:23], v[144:147], a[168:171], a[20:23]
    ds_read_b128 a[136:139], v18 offset:32768
    v_cvt_pk_bf16_f32 v200, v128, v129
    v_mfma_f32_16x16x32_bf16 a[24:27], v[144:147], a[176:179], a[24:27]
    ds_read_b64_tr_b16 a[198:199], v43 offset:2048
    v_exp_f32 v131, v131
    v_mfma_f32_16x16x32_bf16 a[24:27], v[160:163], a[180:183], a[24:27]
    ds_read_b128 a[140:143], v19 offset:32768
    v_cvt_pk_bf16_f32 v201, v130, v131
    v_mfma_f32_16x16x32_bf16 a[56:59], v[164:167], a[180:183], a[56:59]
    v_exp_f32 v132, v132
    v_mfma_f32_16x16x32_bf16 a[56:59], v[148:151], a[176:179], a[56:59]
    buffer_load_dwordx4 v246, s[64:67], s33 offen offset:2048 lds
    v_mfma_f32_16x16x32_bf16 a[88:91], v[152:155], a[176:179], a[88:91]
    ds_read_b64_tr_b16 a[200:201], v44 offset:0
    v_exp_f32 v133, v133
    v_mfma_f32_16x16x32_bf16 a[88:91], v[168:171], a[180:183], a[88:91]
    ds_read_b128 a[144:147], v16 offset:36864
    v_cvt_pk_bf16_f32 v202, v132, v133
    v_mfma_f32_16x16x32_bf16 a[120:123], v[172:175], a[180:183], a[120:123]
    ds_read_b64_tr_b16 a[202:203], v44 offset:2048
    v_exp_f32 v134, v134
    v_mfma_f32_16x16x32_bf16 a[120:123], v[156:159], a[176:179], a[120:123]
    ds_read_b128 a[148:151], v17 offset:36864
    v_mfma_f32_16x16x32_bf16 a[124:127], v[156:159], a[184:187], a[124:127]
    v_exp_f32 v135, v135
    v_mfma_f32_16x16x32_bf16 a[124:127], v[172:175], a[188:191], a[124:127]
    buffer_load_dwordx4 v247, s[64:67], s33 offen offset:3072 lds
    v_mfma_f32_16x16x32_bf16 a[92:95], v[168:171], a[188:191], a[92:95]
    v_exp_f32 v136, v136
    v_mfma_f32_16x16x32_bf16 a[92:95], v[152:155], a[184:187], a[92:95]
    ds_read_b128 a[152:155], v18 offset:36864
    v_cvt_pk_bf16_f32 v203, v134, v135
    v_mfma_f32_16x16x32_bf16 a[60:63], v[148:151], a[184:187], a[60:63]
    v_exp_f32 v137, v137
    v_mfma_f32_16x16x32_bf16 a[60:63], v[164:167], a[188:191], a[60:63]
    ds_read_b128 a[156:159], v19 offset:36864
    v_cvt_pk_bf16_f32 v204, v136, v137
    v_mfma_f32_16x16x32_bf16 a[28:31], v[160:163], a[188:191], a[28:31]
    v_exp_f32 v138, v138
    v_mfma_f32_16x16x32_bf16 a[28:31], v[144:147], a[184:187], a[28:31]
    ds_read_b64_tr_b16 a[204:205], v45 offset:0
    v_mfma_f32_16x16x32_bf16 v[232:235], v[152:155], v[248:251], v[232:235]
    v_exp_f32 v139, v139
    v_mfma_f32_16x16x32_bf16 v[232:235], v[168:171], v[248:251], v[232:235]
    ds_read_b64_tr_b16 a[206:207], v45 offset:2048
    v_cvt_pk_bf16_f32 v205, v138, v139
    v_mfma_f32_16x16x32_bf16 v[236:239], v[172:175], v[248:251], v[236:239]
    v_exp_f32 v140, v140
    v_mfma_f32_16x16x32_bf16 v[236:239], v[156:159], v[248:251], v[236:239]
    s_waitcnt lgkmcnt(0)
    v_mfma_f32_16x16x32_bf16 v[112:115], a[128:131], v[48:51], v[208:211]
    v_exp_f32 v141, v141
    v_mfma_f32_16x16x32_bf16 v[112:115], a[132:135], v[52:55], v[112:115]
    ds_read_b64_tr_b16 a[160:161], v20 offset:16384
    v_cvt_pk_bf16_f32 v206, v140, v141
    v_mfma_f32_16x16x32_bf16 v[112:115], a[136:139], v[56:59], v[112:115]
    s_add_u32 s33, s45, 0
    v_exp_f32 v142, v142
    v_mfma_f32_16x16x32_bf16 v[112:115], a[140:143], v[60:63], v[112:115]
    ds_read_b64_tr_b16 a[162:163], v20 offset:20480
    v_mfma_f32_16x16x32_bf16 v[116:119], a[156:159], v[60:63], v[208:211]
    s_add_u32 m0, s47, 0
    v_exp_f32 v143, v143
    v_mfma_f32_16x16x32_bf16 v[116:119], a[152:155], v[56:59], v[116:119]
    ds_read_b64_tr_b16 a[164:165], v20 offset:24576
    v_cvt_pk_bf16_f32 v207, v142, v143
    v_mfma_f32_16x16x32_bf16 v[116:119], a[148:151], v[52:55], v[116:119]
    buffer_load_dwordx4 v244, s[64:67], s33 offen offset:0 lds
    v_mfma_f32_16x16x32_bf16 v[116:119], a[144:147], v[48:51], v[116:119]
    ds_read_b64_tr_b16 a[166:167], v20 offset:28672
    v_mfma_f32_16x16x32_bf16 v[124:127], a[144:147], v[64:67], v[212:215]
    v_mfma_f32_16x16x32_bf16 v[124:127], a[148:151], v[68:71], v[124:127]
    ds_read_b64_tr_b16 a[168:169], v21 offset:16384
    v_mfma_f32_16x16x32_bf16 v[124:127], a[152:155], v[72:75], v[124:127]
    v_exp_f32 v112, v112
    v_mfma_f32_16x16x32_bf16 v[124:127], a[156:159], v[76:79], v[124:127]
    ds_read_b64_tr_b16 a[170:171], v21 offset:20480
    v_mfma_f32_16x16x32_bf16 v[120:123], a[140:143], v[76:79], v[212:215]
    buffer_load_dwordx4 v245, s[64:67], s33 offen offset:1024 lds
    v_exp_f32 v113, v113
    v_mfma_f32_16x16x32_bf16 v[120:123], a[136:139], v[72:75], v[120:123]
    ds_read_b64_tr_b16 a[172:173], v21 offset:24576
    v_cvt_pk_bf16_f32 v144, v112, v113
    v_mfma_f32_16x16x32_bf16 v[120:123], a[132:135], v[68:71], v[120:123]
    v_exp_f32 v114, v114
    v_mfma_f32_16x16x32_bf16 v[120:123], a[128:131], v[64:67], v[120:123]
    ds_read_b64_tr_b16 a[174:175], v21 offset:28672
    v_mfma_f32_16x16x32_bf16 v[128:131], a[128:131], v[80:83], v[216:219]
    v_exp_f32 v115, v115
    v_mfma_f32_16x16x32_bf16 v[128:131], a[132:135], v[84:87], v[128:131]
    ds_read_b64_tr_b16 a[176:177], v22 offset:16384
    v_cvt_pk_bf16_f32 v145, v114, v115
    v_mfma_f32_16x16x32_bf16 v[128:131], a[136:139], v[88:91], v[128:131]
    buffer_load_dwordx4 v246, s[64:67], s33 offen offset:2048 lds
    v_exp_f32 v116, v116
    v_mfma_f32_16x16x32_bf16 v[128:131], a[140:143], v[92:95], v[128:131]
    ds_read_b64_tr_b16 a[178:179], v22 offset:20480
    v_mfma_f32_16x16x32_bf16 v[132:135], a[156:159], v[92:95], v[216:219]
    v_exp_f32 v117, v117
    v_mfma_f32_16x16x32_bf16 v[132:135], a[152:155], v[88:91], v[132:135]
    ds_read_b64_tr_b16 a[180:181], v22 offset:24576
    v_cvt_pk_bf16_f32 v146, v116, v117
    v_mfma_f32_16x16x32_bf16 v[132:135], a[148:151], v[84:87], v[132:135]
    v_exp_f32 v118, v118
    v_mfma_f32_16x16x32_bf16 v[132:135], a[144:147], v[80:83], v[132:135]
    ds_read_b64_tr_b16 a[182:183], v22 offset:28672
    v_mfma_f32_16x16x32_bf16 v[140:143], a[144:147], v[96:99], v[220:223]
    buffer_load_dwordx4 v247, s[64:67], s33 offen offset:3072 lds
    v_exp_f32 v119, v119
    v_mfma_f32_16x16x32_bf16 v[140:143], a[148:151], v[100:103], v[140:143]
    ds_read_b64_tr_b16 a[184:185], v23 offset:16384
    v_cvt_pk_bf16_f32 v147, v118, v119
    v_mfma_f32_16x16x32_bf16 v[140:143], a[152:155], v[104:107], v[140:143]
    v_exp_f32 v120, v120
    v_mfma_f32_16x16x32_bf16 v[140:143], a[156:159], v[108:111], v[140:143]
    ds_read_b64_tr_b16 a[186:187], v23 offset:20480
    v_mfma_f32_16x16x32_bf16 v[136:139], a[140:143], v[108:111], v[220:223]
    v_exp_f32 v121, v121
    v_mfma_f32_16x16x32_bf16 v[136:139], a[136:139], v[104:107], v[136:139]
    ds_read_b64_tr_b16 a[188:189], v23 offset:24576
    v_cvt_pk_bf16_f32 v148, v120, v121
    v_mfma_f32_16x16x32_bf16 v[136:139], a[132:135], v[100:103], v[136:139]
    s_waitcnt lgkmcnt(2)
    v_exp_f32 v122, v122
    v_mfma_f32_16x16x32_bf16 v[136:139], a[128:131], v[96:99], v[136:139]
    ds_read_b64_tr_b16 a[190:191], v23 offset:28672
    v_mfma_f32_16x16x32_bf16 a[0:3], v[176:179], a[160:163], a[0:3]
    s_add_u32 s52, s45, 512000
    v_exp_f32 v123, v123
    v_mfma_f32_16x16x32_bf16 a[0:3], v[192:195], a[164:167], a[0:3]
    buffer_load_dword v253, v15, s[64:67], s52 offen
    v_cvt_pk_bf16_f32 v149, v122, v123
    v_mfma_f32_16x16x32_bf16 a[32:35], v[196:199], a[164:167], a[32:35]
    s_add_u32 s33, s45, 5120
    v_exp_f32 v124, v124
    v_mfma_f32_16x16x32_bf16 a[32:35], v[180:183], a[160:163], a[32:35]
    v_mfma_f32_16x16x32_bf16 a[64:67], v[184:187], a[160:163], a[64:67]
    s_waitcnt vmcnt(20) lgkmcnt(0)
    v_exp_f32 v125, v125
    v_mfma_f32_16x16x32_bf16 a[64:67], v[200:203], a[164:167], a[64:67]
    v_cvt_pk_bf16_f32 v150, v124, v125
    v_mfma_f32_16x16x32_bf16 a[96:99], v[204:207], a[164:167], a[96:99]
    s_add_u32 m0, s96, 65536
    v_exp_f32 v126, v126
    v_mfma_f32_16x16x32_bf16 a[96:99], v[188:191], a[160:163], a[96:99]
    buffer_load_dwordx4 v244, s[64:67], s33 offen offset:0 lds
    v_mfma_f32_16x16x32_bf16 a[100:103], v[188:191], a[168:171], a[100:103]
    ds_read_b64_tr_b16 a[208:209], v42 offset:4096
    v_exp_f32 v127, v127
    v_mfma_f32_16x16x32_bf16 a[100:103], v[204:207], a[172:175], a[100:103]
    ds_read_b128 a[128:131], v16 offset:40960
    v_cvt_pk_bf16_f32 v151, v126, v127
    v_mfma_f32_16x16x32_bf16 a[68:71], v[200:203], a[172:175], a[68:71]
    ds_read_b64_tr_b16 a[210:211], v42 offset:6144
    v_exp_f32 v128, v128
    v_mfma_f32_16x16x32_bf16 a[68:71], v[184:187], a[168:171], a[68:71]
    ds_read_b128 a[132:135], v17 offset:40960
    v_mfma_f32_16x16x32_bf16 a[36:39], v[180:183], a[168:171], a[36:39]
    ds_read_b64_tr_b16 a[212:213], v43 offset:4096
    v_exp_f32 v129, v129
    v_mfma_f32_16x16x32_bf16 a[36:39], v[196:199], a[172:175], a[36:39]
    buffer_load_dwordx4 v245, s[64:67], s33 offen offset:1024 lds
    v_mfma_f32_16x16x32_bf16 a[4:7], v[192:195], a[172:175], a[4:7]
    v_exp_f32 v130, v130
    v_mfma_f32_16x16x32_bf16 a[4:7], v[176:179], a[168:171], a[4:7]
    ds_read_b128 a[136:139], v18 offset:40960
    v_cvt_pk_bf16_f32 v152, v128, v129
    v_mfma_f32_16x16x32_bf16 a[8:11], v[176:179], a[176:179], a[8:11]
    ds_read_b64_tr_b16 a[214:215], v43 offset:6144
    v_exp_f32 v131, v131
    v_mfma_f32_16x16x32_bf16 a[8:11], v[192:195], a[180:183], a[8:11]
    ds_read_b128 a[140:143], v19 offset:40960
    v_cvt_pk_bf16_f32 v153, v130, v131
    v_mfma_f32_16x16x32_bf16 a[40:43], v[196:199], a[180:183], a[40:43]
    v_exp_f32 v132, v132
    v_mfma_f32_16x16x32_bf16 a[40:43], v[180:183], a[176:179], a[40:43]
    buffer_load_dwordx4 v246, s[64:67], s33 offen offset:2048 lds
    v_mfma_f32_16x16x32_bf16 a[72:75], v[184:187], a[176:179], a[72:75]
    ds_read_b64_tr_b16 a[216:217], v44 offset:4096
    v_exp_f32 v133, v133
    v_mfma_f32_16x16x32_bf16 a[72:75], v[200:203], a[180:183], a[72:75]
    ds_read_b128 a[144:147], v16 offset:45056
    v_cvt_pk_bf16_f32 v154, v132, v133
    v_mfma_f32_16x16x32_bf16 a[104:107], v[204:207], a[180:183], a[104:107]
    ds_read_b64_tr_b16 a[218:219], v44 offset:6144
    v_exp_f32 v134, v134
    v_mfma_f32_16x16x32_bf16 a[104:107], v[188:191], a[176:179], a[104:107]
    ds_read_b128 a[148:151], v17 offset:45056
    v_mfma_f32_16x16x32_bf16 a[108:111], v[188:191], a[184:187], a[108:111]
    v_exp_f32 v135, v135
    v_mfma_f32_16x16x32_bf16 a[108:111], v[204:207], a[188:191], a[108:111]
    buffer_load_dwordx4 v247, s[64:67], s33 offen offset:3072 lds
    v_mfma_f32_16x16x32_bf16 a[76:79], v[200:203], a[188:191], a[76:79]
    v_exp_f32 v136, v136
    v_mfma_f32_16x16x32_bf16 a[76:79], v[184:187], a[184:187], a[76:79]
    ds_read_b128 a[152:155], v18 offset:45056
    v_cvt_pk_bf16_f32 v155, v134, v135
    v_mfma_f32_16x16x32_bf16 a[44:47], v[180:183], a[184:187], a[44:47]
    v_exp_f32 v137, v137
    v_mfma_f32_16x16x32_bf16 a[44:47], v[196:199], a[188:191], a[44:47]
    ds_read_b128 a[156:159], v19 offset:45056
    v_cvt_pk_bf16_f32 v156, v136, v137
    v_mfma_f32_16x16x32_bf16 a[12:15], v[192:195], a[188:191], a[12:15]
    v_exp_f32 v138, v138
    v_mfma_f32_16x16x32_bf16 a[12:15], v[176:179], a[184:187], a[12:15]
    ds_read_b64_tr_b16 a[220:221], v45 offset:4096
    v_mfma_f32_16x16x32_bf16 v[224:227], v[176:179], v[248:251], v[224:227]
    v_exp_f32 v139, v139
    v_mfma_f32_16x16x32_bf16 v[224:227], v[192:195], v[248:251], v[224:227]
    ds_read_b64_tr_b16 a[222:223], v45 offset:6144
    v_cvt_pk_bf16_f32 v157, v138, v139
    v_mfma_f32_16x16x32_bf16 v[228:231], v[196:199], v[248:251], v[228:231]
    v_exp_f32 v140, v140
    v_mfma_f32_16x16x32_bf16 v[228:231], v[180:183], v[248:251], v[228:231]
    s_waitcnt lgkmcnt(0)
    v_mfma_f32_16x16x32_bf16 v[112:115], a[128:131], v[48:51], v[208:211]
    v_exp_f32 v141, v141
    v_mfma_f32_16x16x32_bf16 v[112:115], a[132:135], v[52:55], v[112:115]
    ds_read_b64_tr_b16 a[160:161], v24 offset:16384
    v_cvt_pk_bf16_f32 v158, v140, v141
    v_mfma_f32_16x16x32_bf16 v[112:115], a[136:139], v[56:59], v[112:115]
    s_add_u32 s33, s45, 10240
    v_exp_f32 v142, v142
    v_mfma_f32_16x16x32_bf16 v[112:115], a[140:143], v[60:63], v[112:115]
    ds_read_b64_tr_b16 a[162:163], v24 offset:20480
    v_mfma_f32_16x16x32_bf16 v[116:119], a[156:159], v[60:63], v[208:211]
    s_add_u32 m0, s47, 4096
    v_exp_f32 v143, v143
    v_mfma_f32_16x16x32_bf16 v[116:119], a[152:155], v[56:59], v[116:119]
    ds_read_b64_tr_b16 a[164:165], v24 offset:24576
    v_cvt_pk_bf16_f32 v159, v142, v143
    v_mfma_f32_16x16x32_bf16 v[116:119], a[148:151], v[52:55], v[116:119]
    buffer_load_dwordx4 v244, s[64:67], s33 offen offset:0 lds
    v_mfma_f32_16x16x32_bf16 v[116:119], a[144:147], v[48:51], v[116:119]
    ds_read_b64_tr_b16 a[166:167], v24 offset:28672
    v_mfma_f32_16x16x32_bf16 v[124:127], a[144:147], v[64:67], v[212:215]
    v_mfma_f32_16x16x32_bf16 v[124:127], a[148:151], v[68:71], v[124:127]
    ds_read_b64_tr_b16 a[168:169], v25 offset:16384
    v_mfma_f32_16x16x32_bf16 v[124:127], a[152:155], v[72:75], v[124:127]
    v_exp_f32 v112, v112
    v_mfma_f32_16x16x32_bf16 v[124:127], a[156:159], v[76:79], v[124:127]
    ds_read_b64_tr_b16 a[170:171], v25 offset:20480
    v_mfma_f32_16x16x32_bf16 v[120:123], a[140:143], v[76:79], v[212:215]
    buffer_load_dwordx4 v245, s[64:67], s33 offen offset:1024 lds
    v_exp_f32 v113, v113
    v_mfma_f32_16x16x32_bf16 v[120:123], a[136:139], v[72:75], v[120:123]
    ds_read_b64_tr_b16 a[172:173], v25 offset:24576
    v_cvt_pk_bf16_f32 v160, v112, v113
    v_mfma_f32_16x16x32_bf16 v[120:123], a[132:135], v[68:71], v[120:123]
    v_exp_f32 v114, v114
    v_mfma_f32_16x16x32_bf16 v[120:123], a[128:131], v[64:67], v[120:123]
    ds_read_b64_tr_b16 a[174:175], v25 offset:28672
    v_mfma_f32_16x16x32_bf16 v[128:131], a[128:131], v[80:83], v[216:219]
    v_exp_f32 v115, v115
    v_mfma_f32_16x16x32_bf16 v[128:131], a[132:135], v[84:87], v[128:131]
    ds_read_b64_tr_b16 a[176:177], v26 offset:16384
    v_cvt_pk_bf16_f32 v161, v114, v115
    v_mfma_f32_16x16x32_bf16 v[128:131], a[136:139], v[88:91], v[128:131]
    buffer_load_dwordx4 v246, s[64:67], s33 offen offset:2048 lds
    v_exp_f32 v116, v116
    v_mfma_f32_16x16x32_bf16 v[128:131], a[140:143], v[92:95], v[128:131]
    ds_read_b64_tr_b16 a[178:179], v26 offset:20480
    v_mfma_f32_16x16x32_bf16 v[132:135], a[156:159], v[92:95], v[216:219]
    v_exp_f32 v117, v117
    v_mfma_f32_16x16x32_bf16 v[132:135], a[152:155], v[88:91], v[132:135]
    ds_read_b64_tr_b16 a[180:181], v26 offset:24576
    v_cvt_pk_bf16_f32 v162, v116, v117
    v_mfma_f32_16x16x32_bf16 v[132:135], a[148:151], v[84:87], v[132:135]
    v_exp_f32 v118, v118
    v_mfma_f32_16x16x32_bf16 v[132:135], a[144:147], v[80:83], v[132:135]
    ds_read_b64_tr_b16 a[182:183], v26 offset:28672
    v_mfma_f32_16x16x32_bf16 v[140:143], a[144:147], v[96:99], v[220:223]
    buffer_load_dwordx4 v247, s[64:67], s33 offen offset:3072 lds
    v_exp_f32 v119, v119
    v_mfma_f32_16x16x32_bf16 v[140:143], a[148:151], v[100:103], v[140:143]
    ds_read_b64_tr_b16 a[184:185], v27 offset:16384
    v_cvt_pk_bf16_f32 v163, v118, v119
    v_mfma_f32_16x16x32_bf16 v[140:143], a[152:155], v[104:107], v[140:143]
    v_exp_f32 v120, v120
    v_mfma_f32_16x16x32_bf16 v[140:143], a[156:159], v[108:111], v[140:143]
    ds_read_b64_tr_b16 a[186:187], v27 offset:20480
    v_mfma_f32_16x16x32_bf16 v[136:139], a[140:143], v[108:111], v[220:223]
    v_exp_f32 v121, v121
    v_mfma_f32_16x16x32_bf16 v[136:139], a[136:139], v[104:107], v[136:139]
    ds_read_b64_tr_b16 a[188:189], v27 offset:24576
    v_cvt_pk_bf16_f32 v164, v120, v121
    v_mfma_f32_16x16x32_bf16 v[136:139], a[132:135], v[100:103], v[136:139]
    s_waitcnt lgkmcnt(2)
    v_exp_f32 v122, v122
    v_mfma_f32_16x16x32_bf16 v[136:139], a[128:131], v[96:99], v[136:139]
    ds_read_b64_tr_b16 a[190:191], v27 offset:28672
    v_mfma_f32_16x16x32_bf16 a[16:19], v[176:179], a[160:163], a[16:19]
    s_add_u32 s52, s45, 558080
    v_exp_f32 v123, v123
    v_mfma_f32_16x16x32_bf16 a[16:19], v[192:195], a[164:167], a[16:19]
    buffer_load_dword v3, v15, s[64:67], s52 offen
    v_cvt_pk_bf16_f32 v165, v122, v123
    v_mfma_f32_16x16x32_bf16 a[48:51], v[196:199], a[164:167], a[48:51]
    s_add_u32 s33, s45, 15360
    v_exp_f32 v124, v124
    v_mfma_f32_16x16x32_bf16 a[48:51], v[180:183], a[160:163], a[48:51]
    v_mfma_f32_16x16x32_bf16 a[80:83], v[184:187], a[160:163], a[80:83]
    s_waitcnt vmcnt(24) lgkmcnt(0)
    v_exp_f32 v125, v125
    v_mfma_f32_16x16x32_bf16 a[80:83], v[200:203], a[164:167], a[80:83]
    s_barrier
    v_cvt_pk_bf16_f32 v166, v124, v125
    v_mfma_f32_16x16x32_bf16 a[112:115], v[204:207], a[164:167], a[112:115]
    s_add_u32 m0, s96, 32768
    v_exp_f32 v126, v126
    v_mfma_f32_16x16x32_bf16 a[112:115], v[188:191], a[160:163], a[112:115]
    buffer_load_dwordx4 v244, s[64:67], s33 offen offset:0 lds
    v_mfma_f32_16x16x32_bf16 a[116:119], v[188:191], a[168:171], a[116:119]
    ds_read_b64_tr_b16 a[224:225], v34 offset:0
    v_exp_f32 v127, v127
    v_mfma_f32_16x16x32_bf16 a[116:119], v[204:207], a[172:175], a[116:119]
    ds_read_b128 a[128:131], v16 offset:49152
    v_cvt_pk_bf16_f32 v167, v126, v127
    v_mfma_f32_16x16x32_bf16 a[84:87], v[200:203], a[172:175], a[84:87]
    ds_read_b64_tr_b16 a[226:227], v34 offset:2048
    v_exp_f32 v128, v128
    v_mfma_f32_16x16x32_bf16 a[84:87], v[184:187], a[168:171], a[84:87]
    ds_read_b128 a[132:135], v17 offset:49152
    v_mfma_f32_16x16x32_bf16 a[52:55], v[180:183], a[168:171], a[52:55]
    ds_read_b64_tr_b16 a[228:229], v35 offset:0
    v_exp_f32 v129, v129
    v_mfma_f32_16x16x32_bf16 a[52:55], v[196:199], a[172:175], a[52:55]
    buffer_load_dwordx4 v245, s[64:67], s33 offen offset:1024 lds
    v_mfma_f32_16x16x32_bf16 a[20:23], v[192:195], a[172:175], a[20:23]
    v_exp_f32 v130, v130
    v_mfma_f32_16x16x32_bf16 a[20:23], v[176:179], a[168:171], a[20:23]
    ds_read_b128 a[136:139], v18 offset:49152
    v_cvt_pk_bf16_f32 v168, v128, v129
    v_mfma_f32_16x16x32_bf16 a[24:27], v[176:179], a[176:179], a[24:27]
    ds_read_b64_tr_b16 a[230:231], v35 offset:2048
    v_exp_f32 v131, v131
    v_mfma_f32_16x16x32_bf16 a[24:27], v[192:195], a[180:183], a[24:27]
    ds_read_b128 a[140:143], v19 offset:49152
    v_cvt_pk_bf16_f32 v169, v130, v131
    v_mfma_f32_16x16x32_bf16 a[56:59], v[196:199], a[180:183], a[56:59]
    v_exp_f32 v132, v132
    v_mfma_f32_16x16x32_bf16 a[56:59], v[180:183], a[176:179], a[56:59]
    buffer_load_dwordx4 v246, s[64:67], s33 offen offset:2048 lds
    v_mfma_f32_16x16x32_bf16 a[88:91], v[184:187], a[176:179], a[88:91]
    ds_read_b64_tr_b16 a[232:233], v36 offset:0
    v_exp_f32 v133, v133
    v_mfma_f32_16x16x32_bf16 a[88:91], v[200:203], a[180:183], a[88:91]
    ds_read_b128 a[144:147], v16 offset:53248
    v_cvt_pk_bf16_f32 v170, v132, v133
    v_mfma_f32_16x16x32_bf16 a[120:123], v[204:207], a[180:183], a[120:123]
    ds_read_b64_tr_b16 a[234:235], v36 offset:2048
    v_exp_f32 v134, v134
    v_mfma_f32_16x16x32_bf16 a[120:123], v[188:191], a[176:179], a[120:123]
    ds_read_b128 a[148:151], v17 offset:53248
    v_mfma_f32_16x16x32_bf16 a[124:127], v[188:191], a[184:187], a[124:127]
    v_exp_f32 v135, v135
    v_mfma_f32_16x16x32_bf16 a[124:127], v[204:207], a[188:191], a[124:127]
    buffer_load_dwordx4 v247, s[64:67], s33 offen offset:3072 lds
    v_mfma_f32_16x16x32_bf16 a[92:95], v[200:203], a[188:191], a[92:95]
    v_exp_f32 v136, v136
    v_mfma_f32_16x16x32_bf16 a[92:95], v[184:187], a[184:187], a[92:95]
    ds_read_b128 a[152:155], v18 offset:53248
    v_cvt_pk_bf16_f32 v171, v134, v135
    v_mfma_f32_16x16x32_bf16 a[60:63], v[180:183], a[184:187], a[60:63]
    v_exp_f32 v137, v137
    v_mfma_f32_16x16x32_bf16 a[60:63], v[196:199], a[188:191], a[60:63]
    ds_read_b128 a[156:159], v19 offset:53248
    v_cvt_pk_bf16_f32 v172, v136, v137
    v_mfma_f32_16x16x32_bf16 a[28:31], v[192:195], a[188:191], a[28:31]
    v_exp_f32 v138, v138
    v_mfma_f32_16x16x32_bf16 a[28:31], v[176:179], a[184:187], a[28:31]
    ds_read_b64_tr_b16 a[236:237], v37 offset:0
    v_mfma_f32_16x16x32_bf16 v[232:235], v[184:187], v[248:251], v[232:235]
    v_exp_f32 v139, v139
    v_mfma_f32_16x16x32_bf16 v[232:235], v[200:203], v[248:251], v[232:235]
    ds_read_b64_tr_b16 a[238:239], v37 offset:2048
    v_cvt_pk_bf16_f32 v173, v138, v139
    v_mfma_f32_16x16x32_bf16 v[236:239], v[204:207], v[248:251], v[236:239]
    v_exp_f32 v140, v140
    v_mfma_f32_16x16x32_bf16 v[236:239], v[188:191], v[248:251], v[236:239]
    s_waitcnt lgkmcnt(0)
    v_mfma_f32_16x16x32_bf16 v[112:115], a[128:131], v[48:51], v[208:211]
    v_exp_f32 v141, v141
    v_mfma_f32_16x16x32_bf16 v[112:115], a[132:135], v[52:55], v[112:115]
    ds_read_b64_tr_b16 a[160:161], v20 offset:32768
    v_cvt_pk_bf16_f32 v174, v140, v141
    v_mfma_f32_16x16x32_bf16 v[112:115], a[136:139], v[56:59], v[112:115]
    s_add_u32 s33, s45, 163840
    v_exp_f32 v142, v142
    v_mfma_f32_16x16x32_bf16 v[112:115], a[140:143], v[60:63], v[112:115]
    ds_read_b64_tr_b16 a[162:163], v20 offset:36864
    v_mfma_f32_16x16x32_bf16 v[116:119], a[156:159], v[60:63], v[208:211]
    s_add_u32 m0, s96, 0
    v_exp_f32 v143, v143
    v_mfma_f32_16x16x32_bf16 v[116:119], a[152:155], v[56:59], v[116:119]
    ds_read_b64_tr_b16 a[164:165], v20 offset:40960
    v_cvt_pk_bf16_f32 v175, v142, v143
    v_mfma_f32_16x16x32_bf16 v[116:119], a[148:151], v[52:55], v[116:119]
    buffer_load_dwordx4 v244, s[64:67], s33 offen offset:0 lds
    v_mfma_f32_16x16x32_bf16 v[116:119], a[144:147], v[48:51], v[116:119]
    ds_read_b64_tr_b16 a[166:167], v20 offset:45056
    v_mfma_f32_16x16x32_bf16 v[124:127], a[144:147], v[64:67], v[212:215]
    v_mfma_f32_16x16x32_bf16 v[124:127], a[148:151], v[68:71], v[124:127]
    ds_read_b64_tr_b16 a[168:169], v21 offset:32768
    v_mfma_f32_16x16x32_bf16 v[124:127], a[152:155], v[72:75], v[124:127]
    v_exp_f32 v112, v112
    v_mfma_f32_16x16x32_bf16 v[124:127], a[156:159], v[76:79], v[124:127]
    ds_read_b64_tr_b16 a[170:171], v21 offset:36864
    v_mfma_f32_16x16x32_bf16 v[120:123], a[140:143], v[76:79], v[212:215]
    buffer_load_dwordx4 v245, s[64:67], s33 offen offset:1024 lds
    v_exp_f32 v113, v113
    v_mfma_f32_16x16x32_bf16 v[120:123], a[136:139], v[72:75], v[120:123]
    ds_read_b64_tr_b16 a[172:173], v21 offset:40960
    v_cvt_pk_bf16_f32 v176, v112, v113
    v_mfma_f32_16x16x32_bf16 v[120:123], a[132:135], v[68:71], v[120:123]
    v_exp_f32 v114, v114
    v_mfma_f32_16x16x32_bf16 v[120:123], a[128:131], v[64:67], v[120:123]
    ds_read_b64_tr_b16 a[174:175], v21 offset:45056
    v_mfma_f32_16x16x32_bf16 v[128:131], a[128:131], v[80:83], v[216:219]
    v_exp_f32 v115, v115
    v_mfma_f32_16x16x32_bf16 v[128:131], a[132:135], v[84:87], v[128:131]
    ds_read_b64_tr_b16 a[176:177], v22 offset:32768
    v_cvt_pk_bf16_f32 v177, v114, v115
    v_mfma_f32_16x16x32_bf16 v[128:131], a[136:139], v[88:91], v[128:131]
    buffer_load_dwordx4 v246, s[64:67], s33 offen offset:2048 lds
    v_exp_f32 v116, v116
    v_mfma_f32_16x16x32_bf16 v[128:131], a[140:143], v[92:95], v[128:131]
    ds_read_b64_tr_b16 a[178:179], v22 offset:36864
    v_mfma_f32_16x16x32_bf16 v[132:135], a[156:159], v[92:95], v[216:219]
    v_exp_f32 v117, v117
    v_mfma_f32_16x16x32_bf16 v[132:135], a[152:155], v[88:91], v[132:135]
    ds_read_b64_tr_b16 a[180:181], v22 offset:40960
    v_cvt_pk_bf16_f32 v178, v116, v117
    v_mfma_f32_16x16x32_bf16 v[132:135], a[148:151], v[84:87], v[132:135]
    v_exp_f32 v118, v118
    v_mfma_f32_16x16x32_bf16 v[132:135], a[144:147], v[80:83], v[132:135]
    ds_read_b64_tr_b16 a[182:183], v22 offset:45056
    v_mfma_f32_16x16x32_bf16 v[140:143], a[144:147], v[96:99], v[220:223]
    buffer_load_dwordx4 v247, s[64:67], s33 offen offset:3072 lds
    v_exp_f32 v119, v119
    v_mfma_f32_16x16x32_bf16 v[140:143], a[148:151], v[100:103], v[140:143]
    ds_read_b64_tr_b16 a[184:185], v23 offset:32768
    v_cvt_pk_bf16_f32 v179, v118, v119
    v_mfma_f32_16x16x32_bf16 v[140:143], a[152:155], v[104:107], v[140:143]
    v_exp_f32 v120, v120
    v_mfma_f32_16x16x32_bf16 v[140:143], a[156:159], v[108:111], v[140:143]
    ds_read_b64_tr_b16 a[186:187], v23 offset:36864
    v_mfma_f32_16x16x32_bf16 v[136:139], a[140:143], v[108:111], v[220:223]
    v_exp_f32 v121, v121
    v_mfma_f32_16x16x32_bf16 v[136:139], a[136:139], v[104:107], v[136:139]
    ds_read_b64_tr_b16 a[188:189], v23 offset:40960
    v_cvt_pk_bf16_f32 v180, v120, v121
    v_mfma_f32_16x16x32_bf16 v[136:139], a[132:135], v[100:103], v[136:139]
    s_waitcnt lgkmcnt(2)
    v_exp_f32 v122, v122
    v_mfma_f32_16x16x32_bf16 v[136:139], a[128:131], v[96:99], v[136:139]
    ds_read_b64_tr_b16 a[190:191], v23 offset:45056
    v_mfma_f32_16x16x32_bf16 a[0:3], v[144:147], a[160:163], a[0:3]
    s_add_u32 s52, s45, 604160
    v_exp_f32 v123, v123
    v_mfma_f32_16x16x32_bf16 a[0:3], v[160:163], a[164:167], a[0:3]
    buffer_load_dword v5, v15, s[64:67], s52 offen
    v_cvt_pk_bf16_f32 v181, v122, v123
    v_mfma_f32_16x16x32_bf16 a[32:35], v[164:167], a[164:167], a[32:35]
    s_add_u32 s33, s45, 168960
    v_exp_f32 v124, v124
    v_mfma_f32_16x16x32_bf16 a[32:35], v[148:151], a[160:163], a[32:35]
    v_mfma_f32_16x16x32_bf16 a[64:67], v[152:155], a[160:163], a[64:67]
    s_waitcnt vmcnt(23) lgkmcnt(0)
    v_exp_f32 v125, v125
    v_mfma_f32_16x16x32_bf16 a[64:67], v[168:171], a[164:167], a[64:67]
    v_cvt_pk_bf16_f32 v182, v124, v125
    v_mfma_f32_16x16x32_bf16 a[96:99], v[172:175], a[164:167], a[96:99]
    s_add_u32 m0, s96, 81920
    v_exp_f32 v126, v126
    v_mfma_f32_16x16x32_bf16 a[96:99], v[156:159], a[160:163], a[96:99]
    buffer_load_dwordx4 v244, s[64:67], s33 offen offset:0 lds
    v_mfma_f32_16x16x32_bf16 a[100:103], v[156:159], a[168:171], a[100:103]
    ds_read_b64_tr_b16 a[240:241], v34 offset:16384
    v_exp_f32 v127, v127
    v_mfma_f32_16x16x32_bf16 a[100:103], v[172:175], a[172:175], a[100:103]
    ds_read_b128 a[128:131], v16 offset:57344
    v_cvt_pk_bf16_f32 v183, v126, v127
    v_mfma_f32_16x16x32_bf16 a[68:71], v[168:171], a[172:175], a[68:71]
    ds_read_b64_tr_b16 a[242:243], v34 offset:18432
    v_exp_f32 v128, v128
    v_mfma_f32_16x16x32_bf16 a[68:71], v[152:155], a[168:171], a[68:71]
    ds_read_b128 a[132:135], v17 offset:57344
    v_mfma_f32_16x16x32_bf16 a[36:39], v[148:151], a[168:171], a[36:39]
    ds_read_b64_tr_b16 a[244:245], v35 offset:16384
    v_exp_f32 v129, v129
    v_mfma_f32_16x16x32_bf16 a[36:39], v[164:167], a[172:175], a[36:39]
    buffer_load_dwordx4 v245, s[64:67], s33 offen offset:1024 lds
    v_mfma_f32_16x16x32_bf16 a[4:7], v[160:163], a[172:175], a[4:7]
    v_exp_f32 v130, v130
    v_mfma_f32_16x16x32_bf16 a[4:7], v[144:147], a[168:171], a[4:7]
    ds_read_b128 a[136:139], v18 offset:57344
    v_cvt_pk_bf16_f32 v184, v128, v129
    v_mfma_f32_16x16x32_bf16 a[8:11], v[144:147], a[176:179], a[8:11]
    ds_read_b64_tr_b16 a[246:247], v35 offset:18432
    v_exp_f32 v131, v131
    v_mfma_f32_16x16x32_bf16 a[8:11], v[160:163], a[180:183], a[8:11]
    ds_read_b128 a[140:143], v19 offset:57344
    v_cvt_pk_bf16_f32 v185, v130, v131
    v_mfma_f32_16x16x32_bf16 a[40:43], v[164:167], a[180:183], a[40:43]
    v_exp_f32 v132, v132
    v_mfma_f32_16x16x32_bf16 a[40:43], v[148:151], a[176:179], a[40:43]
    buffer_load_dwordx4 v246, s[64:67], s33 offen offset:2048 lds
    v_mfma_f32_16x16x32_bf16 a[72:75], v[152:155], a[176:179], a[72:75]
    ds_read_b64_tr_b16 a[248:249], v36 offset:16384
    v_exp_f32 v133, v133
    v_mfma_f32_16x16x32_bf16 a[72:75], v[168:171], a[180:183], a[72:75]
    ds_read_b128 a[144:147], v16 offset:61440
    v_cvt_pk_bf16_f32 v186, v132, v133
    v_mfma_f32_16x16x32_bf16 a[104:107], v[172:175], a[180:183], a[104:107]
    ds_read_b64_tr_b16 a[250:251], v36 offset:18432
    v_exp_f32 v134, v134
    v_mfma_f32_16x16x32_bf16 a[104:107], v[156:159], a[176:179], a[104:107]
    ds_read_b128 a[148:151], v17 offset:61440
    v_mfma_f32_16x16x32_bf16 a[108:111], v[156:159], a[184:187], a[108:111]
    v_exp_f32 v135, v135
    v_mfma_f32_16x16x32_bf16 a[108:111], v[172:175], a[188:191], a[108:111]
    buffer_load_dwordx4 v247, s[64:67], s33 offen offset:3072 lds
    v_mfma_f32_16x16x32_bf16 a[76:79], v[168:171], a[188:191], a[76:79]
    v_exp_f32 v136, v136
    v_mfma_f32_16x16x32_bf16 a[76:79], v[152:155], a[184:187], a[76:79]
    ds_read_b128 a[152:155], v18 offset:61440
    v_cvt_pk_bf16_f32 v187, v134, v135
    v_mfma_f32_16x16x32_bf16 a[44:47], v[148:151], a[184:187], a[44:47]
    v_exp_f32 v137, v137
    v_mfma_f32_16x16x32_bf16 a[44:47], v[164:167], a[188:191], a[44:47]
    ds_read_b128 a[156:159], v19 offset:61440
    v_cvt_pk_bf16_f32 v188, v136, v137
    v_mfma_f32_16x16x32_bf16 a[12:15], v[160:163], a[188:191], a[12:15]
    v_exp_f32 v138, v138
    v_mfma_f32_16x16x32_bf16 a[12:15], v[144:147], a[184:187], a[12:15]
    ds_read_b64_tr_b16 a[252:253], v37 offset:16384
    v_mfma_f32_16x16x32_bf16 v[224:227], v[144:147], v[248:251], v[224:227]
    v_exp_f32 v139, v139
    v_mfma_f32_16x16x32_bf16 v[224:227], v[160:163], v[248:251], v[224:227]
    ds_read_b64_tr_b16 a[254:255], v37 offset:18432
    v_cvt_pk_bf16_f32 v189, v138, v139
    v_mfma_f32_16x16x32_bf16 v[228:231], v[164:167], v[248:251], v[228:231]
    v_exp_f32 v140, v140
    v_mfma_f32_16x16x32_bf16 v[228:231], v[148:151], v[248:251], v[228:231]
    s_waitcnt lgkmcnt(0)
    v_mfma_f32_16x16x32_bf16 v[112:115], a[128:131], v[48:51], v[208:211]
    v_exp_f32 v141, v141
    v_mfma_f32_16x16x32_bf16 v[112:115], a[132:135], v[52:55], v[112:115]
    ds_read_b64_tr_b16 a[160:161], v24 offset:32768
    v_cvt_pk_bf16_f32 v190, v140, v141
    v_mfma_f32_16x16x32_bf16 v[112:115], a[136:139], v[56:59], v[112:115]
    s_add_u32 s33, s45, 174080
    v_exp_f32 v142, v142
    v_mfma_f32_16x16x32_bf16 v[112:115], a[140:143], v[60:63], v[112:115]
    ds_read_b64_tr_b16 a[162:163], v24 offset:36864
    v_mfma_f32_16x16x32_bf16 v[116:119], a[156:159], v[60:63], v[208:211]
    s_add_u32 m0, s96, 16384
    v_exp_f32 v143, v143
    v_mfma_f32_16x16x32_bf16 v[116:119], a[152:155], v[56:59], v[116:119]
    ds_read_b64_tr_b16 a[164:165], v24 offset:40960
    v_cvt_pk_bf16_f32 v191, v142, v143
    v_mfma_f32_16x16x32_bf16 v[116:119], a[148:151], v[52:55], v[116:119]
    buffer_load_dwordx4 v244, s[64:67], s33 offen offset:0 lds
    v_mfma_f32_16x16x32_bf16 v[116:119], a[144:147], v[48:51], v[116:119]
    ds_read_b64_tr_b16 a[166:167], v24 offset:45056
    v_mfma_f32_16x16x32_bf16 v[124:127], a[144:147], v[64:67], v[212:215]
    v_mfma_f32_16x16x32_bf16 v[124:127], a[148:151], v[68:71], v[124:127]
    ds_read_b64_tr_b16 a[168:169], v25 offset:32768
    v_mfma_f32_16x16x32_bf16 v[124:127], a[152:155], v[72:75], v[124:127]
    v_exp_f32 v112, v112
    v_mfma_f32_16x16x32_bf16 v[124:127], a[156:159], v[76:79], v[124:127]
    ds_read_b64_tr_b16 a[170:171], v25 offset:36864
    v_mfma_f32_16x16x32_bf16 v[120:123], a[140:143], v[76:79], v[212:215]
    buffer_load_dwordx4 v245, s[64:67], s33 offen offset:1024 lds
    v_exp_f32 v113, v113
    v_mfma_f32_16x16x32_bf16 v[120:123], a[136:139], v[72:75], v[120:123]
    ds_read_b64_tr_b16 a[172:173], v25 offset:40960
    v_cvt_pk_bf16_f32 v192, v112, v113
    v_mfma_f32_16x16x32_bf16 v[120:123], a[132:135], v[68:71], v[120:123]
    v_exp_f32 v114, v114
    v_mfma_f32_16x16x32_bf16 v[120:123], a[128:131], v[64:67], v[120:123]
    ds_read_b64_tr_b16 a[174:175], v25 offset:45056
    v_mfma_f32_16x16x32_bf16 v[128:131], a[128:131], v[80:83], v[216:219]
    v_exp_f32 v115, v115
    v_mfma_f32_16x16x32_bf16 v[128:131], a[132:135], v[84:87], v[128:131]
    ds_read_b64_tr_b16 a[176:177], v26 offset:32768
    v_cvt_pk_bf16_f32 v193, v114, v115
    v_mfma_f32_16x16x32_bf16 v[128:131], a[136:139], v[88:91], v[128:131]
    buffer_load_dwordx4 v246, s[64:67], s33 offen offset:2048 lds
    v_exp_f32 v116, v116
    v_mfma_f32_16x16x32_bf16 v[128:131], a[140:143], v[92:95], v[128:131]
    ds_read_b64_tr_b16 a[178:179], v26 offset:36864
    v_mfma_f32_16x16x32_bf16 v[132:135], a[156:159], v[92:95], v[216:219]
    v_exp_f32 v117, v117
    v_mfma_f32_16x16x32_bf16 v[132:135], a[152:155], v[88:91], v[132:135]
    ds_read_b64_tr_b16 a[180:181], v26 offset:40960
    v_cvt_pk_bf16_f32 v194, v116, v117
    v_mfma_f32_16x16x32_bf16 v[132:135], a[148:151], v[84:87], v[132:135]
    v_exp_f32 v118, v118
    v_mfma_f32_16x16x32_bf16 v[132:135], a[144:147], v[80:83], v[132:135]
    ds_read_b64_tr_b16 a[182:183], v26 offset:45056
    v_mfma_f32_16x16x32_bf16 v[140:143], a[144:147], v[96:99], v[220:223]
    buffer_load_dwordx4 v247, s[64:67], s33 offen offset:3072 lds
    v_exp_f32 v119, v119
    v_mfma_f32_16x16x32_bf16 v[140:143], a[148:151], v[100:103], v[140:143]
    ds_read_b64_tr_b16 a[184:185], v27 offset:32768
    v_cvt_pk_bf16_f32 v195, v118, v119
    v_mfma_f32_16x16x32_bf16 v[140:143], a[152:155], v[104:107], v[140:143]
    v_exp_f32 v120, v120
    v_mfma_f32_16x16x32_bf16 v[140:143], a[156:159], v[108:111], v[140:143]
    ds_read_b64_tr_b16 a[186:187], v27 offset:36864
    v_mfma_f32_16x16x32_bf16 v[136:139], a[140:143], v[108:111], v[220:223]
    v_exp_f32 v121, v121
    v_mfma_f32_16x16x32_bf16 v[136:139], a[136:139], v[104:107], v[136:139]
    ds_read_b64_tr_b16 a[188:189], v27 offset:40960
    v_cvt_pk_bf16_f32 v196, v120, v121
    v_mfma_f32_16x16x32_bf16 v[136:139], a[132:135], v[100:103], v[136:139]
    s_waitcnt lgkmcnt(2)
    v_exp_f32 v122, v122
    v_mfma_f32_16x16x32_bf16 v[136:139], a[128:131], v[96:99], v[136:139]
    ds_read_b64_tr_b16 a[190:191], v27 offset:45056
    v_mfma_f32_16x16x32_bf16 a[16:19], v[144:147], a[160:163], a[16:19]
    s_add_u32 s52, s45, 650240
    v_exp_f32 v123, v123
    v_mfma_f32_16x16x32_bf16 a[16:19], v[160:163], a[164:167], a[16:19]
    buffer_load_dword v6, v15, s[64:67], s52 offen
    v_cvt_pk_bf16_f32 v197, v122, v123
    v_mfma_f32_16x16x32_bf16 a[48:51], v[164:167], a[164:167], a[48:51]
    s_add_u32 s33, s45, 179200
    v_exp_f32 v124, v124
    v_mfma_f32_16x16x32_bf16 a[48:51], v[148:151], a[160:163], a[48:51]
    v_mfma_f32_16x16x32_bf16 a[80:83], v[152:155], a[160:163], a[80:83]
    s_waitcnt vmcnt(37) lgkmcnt(0)
    v_exp_f32 v125, v125
    v_mfma_f32_16x16x32_bf16 a[80:83], v[168:171], a[164:167], a[80:83]
    s_barrier
    v_cvt_pk_bf16_f32 v198, v124, v125
    v_mfma_f32_16x16x32_bf16 a[112:115], v[172:175], a[164:167], a[112:115]
    s_add_u32 m0, s96, 49152
    v_exp_f32 v126, v126
    v_mfma_f32_16x16x32_bf16 a[112:115], v[156:159], a[160:163], a[112:115]
    buffer_load_dwordx4 v244, s[64:67], s33 offen offset:0 lds
    v_mfma_f32_16x16x32_bf16 a[116:119], v[156:159], a[168:171], a[116:119]
    ds_read_b64_tr_b16 a[128:129], v20 offset:49152
    v_exp_f32 v127, v127
    v_mfma_f32_16x16x32_bf16 a[116:119], v[172:175], a[172:175], a[116:119]
    ds_read_b64_tr_b16 a[130:131], v20 offset:53248
    v_cvt_pk_bf16_f32 v199, v126, v127
    v_mfma_f32_16x16x32_bf16 a[84:87], v[168:171], a[172:175], a[84:87]
    v_exp_f32 v128, v128
    v_mfma_f32_16x16x32_bf16 a[84:87], v[152:155], a[168:171], a[84:87]
    ds_read_b64_tr_b16 a[132:133], v20 offset:57344
    v_mfma_f32_16x16x32_bf16 a[52:55], v[148:151], a[168:171], a[52:55]
    ds_read_b64_tr_b16 a[134:135], v20 offset:61440
    v_exp_f32 v129, v129
    v_mfma_f32_16x16x32_bf16 a[52:55], v[164:167], a[172:175], a[52:55]
    buffer_load_dwordx4 v245, s[64:67], s33 offen offset:1024 lds
    v_mfma_f32_16x16x32_bf16 a[20:23], v[160:163], a[172:175], a[20:23]
    v_exp_f32 v130, v130
    v_mfma_f32_16x16x32_bf16 a[20:23], v[144:147], a[168:171], a[20:23]
    ds_read_b64_tr_b16 a[136:137], v21 offset:49152
    v_cvt_pk_bf16_f32 v200, v128, v129
    v_mfma_f32_16x16x32_bf16 a[24:27], v[144:147], a[176:179], a[24:27]
    ds_read_b64_tr_b16 a[138:139], v21 offset:53248
    v_exp_f32 v131, v131
    v_mfma_f32_16x16x32_bf16 a[24:27], v[160:163], a[180:183], a[24:27]
    ds_read_b64_tr_b16 a[140:141], v21 offset:57344
    v_cvt_pk_bf16_f32 v201, v130, v131
    v_mfma_f32_16x16x32_bf16 a[56:59], v[164:167], a[180:183], a[56:59]
    v_exp_f32 v132, v132
    v_mfma_f32_16x16x32_bf16 a[56:59], v[148:151], a[176:179], a[56:59]
    buffer_load_dwordx4 v246, s[64:67], s33 offen offset:2048 lds
    v_mfma_f32_16x16x32_bf16 a[88:91], v[152:155], a[176:179], a[88:91]
    ds_read_b64_tr_b16 a[142:143], v21 offset:61440
    v_exp_f32 v133, v133
    v_mfma_f32_16x16x32_bf16 a[88:91], v[168:171], a[180:183], a[88:91]
    ds_read_b64_tr_b16 a[144:145], v22 offset:49152
    v_cvt_pk_bf16_f32 v202, v132, v133
    v_mfma_f32_16x16x32_bf16 a[120:123], v[172:175], a[180:183], a[120:123]
    v_exp_f32 v134, v134
    v_mfma_f32_16x16x32_bf16 a[120:123], v[156:159], a[176:179], a[120:123]
    ds_read_b64_tr_b16 a[146:147], v22 offset:53248
    v_mfma_f32_16x16x32_bf16 a[124:127], v[156:159], a[184:187], a[124:127]
    ds_read_b64_tr_b16 a[148:149], v22 offset:57344
    v_exp_f32 v135, v135
    v_mfma_f32_16x16x32_bf16 a[124:127], v[172:175], a[188:191], a[124:127]
    buffer_load_dwordx4 v247, s[64:67], s33 offen offset:3072 lds
    v_mfma_f32_16x16x32_bf16 a[92:95], v[168:171], a[188:191], a[92:95]
    v_exp_f32 v136, v136
    v_mfma_f32_16x16x32_bf16 a[92:95], v[152:155], a[184:187], a[92:95]
    ds_read_b64_tr_b16 a[150:151], v22 offset:61440
    v_cvt_pk_bf16_f32 v203, v134, v135
    v_mfma_f32_16x16x32_bf16 a[60:63], v[148:151], a[184:187], a[60:63]
    ds_read_b64_tr_b16 a[152:153], v23 offset:49152
    v_exp_f32 v137, v137
    v_mfma_f32_16x16x32_bf16 a[60:63], v[164:167], a[188:191], a[60:63]
    ds_read_b64_tr_b16 a[154:155], v23 offset:53248
    v_cvt_pk_bf16_f32 v204, v136, v137
    v_mfma_f32_16x16x32_bf16 a[28:31], v[160:163], a[188:191], a[28:31]
    v_exp_f32 v138, v138
    v_mfma_f32_16x16x32_bf16 a[28:31], v[144:147], a[184:187], a[28:31]
    ds_read_b64_tr_b16 a[156:157], v23 offset:57344
    v_mfma_f32_16x16x32_bf16 v[232:235], v[152:155], v[248:251], v[232:235]
    v_exp_f32 v139, v139
    v_mfma_f32_16x16x32_bf16 v[232:235], v[168:171], v[248:251], v[232:235]
    ds_read_b64_tr_b16 a[158:159], v23 offset:61440
    v_cvt_pk_bf16_f32 v205, v138, v139
    v_mfma_f32_16x16x32_bf16 v[236:239], v[172:175], v[248:251], v[236:239]
    v_exp_f32 v140, v140
    v_mfma_f32_16x16x32_bf16 v[236:239], v[156:159], v[248:251], v[236:239]
    ds_read_b64_tr_b16 a[160:161], v24 offset:49152
    ds_read_b64_tr_b16 a[162:163], v24 offset:53248
    ds_read_b64_tr_b16 a[164:165], v24 offset:57344
    ds_read_b64_tr_b16 a[166:167], v24 offset:61440
    v_exp_f32 v141, v141
    v_exp_f32 v142, v142
    v_exp_f32 v143, v143
    s_mov_b32 s54, 0x5f800000
    v_cvt_pk_bf16_f32 v206, v140, v141
    v_cvt_pk_bf16_f32 v207, v142, v143
    s_add_u32 s33, s45, 327680
    s_add_u32 m0, s96, 98304
    v_mfma_f32_16x16x32_bf16 v[224:227], v[176:179], v[248:251], v[224:227]
    ds_read_b64_tr_b16 a[168:169], v25 offset:49152
    ds_read_b64_tr_b16 a[170:171], v25 offset:53248
    v_mfma_f32_16x16x32_bf16 v[224:227], v[192:195], v[248:251], v[224:227]
    ds_read_b64_tr_b16 a[172:173], v25 offset:57344
    ds_read_b64_tr_b16 a[174:175], v25 offset:61440
    v_mfma_f32_16x16x32_bf16 v[228:231], v[196:199], v[248:251], v[228:231]
    ds_read_b64_tr_b16 a[176:177], v26 offset:49152
    ds_read_b64_tr_b16 a[178:179], v26 offset:53248
    v_mfma_f32_16x16x32_bf16 v[228:231], v[180:183], v[248:251], v[228:231]
    ds_read_b64_tr_b16 a[180:181], v26 offset:57344
    ds_read_b64_tr_b16 a[182:183], v26 offset:61440
    v_mfma_f32_16x16x32_bf16 v[232:235], v[184:187], v[248:251], v[232:235]
    ds_read_b64_tr_b16 a[184:185], v27 offset:49152
    ds_read_b64_tr_b16 a[186:187], v27 offset:53248
    v_mfma_f32_16x16x32_bf16 v[232:235], v[200:203], v[248:251], v[232:235]
    ds_read_b64_tr_b16 a[188:189], v27 offset:57344
    ds_read_b64_tr_b16 a[190:191], v27 offset:61440
    v_mfma_f32_16x16x32_bf16 v[236:239], v[204:207], v[248:251], v[236:239]
    buffer_load_dwordx4 v244, s[64:67], s33 offen offset:0 lds
    v_mfma_f32_16x16x32_bf16 v[236:239], v[188:191], v[248:251], v[236:239]
    buffer_load_dwordx4 v245, s[64:67], s33 offen offset:1024 lds
    buffer_load_dwordx4 v246, s[64:67], s33 offen offset:2048 lds
    buffer_load_dwordx4 v247, s[64:67], s33 offen offset:3072 lds
    s_waitcnt lgkmcnt(0)
L1_epi:
    v_mfma_f32_16x16x32_bf16 a[0:3], v[176:179], a[128:131], a[0:3]
    s_nop 1
    v_mfma_f32_16x16x32_bf16 a[0:3], v[192:195], a[132:135], a[0:3]
    v_mfma_f32_16x16x32_bf16 a[4:7], v[192:195], a[140:143], a[4:7]
    v_mfma_f32_16x16x32_bf16 a[4:7], v[176:179], a[136:139], a[4:7]
    v_max3_f32 v8, v224, v225, v226
    v_max3_f32 v8, v8, v227, v228
    v_mfma_f32_16x16x32_bf16 a[8:11], v[176:179], a[144:147], a[8:11]
    v_max3_f32 v8, v8, v229, v230
    v_max3_f32 v8, v8, v231, v232
    v_mfma_f32_16x16x32_bf16 a[8:11], v[192:195], a[148:151], a[8:11]
    v_max3_f32 v8, v8, v233, v234
    v_max3_f32 v8, v8, v235, v236
    v_mfma_f32_16x16x32_bf16 a[12:15], v[192:195], a[156:159], a[12:15]
    v_max3_f32 v8, v8, v237, v238
    v_max_f32 v8, v8, v239
    v_cmp_gt_f32 vcc, v8, s54
    v_mfma_f32_16x16x32_bf16 a[12:15], v[176:179], a[152:155], a[12:15]
    s_lshl_b32 s52, s3, 19
    s_cbranch_vccnz L1_fallback
    s_lshl_b32 s53, s93, 12
    s_add_u32 s52, s52, s53
    v_mfma_f32_16x16x32_bf16 a[16:19], v[176:179], a[160:163], a[16:19]
    s_waitcnt vmcnt(32)
    v_rcp_f32_dpp v208, v224 row_newbcast:0 row_mask:0xf bank_mask:0xf
    v_mfma_f32_16x16x32_bf16 a[16:19], v[192:195], a[164:167], a[16:19]
    ds_read_b64_tr_b16 v[48:49], v42 offset:0
    v_rcp_f32_dpp v209, v225 row_newbcast:0 row_mask:0xf bank_mask:0xf
    v_mfma_f32_16x16x32_bf16 a[20:23], v[192:195], a[172:175], a[20:23]
    ds_read_b64_tr_b16 v[50:51], v42 offset:2048
    v_rcp_f32_dpp v210, v226 row_newbcast:0 row_mask:0xf bank_mask:0xf
    v_mfma_f32_16x16x32_bf16 a[20:23], v[176:179], a[168:171], a[20:23]
    ds_read_b64_tr_b16 v[52:53], v43 offset:0
    v_rcp_f32_dpp v211, v227 row_newbcast:0 row_mask:0xf bank_mask:0xf
    v_mfma_f32_16x16x32_bf16 a[24:27], v[176:179], a[176:179], a[24:27]
    ds_read_b64_tr_b16 v[54:55], v43 offset:2048
    v_rcp_f32_dpp v212, v228 row_newbcast:0 row_mask:0xf bank_mask:0xf
    v_mfma_f32_16x16x32_bf16 a[24:27], v[192:195], a[180:183], a[24:27]
    ds_read_b64_tr_b16 v[56:57], v44 offset:0
    v_rcp_f32_dpp v213, v229 row_newbcast:0 row_mask:0xf bank_mask:0xf
    v_mfma_f32_16x16x32_bf16 a[28:31], v[192:195], a[188:191], a[28:31]
    ds_read_b64_tr_b16 v[58:59], v44 offset:2048
    v_rcp_f32_dpp v214, v230 row_newbcast:0 row_mask:0xf bank_mask:0xf
    v_mfma_f32_16x16x32_bf16 a[28:31], v[176:179], a[184:187], a[28:31]
    ds_read_b64_tr_b16 v[60:61], v45 offset:0
    v_rcp_f32_dpp v215, v231 row_newbcast:0 row_mask:0xf bank_mask:0xf
    v_mfma_f32_16x16x32_bf16 a[60:63], v[180:183], a[184:187], a[60:63]
    ds_read_b64_tr_b16 v[62:63], v45 offset:2048
    v_mfma_f32_16x16x32_bf16 a[60:63], v[196:199], a[188:191], a[60:63]
    s_waitcnt vmcnt(28)
    v_mfma_f32_16x16x32_bf16 a[56:59], v[196:199], a[180:183], a[56:59]
    ds_read_b64_tr_b16 v[64:65], v38 offset:0
    v_mfma_f32_16x16x32_bf16 a[56:59], v[180:183], a[176:179], a[56:59]
    ds_read_b64_tr_b16 v[66:67], v38 offset:2048
    v_mfma_f32_16x16x32_bf16 a[52:55], v[180:183], a[168:171], a[52:55]
    ds_read_b64_tr_b16 v[68:69], v39 offset:0
    v_accvgpr_read_b32 v112, a0
    v_mfma_f32_16x16x32_bf16 a[52:55], v[196:199], a[172:175], a[52:55]
    ds_read_b64_tr_b16 v[70:71], v39 offset:2048
    v_accvgpr_read_b32 v113, a4
    v_mfma_f32_16x16x32_bf16 a[48:51], v[196:199], a[164:167], a[48:51]
    ds_read_b64_tr_b16 v[72:73], v40 offset:0
    v_accvgpr_read_b32 v114, a8
    v_mfma_f32_16x16x32_bf16 a[48:51], v[180:183], a[160:163], a[48:51]
    ds_read_b64_tr_b16 v[74:75], v40 offset:2048
    v_accvgpr_read_b32 v115, a12
    v_mfma_f32_16x16x32_bf16 a[44:47], v[180:183], a[152:155], a[44:47]
    ds_read_b64_tr_b16 v[76:77], v41 offset:0
    v_accvgpr_read_b32 v116, a16
    v_mfma_f32_16x16x32_bf16 a[44:47], v[196:199], a[156:159], a[44:47]
    ds_read_b64_tr_b16 v[78:79], v41 offset:2048
    v_accvgpr_read_b32 v117, a20
    v_mfma_f32_16x16x32_bf16 a[40:43], v[196:199], a[148:151], a[40:43]
    s_waitcnt lgkmcnt(8)
    v_accvgpr_read_b32 v118, a24
    v_accvgpr_read_b32 v119, a28
    v_mfma_f32_16x16x32_bf16 a[40:43], v[180:183], a[144:147], a[40:43]
    s_add_u32 m0, s47, 0
    v_mul_f32 v112, v112, v208
    v_mul_f32 v113, v113, v208
    v_mfma_f32_16x16x32_bf16 a[36:39], v[180:183], a[136:139], a[36:39]
    s_add_u32 s33, s45, 332800
    v_mul_f32 v114, v114, v208
    v_mul_f32 v115, v115, v208
    v_mfma_f32_16x16x32_bf16 a[36:39], v[196:199], a[140:143], a[36:39]
    buffer_load_dwordx4 v244, s[64:67], s33 offen offset:0 lds
    v_mfma_f32_16x16x32_bf16 a[32:35], v[196:199], a[132:135], a[32:35]
    v_mul_f32 v116, v116, v208
    v_mul_f32 v117, v117, v208
    v_mfma_f32_16x16x32_bf16 a[32:35], v[180:183], a[128:131], a[32:35]
    buffer_load_dwordx4 v245, s[64:67], s33 offen offset:1024 lds
    v_mfma_f32_16x16x32_bf16 a[64:67], v[184:187], a[128:131], a[64:67]
    v_mul_f32 v118, v118, v208
    v_mul_f32 v119, v119, v208
    v_mfma_f32_16x16x32_bf16 a[64:67], v[200:203], a[132:135], a[64:67]
    buffer_load_dwordx4 v246, s[64:67], s33 offen offset:2048 lds
    v_mfma_f32_16x16x32_bf16 a[68:71], v[200:203], a[140:143], a[68:71]
    v_cvt_pk_bf16_f32 v120, v112, v113
    v_cvt_pk_bf16_f32 v121, v114, v115
    v_mfma_f32_16x16x32_bf16 a[68:71], v[184:187], a[136:139], a[68:71]
    buffer_load_dwordx4 v247, s[64:67], s33 offen offset:3072 lds
    v_mfma_f32_16x16x32_bf16 a[72:75], v[184:187], a[144:147], a[72:75]
    v_cvt_pk_bf16_f32 v122, v116, v117
    v_cvt_pk_bf16_f32 v123, v118, v119
    v_mfma_f32_16x16x32_bf16 a[72:75], v[200:203], a[148:151], a[72:75]
    buffer_store_dwordx4 v[120:123], v254, s[24:27], s52 offen offset:0 sc1
    v_mfma_f32_16x16x32_bf16 a[76:79], v[200:203], a[156:159], a[76:79]
    v_accvgpr_read_b32 v124, a1
    v_accvgpr_read_b32 v125, a5
    v_mfma_f32_16x16x32_bf16 a[76:79], v[184:187], a[152:155], a[76:79]
    v_accvgpr_read_b32 v126, a9
    v_accvgpr_read_b32 v127, a13
    v_mfma_f32_16x16x32_bf16 a[80:83], v[184:187], a[160:163], a[80:83]
    v_accvgpr_read_b32 v128, a17
    v_accvgpr_read_b32 v129, a21
    v_mfma_f32_16x16x32_bf16 a[80:83], v[200:203], a[164:167], a[80:83]
    v_accvgpr_read_b32 v130, a25
    v_accvgpr_read_b32 v131, a29
    v_mfma_f32_16x16x32_bf16 a[84:87], v[200:203], a[172:175], a[84:87]
    v_mul_f32 v124, v124, v209
    v_mul_f32 v125, v125, v209
    v_mfma_f32_16x16x32_bf16 a[84:87], v[184:187], a[168:171], a[84:87]
    v_mul_f32 v126, v126, v209
    v_mul_f32 v127, v127, v209
    v_mfma_f32_16x16x32_bf16 a[88:91], v[184:187], a[176:179], a[88:91]
    v_mul_f32 v128, v128, v209
    v_mul_f32 v129, v129, v209
    v_mfma_f32_16x16x32_bf16 a[88:91], v[200:203], a[180:183], a[88:91]
    v_mul_f32 v130, v130, v209
    v_mul_f32 v131, v131, v209
    v_mfma_f32_16x16x32_bf16 a[92:95], v[200:203], a[188:191], a[92:95]
    v_cvt_pk_bf16_f32 v132, v124, v125
    v_cvt_pk_bf16_f32 v133, v126, v127
    v_mfma_f32_16x16x32_bf16 a[92:95], v[184:187], a[184:187], a[92:95]
    v_cvt_pk_bf16_f32 v134, v128, v129
    v_cvt_pk_bf16_f32 v135, v130, v131
    v_mfma_f32_16x16x32_bf16 a[124:127], v[188:191], a[184:187], a[124:127]
    buffer_store_dwordx4 v[132:135], v254, s[24:27], s52 offen offset:256 sc1
    v_mfma_f32_16x16x32_bf16 a[124:127], v[204:207], a[188:191], a[124:127]
    v_accvgpr_read_b32 v112, a2
    v_accvgpr_read_b32 v113, a6
    v_mfma_f32_16x16x32_bf16 a[120:123], v[204:207], a[180:183], a[120:123]
    v_accvgpr_read_b32 v114, a10
    v_accvgpr_read_b32 v115, a14
    v_mfma_f32_16x16x32_bf16 a[120:123], v[188:191], a[176:179], a[120:123]
    v_accvgpr_read_b32 v116, a18
    v_accvgpr_read_b32 v117, a22
    v_mfma_f32_16x16x32_bf16 a[116:119], v[188:191], a[168:171], a[116:119]
    v_accvgpr_read_b32 v118, a26
    v_accvgpr_read_b32 v119, a30
    v_mfma_f32_16x16x32_bf16 a[116:119], v[204:207], a[172:175], a[116:119]
    v_mul_f32 v112, v112, v210
    v_mul_f32 v113, v113, v210
    v_mfma_f32_16x16x32_bf16 a[112:115], v[204:207], a[164:167], a[112:115]
    v_mul_f32 v114, v114, v210
    v_mul_f32 v115, v115, v210
    v_mfma_f32_16x16x32_bf16 a[112:115], v[188:191], a[160:163], a[112:115]
    v_mul_f32 v116, v116, v210
    v_mul_f32 v117, v117, v210
    v_mfma_f32_16x16x32_bf16 a[108:111], v[188:191], a[152:155], a[108:111]
    v_mul_f32 v118, v118, v210
    v_mul_f32 v119, v119, v210
    v_mfma_f32_16x16x32_bf16 a[108:111], v[204:207], a[156:159], a[108:111]
    v_cvt_pk_bf16_f32 v120, v112, v113
    v_cvt_pk_bf16_f32 v121, v114, v115
    v_mfma_f32_16x16x32_bf16 a[104:107], v[204:207], a[148:151], a[104:107]
    v_cvt_pk_bf16_f32 v122, v116, v117
    v_cvt_pk_bf16_f32 v123, v118, v119
    v_mfma_f32_16x16x32_bf16 a[104:107], v[188:191], a[144:147], a[104:107]
    buffer_store_dwordx4 v[120:123], v254, s[24:27], s52 offen offset:512 sc1
    v_mfma_f32_16x16x32_bf16 a[100:103], v[188:191], a[136:139], a[100:103]
    v_mfma_f32_16x16x32_bf16 a[100:103], v[204:207], a[140:143], a[100:103]
    v_mfma_f32_16x16x32_bf16 a[96:99], v[204:207], a[132:135], a[96:99]
    v_mfma_f32_16x16x32_bf16 a[96:99], v[188:191], a[128:131], a[96:99]
    v_rcp_f32_dpp v216, v232 row_newbcast:0 row_mask:0xf bank_mask:0xf
    v_rcp_f32_dpp v217, v233 row_newbcast:0 row_mask:0xf bank_mask:0xf
    v_rcp_f32_dpp v218, v234 row_newbcast:0 row_mask:0xf bank_mask:0xf
    v_rcp_f32_dpp v219, v235 row_newbcast:0 row_mask:0xf bank_mask:0xf
    v_rcp_f32_dpp v220, v236 row_newbcast:0 row_mask:0xf bank_mask:0xf
    v_rcp_f32_dpp v221, v237 row_newbcast:0 row_mask:0xf bank_mask:0xf
    v_rcp_f32_dpp v222, v238 row_newbcast:0 row_mask:0xf bank_mask:0xf
    v_rcp_f32_dpp v223, v239 row_newbcast:0 row_mask:0xf bank_mask:0xf
    v_accvgpr_read_b32 v124, a3
    v_accvgpr_read_b32 v125, a7
    v_accvgpr_read_b32 v126, a11
    v_accvgpr_read_b32 v127, a15
    v_accvgpr_read_b32 v128, a19
    v_accvgpr_read_b32 v129, a23
    v_accvgpr_read_b32 v130, a27
    v_accvgpr_read_b32 v131, a31
    v_pk_mul_f32 v[124:125], v[124:125], v[210:211] op_sel:[0,1] op_sel_hi:[1,1]
    v_pk_mul_f32 v[126:127], v[126:127], v[210:211] op_sel:[0,1] op_sel_hi:[1,1]
    v_pk_mul_f32 v[128:129], v[128:129], v[210:211] op_sel:[0,1] op_sel_hi:[1,1]
    v_pk_mul_f32 v[130:131], v[130:131], v[210:211] op_sel:[0,1] op_sel_hi:[1,1]
    v_cvt_pk_bf16_f32 v132, v124, v125
    v_cvt_pk_bf16_f32 v133, v126, v127
    v_cvt_pk_bf16_f32 v134, v128, v129
    v_cvt_pk_bf16_f32 v135, v130, v131
    buffer_store_dwordx4 v[132:135], v254, s[24:27], s52 offen offset:768 sc1
    s_add_u32 s52, s52, 131072
    v_accvgpr_read_b32 v112, a32
    v_accvgpr_read_b32 v113, a36
    v_accvgpr_read_b32 v114, a40
    v_accvgpr_read_b32 v115, a44
    v_accvgpr_read_b32 v116, a48
    v_accvgpr_read_b32 v117, a52
    v_accvgpr_read_b32 v118, a56
    v_accvgpr_read_b32 v119, a60
    v_pk_mul_f32 v[112:113], v[112:113], v[212:213] op_sel_hi:[1,0]
    v_pk_mul_f32 v[114:115], v[114:115], v[212:213] op_sel_hi:[1,0]
    v_pk_mul_f32 v[116:117], v[116:117], v[212:213] op_sel_hi:[1,0]
    v_pk_mul_f32 v[118:119], v[118:119], v[212:213] op_sel_hi:[1,0]
    v_cvt_pk_bf16_f32 v120, v112, v113
    v_cvt_pk_bf16_f32 v121, v114, v115
    v_cvt_pk_bf16_f32 v122, v116, v117
    v_cvt_pk_bf16_f32 v123, v118, v119
    buffer_store_dwordx4 v[120:123], v254, s[24:27], s52 offen offset:0 sc1
    v_accvgpr_read_b32 v124, a33
    v_accvgpr_read_b32 v125, a37
    v_accvgpr_read_b32 v126, a41
    v_accvgpr_read_b32 v127, a45
    v_accvgpr_read_b32 v128, a49
    v_accvgpr_read_b32 v129, a53
    v_accvgpr_read_b32 v130, a57
    v_accvgpr_read_b32 v131, a61
    v_pk_mul_f32 v[124:125], v[124:125], v[212:213] op_sel:[0,1] op_sel_hi:[1,1]
    v_pk_mul_f32 v[126:127], v[126:127], v[212:213] op_sel:[0,1] op_sel_hi:[1,1]
    v_pk_mul_f32 v[128:129], v[128:129], v[212:213] op_sel:[0,1] op_sel_hi:[1,1]
    v_pk_mul_f32 v[130:131], v[130:131], v[212:213] op_sel:[0,1] op_sel_hi:[1,1]
    v_cvt_pk_bf16_f32 v132, v124, v125
    v_cvt_pk_bf16_f32 v133, v126, v127
    v_cvt_pk_bf16_f32 v134, v128, v129
    v_cvt_pk_bf16_f32 v135, v130, v131
    buffer_store_dwordx4 v[132:135], v254, s[24:27], s52 offen offset:256 sc1
    v_accvgpr_read_b32 v112, a34
    v_accvgpr_read_b32 v113, a38
    v_accvgpr_read_b32 v114, a42
    v_accvgpr_read_b32 v115, a46
    v_accvgpr_read_b32 v116, a50
    v_accvgpr_read_b32 v117, a54
    v_accvgpr_read_b32 v118, a58
    v_accvgpr_read_b32 v119, a62
    v_pk_mul_f32 v[112:113], v[112:113], v[214:215] op_sel_hi:[1,0]
    v_pk_mul_f32 v[114:115], v[114:115], v[214:215] op_sel_hi:[1,0]
    v_pk_mul_f32 v[116:117], v[116:117], v[214:215] op_sel_hi:[1,0]
    v_pk_mul_f32 v[118:119], v[118:119], v[214:215] op_sel_hi:[1,0]
    v_cvt_pk_bf16_f32 v120, v112, v113
    v_cvt_pk_bf16_f32 v121, v114, v115
    v_cvt_pk_bf16_f32 v122, v116, v117
    v_cvt_pk_bf16_f32 v123, v118, v119
    buffer_store_dwordx4 v[120:123], v254, s[24:27], s52 offen offset:512 sc1
    v_accvgpr_read_b32 v124, a35
    v_accvgpr_read_b32 v125, a39
    v_accvgpr_read_b32 v126, a43
    v_accvgpr_read_b32 v127, a47
    v_accvgpr_read_b32 v128, a51
    v_accvgpr_read_b32 v129, a55
    v_accvgpr_read_b32 v130, a59
    v_accvgpr_read_b32 v131, a63
    v_pk_mul_f32 v[124:125], v[124:125], v[214:215] op_sel:[0,1] op_sel_hi:[1,1]
    v_pk_mul_f32 v[126:127], v[126:127], v[214:215] op_sel:[0,1] op_sel_hi:[1,1]
    v_pk_mul_f32 v[128:129], v[128:129], v[214:215] op_sel:[0,1] op_sel_hi:[1,1]
    v_pk_mul_f32 v[130:131], v[130:131], v[214:215] op_sel:[0,1] op_sel_hi:[1,1]
    v_cvt_pk_bf16_f32 v132, v124, v125
    v_cvt_pk_bf16_f32 v133, v126, v127
    v_cvt_pk_bf16_f32 v134, v128, v129
    v_cvt_pk_bf16_f32 v135, v130, v131
    buffer_store_dwordx4 v[132:135], v254, s[24:27], s52 offen offset:768 sc1
    s_add_u32 s52, s52, 131072
    v_accvgpr_read_b32 v112, a64
    v_accvgpr_read_b32 v113, a68
    v_accvgpr_read_b32 v114, a72
    v_accvgpr_read_b32 v115, a76
    v_accvgpr_read_b32 v116, a80
    v_accvgpr_read_b32 v117, a84
    v_accvgpr_read_b32 v118, a88
    v_accvgpr_read_b32 v119, a92
    v_pk_mul_f32 v[112:113], v[112:113], v[216:217] op_sel_hi:[1,0]
    v_pk_mul_f32 v[114:115], v[114:115], v[216:217] op_sel_hi:[1,0]
    v_pk_mul_f32 v[116:117], v[116:117], v[216:217] op_sel_hi:[1,0]
    v_pk_mul_f32 v[118:119], v[118:119], v[216:217] op_sel_hi:[1,0]
    v_cvt_pk_bf16_f32 v120, v112, v113
    v_cvt_pk_bf16_f32 v121, v114, v115
    v_cvt_pk_bf16_f32 v122, v116, v117
    v_cvt_pk_bf16_f32 v123, v118, v119
    buffer_store_dwordx4 v[120:123], v254, s[24:27], s52 offen offset:0 sc1
    v_accvgpr_read_b32 v124, a65
    v_accvgpr_read_b32 v125, a69
    v_accvgpr_read_b32 v126, a73
    v_accvgpr_read_b32 v127, a77
    v_accvgpr_read_b32 v128, a81
    v_accvgpr_read_b32 v129, a85
    v_accvgpr_read_b32 v130, a89
    v_accvgpr_read_b32 v131, a93
    v_pk_mul_f32 v[124:125], v[124:125], v[216:217] op_sel:[0,1] op_sel_hi:[1,1]
    v_pk_mul_f32 v[126:127], v[126:127], v[216:217] op_sel:[0,1] op_sel_hi:[1,1]
    v_pk_mul_f32 v[128:129], v[128:129], v[216:217] op_sel:[0,1] op_sel_hi:[1,1]
    v_pk_mul_f32 v[130:131], v[130:131], v[216:217] op_sel:[0,1] op_sel_hi:[1,1]
    v_cvt_pk_bf16_f32 v132, v124, v125
    v_cvt_pk_bf16_f32 v133, v126, v127
    v_cvt_pk_bf16_f32 v134, v128, v129
    v_cvt_pk_bf16_f32 v135, v130, v131
    buffer_store_dwordx4 v[132:135], v254, s[24:27], s52 offen offset:256 sc1
    v_accvgpr_read_b32 v112, a66
    v_accvgpr_read_b32 v113, a70
    v_accvgpr_read_b32 v114, a74
    v_accvgpr_read_b32 v115, a78
    v_accvgpr_read_b32 v116, a82
    v_accvgpr_read_b32 v117, a86
    v_accvgpr_read_b32 v118, a90
    v_accvgpr_read_b32 v119, a94
    v_pk_mul_f32 v[112:113], v[112:113], v[218:219] op_sel_hi:[1,0]
    v_pk_mul_f32 v[114:115], v[114:115], v[218:219] op_sel_hi:[1,0]
    v_pk_mul_f32 v[116:117], v[116:117], v[218:219] op_sel_hi:[1,0]
    v_pk_mul_f32 v[118:119], v[118:119], v[218:219] op_sel_hi:[1,0]
    v_cvt_pk_bf16_f32 v120, v112, v113
    v_cvt_pk_bf16_f32 v121, v114, v115
    v_cvt_pk_bf16_f32 v122, v116, v117
    v_cvt_pk_bf16_f32 v123, v118, v119
    buffer_store_dwordx4 v[120:123], v254, s[24:27], s52 offen offset:512 sc1
    v_accvgpr_read_b32 v124, a67
    v_accvgpr_read_b32 v125, a71
    v_accvgpr_read_b32 v126, a75
    v_accvgpr_read_b32 v127, a79
    v_accvgpr_read_b32 v128, a83
    v_accvgpr_read_b32 v129, a87
    v_accvgpr_read_b32 v130, a91
    v_accvgpr_read_b32 v131, a95
    v_pk_mul_f32 v[124:125], v[124:125], v[218:219] op_sel:[0,1] op_sel_hi:[1,1]
    v_pk_mul_f32 v[126:127], v[126:127], v[218:219] op_sel:[0,1] op_sel_hi:[1,1]
    v_pk_mul_f32 v[128:129], v[128:129], v[218:219] op_sel:[0,1] op_sel_hi:[1,1]
    v_pk_mul_f32 v[130:131], v[130:131], v[218:219] op_sel:[0,1] op_sel_hi:[1,1]
    v_cvt_pk_bf16_f32 v132, v124, v125
    v_cvt_pk_bf16_f32 v133, v126, v127
    v_cvt_pk_bf16_f32 v134, v128, v129
    v_cvt_pk_bf16_f32 v135, v130, v131
    buffer_store_dwordx4 v[132:135], v254, s[24:27], s52 offen offset:768 sc1
    s_add_u32 s52, s52, 131072
    v_accvgpr_read_b32 v112, a96
    v_accvgpr_read_b32 v113, a100
    v_accvgpr_read_b32 v114, a104
    v_accvgpr_read_b32 v115, a108
    v_accvgpr_read_b32 v116, a112
    v_accvgpr_read_b32 v117, a116
    v_accvgpr_read_b32 v118, a120
    v_accvgpr_read_b32 v119, a124
    v_pk_mul_f32 v[112:113], v[112:113], v[220:221] op_sel_hi:[1,0]
    v_pk_mul_f32 v[114:115], v[114:115], v[220:221] op_sel_hi:[1,0]
    v_pk_mul_f32 v[116:117], v[116:117], v[220:221] op_sel_hi:[1,0]
    v_pk_mul_f32 v[118:119], v[118:119], v[220:221] op_sel_hi:[1,0]
    v_cvt_pk_bf16_f32 v120, v112, v113
    v_cvt_pk_bf16_f32 v121, v114, v115
    v_cvt_pk_bf16_f32 v122, v116, v117
    v_cvt_pk_bf16_f32 v123, v118, v119
    buffer_store_dwordx4 v[120:123], v254, s[24:27], s52 offen offset:0 sc1
    v_accvgpr_read_b32 v124, a97
    v_accvgpr_read_b32 v125, a101
    v_accvgpr_read_b32 v126, a105
    v_accvgpr_read_b32 v127, a109
    v_accvgpr_read_b32 v128, a113
    v_accvgpr_read_b32 v129, a117
    v_accvgpr_read_b32 v130, a121
    v_accvgpr_read_b32 v131, a125
    v_pk_mul_f32 v[124:125], v[124:125], v[220:221] op_sel:[0,1] op_sel_hi:[1,1]
    v_pk_mul_f32 v[126:127], v[126:127], v[220:221] op_sel:[0,1] op_sel_hi:[1,1]
    v_pk_mul_f32 v[128:129], v[128:129], v[220:221] op_sel:[0,1] op_sel_hi:[1,1]
    v_pk_mul_f32 v[130:131], v[130:131], v[220:221] op_sel:[0,1] op_sel_hi:[1,1]
    v_cvt_pk_bf16_f32 v132, v124, v125
    v_cvt_pk_bf16_f32 v133, v126, v127
    v_cvt_pk_bf16_f32 v134, v128, v129
    v_cvt_pk_bf16_f32 v135, v130, v131
    buffer_store_dwordx4 v[132:135], v254, s[24:27], s52 offen offset:256 sc1
    v_accvgpr_read_b32 v112, a98
    v_accvgpr_read_b32 v113, a102
    v_accvgpr_read_b32 v114, a106
    v_accvgpr_read_b32 v115, a110
    v_accvgpr_read_b32 v116, a114
    v_accvgpr_read_b32 v117, a118
    v_accvgpr_read_b32 v118, a122
    v_accvgpr_read_b32 v119, a126
    v_pk_mul_f32 v[112:113], v[112:113], v[222:223] op_sel_hi:[1,0]
    v_pk_mul_f32 v[114:115], v[114:115], v[222:223] op_sel_hi:[1,0]
    v_pk_mul_f32 v[116:117], v[116:117], v[222:223] op_sel_hi:[1,0]
    v_pk_mul_f32 v[118:119], v[118:119], v[222:223] op_sel_hi:[1,0]
    v_cvt_pk_bf16_f32 v120, v112, v113
    v_cvt_pk_bf16_f32 v121, v114, v115
    v_cvt_pk_bf16_f32 v122, v116, v117
    v_cvt_pk_bf16_f32 v123, v118, v119
    buffer_store_dwordx4 v[120:123], v254, s[24:27], s52 offen offset:512 sc1
    v_accvgpr_read_b32 v124, a99
    v_accvgpr_read_b32 v125, a103
    v_accvgpr_read_b32 v126, a107
    v_accvgpr_read_b32 v127, a111
    v_accvgpr_read_b32 v128, a115
    v_accvgpr_read_b32 v129, a119
    v_accvgpr_read_b32 v130, a123
    v_accvgpr_read_b32 v131, a127
    v_pk_mul_f32 v[124:125], v[124:125], v[222:223] op_sel:[0,1] op_sel_hi:[1,1]
    v_pk_mul_f32 v[126:127], v[126:127], v[222:223] op_sel:[0,1] op_sel_hi:[1,1]
    v_pk_mul_f32 v[128:129], v[128:129], v[222:223] op_sel:[0,1] op_sel_hi:[1,1]
    v_pk_mul_f32 v[130:131], v[130:131], v[222:223] op_sel:[0,1] op_sel_hi:[1,1]
    v_cvt_pk_bf16_f32 v132, v124, v125
    v_cvt_pk_bf16_f32 v133, v126, v127
    v_cvt_pk_bf16_f32 v134, v128, v129
    v_cvt_pk_bf16_f32 v135, v130, v131
    buffer_store_dwordx4 v[132:135], v254, s[24:27], s52 offen offset:768 sc1
    s_waitcnt vmcnt(20)
    ds_read_b64_tr_b16 v[80:81], v42 offset:4096
    ds_read_b64_tr_b16 v[82:83], v42 offset:6144
    ds_read_b64_tr_b16 v[84:85], v43 offset:4096
    ds_read_b64_tr_b16 v[86:87], v43 offset:6144
    ds_read_b64_tr_b16 v[88:89], v44 offset:4096
    ds_read_b64_tr_b16 v[90:91], v44 offset:6144
    ds_read_b64_tr_b16 v[92:93], v45 offset:4096
    ds_read_b64_tr_b16 v[94:95], v45 offset:6144
    ds_read_b64_tr_b16 v[96:97], v34 offset:32768
    ds_read_b64_tr_b16 v[98:99], v34 offset:34816
    ds_read_b64_tr_b16 v[100:101], v35 offset:32768
    ds_read_b64_tr_b16 v[102:103], v35 offset:34816
    ds_read_b64_tr_b16 v[104:105], v36 offset:32768
    ds_read_b64_tr_b16 v[106:107], v36 offset:34816
    ds_read_b64_tr_b16 v[108:109], v37 offset:32768
    ds_read_b64_tr_b16 v[110:111], v37 offset:34816
    ds_read_b64_tr_b16 a[128:129], v34 offset:0
    ds_read_b64_tr_b16 a[130:131], v34 offset:2048
    ds_read_b64_tr_b16 a[132:133], v35 offset:0
    ds_read_b64_tr_b16 a[134:135], v35 offset:2048
    ds_read_b64_tr_b16 a[136:137], v36 offset:0
    ds_read_b64_tr_b16 a[138:139], v36 offset:2048
    ds_read_b64_tr_b16 a[140:141], v37 offset:0
    ds_read_b64_tr_b16 a[142:143], v37 offset:2048
    ds_read_b64_tr_b16 a[144:145], v38 offset:16384
    ds_read_b64_tr_b16 a[146:147], v38 offset:18432
    ds_read_b64_tr_b16 a[148:149], v39 offset:16384
    ds_read_b64_tr_b16 a[150:151], v39 offset:18432
    ds_read_b64_tr_b16 a[152:153], v40 offset:16384
    ds_read_b64_tr_b16 a[154:155], v40 offset:18432
    ds_read_b64_tr_b16 a[156:157], v41 offset:16384
    ds_read_b64_tr_b16 a[158:159], v41 offset:18432
    ds_read_b64_tr_b16 a[160:161], v34 offset:16384
    ds_read_b64_tr_b16 a[162:163], v34 offset:18432
    ds_read_b64_tr_b16 a[164:165], v35 offset:16384
    ds_read_b64_tr_b16 a[166:167], v35 offset:18432
    ds_read_b64_tr_b16 a[168:169], v36 offset:16384
    ds_read_b64_tr_b16 a[170:171], v36 offset:18432
    ds_read_b64_tr_b16 a[172:173], v37 offset:16384
    ds_read_b64_tr_b16 a[174:175], v37 offset:18432
    ds_read_b64_tr_b16 a[176:177], v34 offset:49152
    ds_read_b64_tr_b16 a[178:179], v34 offset:51200
    ds_read_b64_tr_b16 a[180:181], v35 offset:49152
    ds_read_b64_tr_b16 a[182:183], v35 offset:51200
    ds_read_b64_tr_b16 a[184:185], v36 offset:49152
    ds_read_b64_tr_b16 a[186:187], v36 offset:51200
    ds_read_b64_tr_b16 a[188:189], v37 offset:49152
    ds_read_b64_tr_b16 a[190:191], v37 offset:51200
    ds_read_b64_tr_b16 v[144:145], v38 offset:32768
    ds_read_b64_tr_b16 v[146:147], v38 offset:34816
    ds_read_b64_tr_b16 v[148:149], v39 offset:32768
    ds_read_b64_tr_b16 v[150:151], v39 offset:34816
    ds_read_b64_tr_b16 v[152:153], v40 offset:32768
    ds_read_b64_tr_b16 v[154:155], v40 offset:34816
    ds_read_b64_tr_b16 v[156:157], v41 offset:32768
    ds_read_b64_tr_b16 v[158:159], v41 offset:34816
    v_lshlrev_b32 v8, 8, v7
    v_lshl_add_u32 v8, v1, 6, v8
    v_lshl_add_u32 v16, v4, 4, v8
    v_add_u32 v17, 0x20000, v16
    v_add_u32 v18, 0x40000, v16
    v_add_u32 v19, 0x60000, v16
    v_add_u32 v20, 0x80000, v16
    v_mul_u32_u24 v8, 5120, v1
    v_lshl_add_u32 v21, v2, 3, v8
    v_xor_b32 v8, v2, v1
    v_lshlrev_b32 v8, 4, v8
    v_lshl_add_u32 v9, v1, 8, v8
    v_add_u32 v24, s96, v9
    v_xor_b32 v25, 64, v24
    v_xor_b32 v26, 0x80, v24
    v_xor_b32 v27, 0xc0, v24
    v_add_u32 v28, 0x10000, v24
    v_add_u32 v29, 0x10000, v25
    v_add_u32 v30, 0x10000, v26
    v_add_u32 v31, 0x10000, v27
    s_lshl_b32 s53, s3, 6
    v_lshl_add_u32 v10, v2, 8, v8
    v_xor_b32 v10, s53, v10
    v_add_u32 v11, 0x10000, v10
    s_mov_b32 s51, 0x40000
L1_chk:
    v_readfirstlane_b32 s53, v14
    s_sub_u32 s51, s51, 1
    s_cbranch_scc1 L1_clr
    s_cmp_ge_u32 s53, 32
    s_cbranch_scc1 L1_clr
    buffer_load_dword v14, v255, s[80:83], 0 offen offset:128 sc1
    s_waitcnt vmcnt(0)
    s_branch L1_chk
L1_clr:
    s_mov_b32 s51, 0x40000
    s_waitcnt lgkmcnt(0)
    s_waitcnt vmcnt(0)
    s_barrier
    s_cmp_lg_u32 s3, 0
    s_cbranch_scc1 L1_nosig
    s_lshr_b32 s52, s93, 3
    s_lshl_b32 s53, s92, 2
    s_add_u32 s52, s52, s53
    s_lshl_b32 s52, s52, 8
    v_mov_b32 v8, 1
    s_mov_b64 exec, 1
    buffer_atomic_add v8, v255, s[76:79], s52 offen sc1
    s_mov_b64 exec, -1
L1_nosig:
    s_cmp_ge_u32 s46, 30
    s_cbranch_scc1 L1_fin
    ds_read_b64_tr_b16 v[160:161], v42 offset:0
    ds_read_b64_tr_b16 v[162:163], v42 offset:2048
    ds_read_b64_tr_b16 v[164:165], v43 offset:0
    ds_read_b64_tr_b16 v[166:167], v43 offset:2048
    ds_read_b64_tr_b16 v[168:169], v44 offset:0
    ds_read_b64_tr_b16 v[170:171], v44 offset:2048
    ds_read_b64_tr_b16 v[172:173], v45 offset:0
    ds_read_b64_tr_b16 v[174:175], v45 offset:2048
    s_add_u32 m0, s96, 114688
    s_add_u32 s33, s45, 337920
    buffer_load_dwordx4 v244, s[64:67], s33 offen offset:0 lds
    buffer_load_dwordx4 v245, s[64:67], s33 offen offset:1024 lds
    buffer_load_dwordx4 v246, s[64:67], s33 offen offset:2048 lds
    buffer_load_dwordx4 v247, s[64:67], s33 offen offset:3072 lds
    s_add_u32 m0, s96, 65536
    s_add_u32 s33, s45, 343040
    buffer_load_dwordx4 v244, s[64:67], s33 offen offset:0 lds
    buffer_load_dwordx4 v245, s[64:67], s33 offen offset:1024 lds
    buffer_load_dwordx4 v246, s[64:67], s33 offen offset:2048 lds
    buffer_load_dwordx4 v247, s[64:67], s33 offen offset:3072 lds
    s_add_u32 m0, s47, 4096
    s_add_u32 s33, s45, 491520
    buffer_load_dwordx4 v244, s[64:67], s33 offen offset:0 lds
    buffer_load_dwordx4 v245, s[64:67], s33 offen offset:1024 lds
    buffer_load_dwordx4 v246, s[64:67], s33 offen offset:2048 lds
    buffer_load_dwordx4 v247, s[64:67], s33 offen offset:3072 lds
    s_add_u32 m0, s96, 32768
    s_add_u32 s33, s45, 496640
    buffer_load_dwordx4 v244, s[64:67], s33 offen offset:0 lds
    buffer_load_dwordx4 v245, s[64:67], s33 offen offset:1024 lds
    buffer_load_dwordx4 v246, s[64:67], s33 offen offset:2048 lds
    buffer_load_dwordx4 v247, s[64:67], s33 offen offset:3072 lds
    s_add_u32 m0, s96, 0
    s_add_u32 s33, s45, 501760
    buffer_load_dwordx4 v244, s[64:67], s33 offen offset:0 lds
    buffer_load_dwordx4 v245, s[64:67], s33 offen offset:1024 lds
    buffer_load_dwordx4 v246, s[64:67], s33 offen offset:2048 lds
    buffer_load_dwordx4 v247, s[64:67], s33 offen offset:3072 lds
    s_add_u32 m0, s96, 81920
    s_add_u32 s33, s45, 506880
    buffer_load_dwordx4 v244, s[64:67], s33 offen offset:0 lds
    buffer_load_dwordx4 v245, s[64:67], s33 offen offset:1024 lds
    buffer_load_dwordx4 v246, s[64:67], s33 offen offset:2048 lds
    buffer_load_dwordx4 v247, s[64:67], s33 offen offset:3072 lds
    s_add_u32 m0, s96, 16384
    s_add_u32 s33, s98, 655360
    buffer_load_dwordx4 v244, s[64:67], s33 offen offset:0 lds
    buffer_load_dwordx4 v245, s[64:67], s33 offen offset:1024 lds
    buffer_load_dwordx4 v246, s[64:67], s33 offen offset:2048 lds
    buffer_load_dwordx4 v247, s[64:67], s33 offen offset:3072 lds
    s_add_u32 m0, s96, 49152
    s_add_u32 s33, s98, 660480
    buffer_load_dwordx4 v244, s[64:67], s33 offen offset:0 lds
    buffer_load_dwordx4 v245, s[64:67], s33 offen offset:1024 lds
    buffer_load_dwordx4 v246, s[64:67], s33 offen offset:2048 lds
    buffer_load_dwordx4 v247, s[64:67], s33 offen offset:3072 lds
    buffer_load_dword v22, v255, s[76:79], s58 offen sc1
    s_add_u32 m0, s96, 98304
    s_add_u32 s33, s98, 665600
    buffer_load_dwordx4 v244, s[64:67], s33 offen offset:0 lds
    buffer_load_dwordx4 v245, s[64:67], s33 offen offset:1024 lds
    buffer_load_dwordx4 v246, s[64:67], s33 offen offset:2048 lds
    buffer_load_dwordx4 v247, s[64:67], s33 offen offset:3072 lds
    s_waitcnt lgkmcnt(0)
    s_add_u32 m0, s47, 0
    s_add_u32 s33, s98, 670720
    buffer_load_dwordx4 v244, s[64:67], s33 offen offset:0 lds
    buffer_load_dwordx4 v245, s[64:67], s33 offen offset:1024 lds
    buffer_load_dwordx4 v246, s[64:67], s33 offen offset:2048 lds
    buffer_load_dwordx4 v247, s[64:67], s33 offen offset:3072 lds
    s_waitcnt vmcnt(8) lgkmcnt(0)
L1_poll:
    v_readfirstlane_b32 s53, v22
    s_sub_u32 s51, s51, 1
    s_cbranch_scc1 L1_ready
    s_cmp_ge_u32 s53, 8
    s_cbranch_scc1 L1_ready
    buffer_load_dword v22, v255, s[76:79], s58 offen sc1
    s_waitcnt vmcnt(0)
    s_branch L1_poll
L1_ready:
    s_add_u32 s55, s97, 28672
    buffer_load_dwordx4 v[176:179], v16, s[68:71], s55 offen offset:0 sc1
    buffer_load_dwordx4 v[180:183], v17, s[68:71], s55 offen offset:0 sc1
    buffer_load_dwordx4 v[184:187], v18, s[68:71], s55 offen offset:0 sc1
    buffer_load_dwordx4 v[188:191], v19, s[68:71], s55 offen offset:0 sc1
    buffer_load_dwordx4 v[192:195], v20, s[68:71], s55 offen offset:0 sc1
    buffer_load_dwordx4 v[196:199], v16, s[68:71], s55 offen offset:1024 sc1
    buffer_load_dwordx4 v[200:203], v17, s[68:71], s55 offen offset:1024 sc1
    buffer_load_dwordx4 v[204:207], v18, s[68:71], s55 offen offset:1024 sc1
    buffer_load_dwordx4 v[224:227], v19, s[68:71], s55 offen offset:1024 sc1
    buffer_load_dwordx4 v[228:231], v20, s[68:71], s55 offen offset:1024 sc1
    buffer_load_dwordx4 v[232:235], v16, s[68:71], s55 offen offset:2048 sc1
    buffer_load_dwordx4 v[236:239], v17, s[68:71], s55 offen offset:2048 sc1
    buffer_load_dwordx4 a[80:83], v18, s[68:71], s55 offen offset:2048 sc1
    buffer_load_dwordx4 a[84:87], v19, s[68:71], s55 offen offset:2048 sc1
    buffer_load_dwordx4 a[88:91], v20, s[68:71], s55 offen offset:2048 sc1
    buffer_load_dwordx4 a[92:95], v16, s[68:71], s55 offen offset:3072 sc1
    buffer_load_dwordx4 a[96:99], v17, s[68:71], s55 offen offset:3072 sc1
    buffer_load_dwordx4 a[100:103], v18, s[68:71], s55 offen offset:3072 sc1
    buffer_load_dwordx4 a[104:107], v19, s[68:71], s55 offen offset:3072 sc1
    buffer_load_dwordx4 a[108:111], v20, s[68:71], s55 offen offset:3072 sc1
    s_add_u32 s55, s44, 0
    buffer_load_dwordx4 a[112:115], v16, s[68:71], s55 offen offset:0 sc1
    buffer_load_dwordx4 a[116:119], v17, s[68:71], s55 offen offset:0 sc1
    buffer_load_dwordx4 a[120:123], v18, s[68:71], s55 offen offset:0 sc1
    buffer_load_dwordx4 a[124:127], v19, s[68:71], s55 offen offset:0 sc1
    buffer_load_dwordx4 v[112:115], v20, s[68:71], s55 offen offset:0 sc1
    s_waitcnt vmcnt(15)
    v_mfma_f32_16x16x32_bf16 a[0:3], a[192:195], v[176:179], 0
    buffer_load_dwordx4 v[132:135], v16, s[68:71], s55 offen offset:1024 sc1
    v_mfma_f32_16x16x32_bf16 a[0:3], a[208:211], v[196:199], a[0:3]
    ds_read_b64_tr_b16 v[116:117], v38 offset:49152
    v_mfma_f32_16x16x32_bf16 a[4:7], a[208:211], v[200:203], 0
    ds_read_b64_tr_b16 v[118:119], v38 offset:51200
    v_mfma_f32_16x16x32_bf16 a[4:7], a[192:195], v[180:183], a[4:7]
    ds_read_b64_tr_b16 v[120:121], v39 offset:49152
    v_mfma_f32_16x16x32_bf16 a[8:11], a[192:195], v[184:187], 0
    buffer_load_dwordx4 v[136:139], v17, s[68:71], s55 offen offset:1024 sc1
    v_mfma_f32_16x16x32_bf16 a[8:11], a[208:211], v[204:207], a[8:11]
    ds_read_b64_tr_b16 v[122:123], v39 offset:51200
    v_mfma_f32_16x16x32_bf16 a[12:15], a[208:211], v[224:227], 0
    ds_read_b64_tr_b16 v[124:125], v40 offset:49152
    v_mfma_f32_16x16x32_bf16 a[12:15], a[192:195], v[188:191], a[12:15]
    ds_read_b64_tr_b16 v[126:127], v40 offset:51200
    v_mfma_f32_16x16x32_bf16 a[16:19], a[192:195], v[192:195], 0
    buffer_load_dwordx4 v[140:143], v18, s[68:71], s55 offen offset:1024 sc1
    v_mfma_f32_16x16x32_bf16 a[16:19], a[208:211], v[228:231], a[16:19]
    ds_read_b64_tr_b16 v[128:129], v41 offset:49152
    v_mfma_f32_16x16x32_bf16 a[36:39], a[212:215], v[228:231], 0
    ds_read_b64_tr_b16 v[130:131], v41 offset:51200
    v_mfma_f32_16x16x32_bf16 a[36:39], a[196:199], v[192:195], a[36:39]
    v_mfma_f32_16x16x32_bf16 a[32:35], a[196:199], v[188:191], 0
    buffer_load_dwordx4 v[208:211], v19, s[68:71], s55 offen offset:1024 sc1
    v_mfma_f32_16x16x32_bf16 a[32:35], a[212:215], v[224:227], a[32:35]
    v_mfma_f32_16x16x32_bf16 a[28:31], a[212:215], v[204:207], 0
    v_mfma_f32_16x16x32_bf16 a[28:31], a[196:199], v[184:187], a[28:31]
    v_mfma_f32_16x16x32_bf16 a[24:27], a[196:199], v[180:183], 0
    buffer_load_dwordx4 v[212:215], v20, s[68:71], s55 offen offset:1024 sc1
    v_mfma_f32_16x16x32_bf16 a[24:27], a[212:215], v[200:203], a[24:27]
    v_mfma_f32_16x16x32_bf16 a[20:23], a[212:215], v[196:199], 0
    v_mfma_f32_16x16x32_bf16 a[20:23], a[196:199], v[176:179], a[20:23]
    s_waitcnt lgkmcnt(0)
    v_mfma_f32_16x16x32_bf16 a[40:43], a[200:203], v[176:179], 0
    buffer_load_dwordx4 v[216:219], v16, s[68:71], s55 offen offset:2048 sc1
    v_mfma_f32_16x16x32_bf16 a[40:43], a[216:219], v[196:199], a[40:43]
    v_mfma_f32_16x16x32_bf16 a[44:47], a[216:219], v[200:203], 0
    buffer_load_dwordx4 v[220:223], v17, s[68:71], s55 offen offset:2048 sc1
    v_mfma_f32_16x16x32_bf16 a[44:47], a[200:203], v[180:183], a[44:47]
    v_mfma_f32_16x16x32_bf16 a[48:51], a[200:203], v[184:187], 0
    buffer_load_dwordx4 a[192:195], v18, s[68:71], s55 offen offset:2048 sc1
    v_mfma_f32_16x16x32_bf16 a[48:51], a[216:219], v[204:207], a[48:51]
    v_mfma_f32_16x16x32_bf16 a[52:55], a[216:219], v[224:227], 0
    buffer_load_dwordx4 a[196:199], v19, s[68:71], s55 offen offset:2048 sc1
    v_mfma_f32_16x16x32_bf16 a[52:55], a[200:203], v[188:191], a[52:55]
    v_mfma_f32_16x16x32_bf16 a[56:59], a[200:203], v[192:195], 0
    buffer_load_dwordx4 a[208:211], v20, s[68:71], s55 offen offset:2048 sc1
    v_mfma_f32_16x16x32_bf16 a[56:59], a[216:219], v[228:231], a[56:59]
    v_mfma_f32_16x16x32_bf16 a[76:79], a[220:223], v[228:231], 0
    s_add_u32 m0, s96, 114688
    s_add_u32 s33, s98, 819200
    buffer_load_dwordx4 v244, s[64:67], s33 offen offset:0 lds
    v_mfma_f32_16x16x32_bf16 a[76:79], a[204:207], v[192:195], a[76:79]
    v_mfma_f32_16x16x32_bf16 a[72:75], a[204:207], v[188:191], 0
    buffer_load_dwordx4 v245, s[64:67], s33 offen offset:1024 lds
    v_mfma_f32_16x16x32_bf16 a[72:75], a[220:223], v[224:227], a[72:75]
    v_mfma_f32_16x16x32_bf16 a[68:71], a[220:223], v[204:207], 0
    buffer_load_dwordx4 v246, s[64:67], s33 offen offset:2048 lds
    v_mfma_f32_16x16x32_bf16 a[68:71], a[204:207], v[184:187], a[68:71]
    v_mfma_f32_16x16x32_bf16 a[64:67], a[204:207], v[180:183], 0
    buffer_load_dwordx4 v247, s[64:67], s33 offen offset:3072 lds
    v_mfma_f32_16x16x32_bf16 a[64:67], a[220:223], v[200:203], a[64:67]
    v_mfma_f32_16x16x32_bf16 a[60:63], a[220:223], v[196:199], 0
    v_mfma_f32_16x16x32_bf16 a[60:63], a[204:207], v[176:179], a[60:63]
    s_waitcnt vmcnt(19)
    v_mfma_f32_16x16x32_bf16 a[0:3], a[224:227], v[232:235], a[0:3]
    buffer_load_dwordx4 a[220:223], v16, s[68:71], s55 offen offset:3072 sc1
    v_mfma_f32_16x16x32_bf16 a[0:3], a[240:243], a[92:95], a[0:3]
    ds_read_b64_tr_b16 a[212:213], v38 offset:0
    v_mfma_f32_16x16x32_bf16 a[4:7], a[240:243], a[96:99], a[4:7]
    ds_read_b64_tr_b16 a[214:215], v38 offset:2048
    v_mfma_f32_16x16x32_bf16 a[4:7], a[224:227], v[236:239], a[4:7]
    ds_read_b64_tr_b16 a[200:201], v39 offset:0
    v_mfma_f32_16x16x32_bf16 a[8:11], a[224:227], a[80:83], a[8:11]
    buffer_load_dwordx4 v[176:179], v17, s[68:71], s55 offen offset:3072 sc1
    v_mfma_f32_16x16x32_bf16 a[8:11], a[240:243], a[100:103], a[8:11]
    ds_read_b64_tr_b16 a[202:203], v39 offset:2048
    v_mfma_f32_16x16x32_bf16 a[12:15], a[240:243], a[104:107], a[12:15]
    ds_read_b64_tr_b16 a[204:205], v40 offset:0
    v_mfma_f32_16x16x32_bf16 a[12:15], a[224:227], a[84:87], a[12:15]
    ds_read_b64_tr_b16 a[206:207], v40 offset:2048
    v_mfma_f32_16x16x32_bf16 a[16:19], a[224:227], a[88:91], a[16:19]
    buffer_load_dwordx4 v[180:183], v18, s[68:71], s55 offen offset:3072 sc1
    v_mfma_f32_16x16x32_bf16 a[16:19], a[240:243], a[108:111], a[16:19]
    ds_read_b64_tr_b16 a[216:217], v41 offset:0
    v_mfma_f32_16x16x32_bf16 a[36:39], a[244:247], a[108:111], a[36:39]
    ds_read_b64_tr_b16 a[218:219], v41 offset:2048
    v_mfma_f32_16x16x32_bf16 a[36:39], a[228:231], a[88:91], a[36:39]
    v_mfma_f32_16x16x32_bf16 a[32:35], a[228:231], a[84:87], a[32:35]
    buffer_load_dwordx4 v[184:187], v19, s[68:71], s55 offen offset:3072 sc1
    v_mfma_f32_16x16x32_bf16 a[32:35], a[244:247], a[104:107], a[32:35]
    v_mfma_f32_16x16x32_bf16 a[28:31], a[244:247], a[100:103], a[28:31]
    v_mfma_f32_16x16x32_bf16 a[28:31], a[228:231], a[80:83], a[28:31]
    v_mfma_f32_16x16x32_bf16 a[24:27], a[228:231], v[236:239], a[24:27]
    buffer_load_dwordx4 v[188:191], v20, s[68:71], s55 offen offset:3072 sc1
    v_mfma_f32_16x16x32_bf16 a[24:27], a[244:247], a[96:99], a[24:27]
    v_mfma_f32_16x16x32_bf16 a[20:23], a[244:247], a[92:95], a[20:23]
    v_mfma_f32_16x16x32_bf16 a[20:23], a[228:231], v[232:235], a[20:23]
    s_waitcnt lgkmcnt(0)
    v_mfma_f32_16x16x32_bf16 a[40:43], a[232:235], v[232:235], a[40:43]
    s_add_u32 s55, s44, 4096
    buffer_load_dwordx4 v[224:227], v16, s[68:71], s55 offen offset:0 sc1
    v_mfma_f32_16x16x32_bf16 a[40:43], a[248:251], a[92:95], a[40:43]
    ds_read_b64_tr_b16 v[192:193], v42 offset:4096
    v_mfma_f32_16x16x32_bf16 a[44:47], a[248:251], a[96:99], a[44:47]
    ds_read_b64_tr_b16 v[194:195], v42 offset:6144
    v_mfma_f32_16x16x32_bf16 a[44:47], a[232:235], v[236:239], a[44:47]
    ds_read_b64_tr_b16 v[196:197], v43 offset:4096
    v_mfma_f32_16x16x32_bf16 a[48:51], a[232:235], a[80:83], a[48:51]
    buffer_load_dwordx4 v[228:231], v17, s[68:71], s55 offen offset:0 sc1
    v_mfma_f32_16x16x32_bf16 a[48:51], a[248:251], a[100:103], a[48:51]
    ds_read_b64_tr_b16 v[198:199], v43 offset:6144
    v_mfma_f32_16x16x32_bf16 a[52:55], a[248:251], a[104:107], a[52:55]
    ds_read_b64_tr_b16 v[200:201], v44 offset:4096
    v_mfma_f32_16x16x32_bf16 a[52:55], a[232:235], a[84:87], a[52:55]
    ds_read_b64_tr_b16 v[202:203], v44 offset:6144
    v_mfma_f32_16x16x32_bf16 a[56:59], a[232:235], a[88:91], a[56:59]
    buffer_load_dwordx4 a[224:227], v18, s[68:71], s55 offen offset:0 sc1
    v_mfma_f32_16x16x32_bf16 a[56:59], a[248:251], a[108:111], a[56:59]
    ds_read_b64_tr_b16 v[204:205], v45 offset:4096
    v_mfma_f32_16x16x32_bf16 a[76:79], a[252:255], a[108:111], a[76:79]
    ds_read_b64_tr_b16 v[206:207], v45 offset:6144
    v_mfma_f32_16x16x32_bf16 a[76:79], a[236:239], a[88:91], a[76:79]
    v_mfma_f32_16x16x32_bf16 a[72:75], a[236:239], a[84:87], a[72:75]
    buffer_load_dwordx4 a[228:231], v19, s[68:71], s55 offen offset:0 sc1
    v_mfma_f32_16x16x32_bf16 a[72:75], a[252:255], a[104:107], a[72:75]
    v_mfma_f32_16x16x32_bf16 a[68:71], a[252:255], a[100:103], a[68:71]
    v_mfma_f32_16x16x32_bf16 a[68:71], a[236:239], a[80:83], a[68:71]
    v_mfma_f32_16x16x32_bf16 a[64:67], a[236:239], v[236:239], a[64:67]
    buffer_load_dwordx4 a[240:243], v20, s[68:71], s55 offen offset:0 sc1
    v_mfma_f32_16x16x32_bf16 a[64:67], a[252:255], a[96:99], a[64:67]
    v_mfma_f32_16x16x32_bf16 a[60:63], a[252:255], a[92:95], a[60:63]
    v_mfma_f32_16x16x32_bf16 a[60:63], a[236:239], v[232:235], a[60:63]
    s_waitcnt lgkmcnt(0)
    s_waitcnt vmcnt(19)
    v_mfma_f32_16x16x32_bf16 a[0:3], v[48:51], a[112:115], a[0:3]
    buffer_load_dwordx4 a[252:255], v16, s[68:71], s55 offen offset:1024 sc1
    v_mfma_f32_16x16x32_bf16 a[0:3], v[64:67], v[132:135], a[0:3]
    ds_read_b64_tr_b16 a[244:245], v34 offset:32768
    v_mfma_f32_16x16x32_bf16 a[4:7], v[64:67], v[136:139], a[4:7]
    buffer_load_dwordx4 v[232:235], v17, s[68:71], s55 offen offset:1024 sc1
    v_mfma_f32_16x16x32_bf16 a[4:7], v[48:51], a[116:119], a[4:7]
    ds_read_b64_tr_b16 a[246:247], v34 offset:34816
    v_mfma_f32_16x16x32_bf16 a[8:11], v[48:51], a[120:123], a[8:11]
    buffer_load_dwordx4 v[236:239], v18, s[68:71], s55 offen offset:1024 sc1
    v_mfma_f32_16x16x32_bf16 a[8:11], v[64:67], v[140:143], a[8:11]
    ds_read_b64_tr_b16 a[232:233], v35 offset:32768
    v_mfma_f32_16x16x32_bf16 a[12:15], v[64:67], v[208:211], a[12:15]
    buffer_load_dwordx4 a[80:83], v19, s[68:71], s55 offen offset:1024 sc1
    v_mfma_f32_16x16x32_bf16 a[12:15], v[48:51], a[124:127], a[12:15]
    ds_read_b64_tr_b16 a[234:235], v35 offset:34816
    v_mfma_f32_16x16x32_bf16 a[16:19], v[48:51], v[112:115], a[16:19]
    buffer_load_dwordx4 a[84:87], v20, s[68:71], s55 offen offset:1024 sc1
    v_mfma_f32_16x16x32_bf16 a[16:19], v[64:67], v[212:215], a[16:19]
    ds_read_b64_tr_b16 a[236:237], v36 offset:32768
    v_mfma_f32_16x16x32_bf16 a[36:39], v[68:71], v[212:215], a[36:39]
    s_add_u32 m0, s96, 65536
    s_add_u32 s33, s98, 824320
    buffer_load_dwordx4 v244, s[64:67], s33 offen offset:0 lds
    v_mfma_f32_16x16x32_bf16 a[36:39], v[52:55], v[112:115], a[36:39]
    ds_read_b64_tr_b16 a[238:239], v36 offset:34816
    v_mfma_f32_16x16x32_bf16 a[32:35], v[52:55], a[124:127], a[32:35]
    buffer_load_dwordx4 v245, s[64:67], s33 offen offset:1024 lds
    v_mfma_f32_16x16x32_bf16 a[32:35], v[68:71], v[208:211], a[32:35]
    ds_read_b64_tr_b16 a[248:249], v37 offset:32768
    v_mfma_f32_16x16x32_bf16 a[28:31], v[68:71], v[140:143], a[28:31]
    buffer_load_dwordx4 v246, s[64:67], s33 offen offset:2048 lds
    v_mfma_f32_16x16x32_bf16 a[28:31], v[52:55], a[120:123], a[28:31]
    ds_read_b64_tr_b16 a[250:251], v37 offset:34816
    v_mfma_f32_16x16x32_bf16 a[24:27], v[52:55], a[116:119], a[24:27]
    buffer_load_dwordx4 v247, s[64:67], s33 offen offset:3072 lds
    v_mfma_f32_16x16x32_bf16 a[24:27], v[68:71], v[136:139], a[24:27]
    v_mfma_f32_16x16x32_bf16 a[20:23], v[68:71], v[132:135], a[20:23]
    v_mfma_f32_16x16x32_bf16 a[20:23], v[52:55], a[112:115], a[20:23]
    s_waitcnt lgkmcnt(0)
    v_mfma_f32_16x16x32_bf16 a[40:43], v[56:59], a[112:115], a[40:43]
    buffer_load_dwordx4 a[104:107], v16, s[68:71], s55 offen offset:2048 sc1
    v_mfma_f32_16x16x32_bf16 a[40:43], v[72:75], v[132:135], a[40:43]
    ds_read_b64_tr_b16 a[88:89], v34 offset:0
    v_mfma_f32_16x16x32_bf16 a[44:47], v[72:75], v[136:139], a[44:47]
    ds_read_b64_tr_b16 a[90:91], v34 offset:2048
    v_mfma_f32_16x16x32_bf16 a[44:47], v[56:59], a[116:119], a[44:47]
    ds_read_b64_tr_b16 a[92:93], v35 offset:0
    v_mfma_f32_16x16x32_bf16 a[48:51], v[56:59], a[120:123], a[48:51]
    buffer_load_dwordx4 a[108:111], v17, s[68:71], s55 offen offset:2048 sc1
    v_mfma_f32_16x16x32_bf16 a[48:51], v[72:75], v[140:143], a[48:51]
    ds_read_b64_tr_b16 a[94:95], v35 offset:2048
    v_mfma_f32_16x16x32_bf16 a[52:55], v[72:75], v[208:211], a[52:55]
    ds_read_b64_tr_b16 a[96:97], v36 offset:0
    v_mfma_f32_16x16x32_bf16 a[52:55], v[56:59], a[124:127], a[52:55]
    ds_read_b64_tr_b16 a[98:99], v36 offset:2048
    v_mfma_f32_16x16x32_bf16 a[56:59], v[56:59], v[112:115], a[56:59]
    buffer_load_dwordx4 v[48:51], v18, s[68:71], s55 offen offset:2048 sc1
    v_mfma_f32_16x16x32_bf16 a[56:59], v[72:75], v[212:215], a[56:59]
    ds_read_b64_tr_b16 a[100:101], v37 offset:0
    v_mfma_f32_16x16x32_bf16 a[76:79], v[76:79], v[212:215], a[76:79]
    ds_read_b64_tr_b16 a[102:103], v37 offset:2048
    v_mfma_f32_16x16x32_bf16 a[76:79], v[60:63], v[112:115], a[76:79]
    v_mfma_f32_16x16x32_bf16 a[72:75], v[60:63], a[124:127], a[72:75]
    buffer_load_dwordx4 v[52:55], v19, s[68:71], s55 offen offset:2048 sc1
    v_mfma_f32_16x16x32_bf16 a[72:75], v[76:79], v[208:211], a[72:75]
    v_mfma_f32_16x16x32_bf16 a[68:71], v[76:79], v[140:143], a[68:71]
    v_mfma_f32_16x16x32_bf16 a[68:71], v[60:63], a[120:123], a[68:71]
    v_mfma_f32_16x16x32_bf16 a[64:67], v[60:63], a[116:119], a[64:67]
    buffer_load_dwordx4 v[64:67], v20, s[68:71], s55 offen offset:2048 sc1
    v_mfma_f32_16x16x32_bf16 a[64:67], v[76:79], v[136:139], a[64:67]
    v_mfma_f32_16x16x32_bf16 a[60:63], v[76:79], v[132:135], a[60:63]
    v_mfma_f32_16x16x32_bf16 a[60:63], v[60:63], a[112:115], a[60:63]
    s_waitcnt lgkmcnt(0)
    s_waitcnt vmcnt(19)
    v_mfma_f32_16x16x32_bf16 a[0:3], v[80:83], v[216:219], a[0:3]
    buffer_load_dwordx4 v[76:79], v16, s[68:71], s55 offen offset:3072 sc1
    v_mfma_f32_16x16x32_bf16 a[0:3], v[96:99], a[220:223], a[0:3]
    ds_read_b64_tr_b16 v[68:69], v38 offset:16384
    v_mfma_f32_16x16x32_bf16 a[4:7], v[96:99], v[176:179], a[4:7]
    ds_read_b64_tr_b16 v[70:71], v38 offset:18432
    v_mfma_f32_16x16x32_bf16 a[4:7], v[80:83], v[220:223], a[4:7]
    ds_read_b64_tr_b16 v[56:57], v39 offset:16384
    v_mfma_f32_16x16x32_bf16 a[8:11], v[80:83], a[192:195], a[8:11]
    buffer_load_dwordx4 a[112:115], v17, s[68:71], s55 offen offset:3072 sc1
    v_mfma_f32_16x16x32_bf16 a[8:11], v[96:99], v[180:183], a[8:11]
    ds_read_b64_tr_b16 v[58:59], v39 offset:18432
    v_mfma_f32_16x16x32_bf16 a[12:15], v[96:99], v[184:187], a[12:15]
    ds_read_b64_tr_b16 v[60:61], v40 offset:16384
    v_mfma_f32_16x16x32_bf16 a[12:15], v[80:83], a[196:199], a[12:15]
    ds_read_b64_tr_b16 v[62:63], v40 offset:18432
    v_mfma_f32_16x16x32_bf16 a[16:19], v[80:83], a[208:211], a[16:19]
    buffer_load_dwordx4 a[116:119], v18, s[68:71], s55 offen offset:3072 sc1
    v_mfma_f32_16x16x32_bf16 a[16:19], v[96:99], v[188:191], a[16:19]
    ds_read_b64_tr_b16 v[72:73], v41 offset:16384
    v_mfma_f32_16x16x32_bf16 a[36:39], v[100:103], v[188:191], a[36:39]
    ds_read_b64_tr_b16 v[74:75], v41 offset:18432
    v_mfma_f32_16x16x32_bf16 a[36:39], v[84:87], a[208:211], a[36:39]
    v_mfma_f32_16x16x32_bf16 a[32:35], v[84:87], a[196:199], a[32:35]
    buffer_load_dwordx4 a[120:123], v19, s[68:71], s55 offen offset:3072 sc1
    v_mfma_f32_16x16x32_bf16 a[32:35], v[100:103], v[184:187], a[32:35]
    v_mfma_f32_16x16x32_bf16 a[28:31], v[100:103], v[180:183], a[28:31]
    v_mfma_f32_16x16x32_bf16 a[28:31], v[84:87], a[192:195], a[28:31]
    v_mfma_f32_16x16x32_bf16 a[24:27], v[84:87], v[220:223], a[24:27]
    buffer_load_dwordx4 a[124:127], v20, s[68:71], s55 offen offset:3072 sc1
    v_mfma_f32_16x16x32_bf16 a[24:27], v[100:103], v[176:179], a[24:27]
    v_mfma_f32_16x16x32_bf16 a[20:23], v[100:103], a[220:223], a[20:23]
    v_mfma_f32_16x16x32_bf16 a[20:23], v[84:87], v[216:219], a[20:23]
    s_waitcnt lgkmcnt(0)
    v_mfma_f32_16x16x32_bf16 a[40:43], v[88:91], v[216:219], a[40:43]
    s_add_u32 s55, s44, 8192
    buffer_load_dwordx4 v[208:211], v16, s[68:71], s55 offen offset:0 sc1
    v_mfma_f32_16x16x32_bf16 a[40:43], v[104:107], a[220:223], a[40:43]
    ds_read_b64_tr_b16 v[112:113], v34 offset:16384
    v_mfma_f32_16x16x32_bf16 a[44:47], v[104:107], v[176:179], a[44:47]
    buffer_load_dwordx4 v[212:215], v17, s[68:71], s55 offen offset:0 sc1
    v_mfma_f32_16x16x32_bf16 a[44:47], v[88:91], v[220:223], a[44:47]
    ds_read_b64_tr_b16 v[114:115], v34 offset:18432
    v_mfma_f32_16x16x32_bf16 a[48:51], v[88:91], a[192:195], a[48:51]
    buffer_load_dwordx4 v[80:83], v18, s[68:71], s55 offen offset:0 sc1
    v_mfma_f32_16x16x32_bf16 a[48:51], v[104:107], v[180:183], a[48:51]
    ds_read_b64_tr_b16 v[132:133], v35 offset:16384
    v_mfma_f32_16x16x32_bf16 a[52:55], v[104:107], v[184:187], a[52:55]
    buffer_load_dwordx4 v[84:87], v19, s[68:71], s55 offen offset:0 sc1
    v_mfma_f32_16x16x32_bf16 a[52:55], v[88:91], a[196:199], a[52:55]
    ds_read_b64_tr_b16 v[134:135], v35 offset:18432
    v_mfma_f32_16x16x32_bf16 a[56:59], v[88:91], a[208:211], a[56:59]
    buffer_load_dwordx4 v[96:99], v20, s[68:71], s55 offen offset:0 sc1
    v_mfma_f32_16x16x32_bf16 a[56:59], v[104:107], v[188:191], a[56:59]
    ds_read_b64_tr_b16 v[136:137], v36 offset:16384
    v_mfma_f32_16x16x32_bf16 a[76:79], v[108:111], v[188:191], a[76:79]
    s_add_u32 m0, s47, 4096
    s_add_u32 s33, s98, 829440
    buffer_load_dwordx4 v244, s[64:67], s33 offen offset:0 lds
    v_mfma_f32_16x16x32_bf16 a[76:79], v[92:95], a[208:211], a[76:79]
    ds_read_b64_tr_b16 v[138:139], v36 offset:18432
    v_mfma_f32_16x16x32_bf16 a[72:75], v[92:95], a[196:199], a[72:75]
    buffer_load_dwordx4 v245, s[64:67], s33 offen offset:1024 lds
    v_mfma_f32_16x16x32_bf16 a[72:75], v[108:111], v[184:187], a[72:75]
    ds_read_b64_tr_b16 v[140:141], v37 offset:16384
    v_mfma_f32_16x16x32_bf16 a[68:71], v[108:111], v[180:183], a[68:71]
    buffer_load_dwordx4 v246, s[64:67], s33 offen offset:2048 lds
    v_mfma_f32_16x16x32_bf16 a[68:71], v[92:95], a[192:195], a[68:71]
    ds_read_b64_tr_b16 v[142:143], v37 offset:18432
    v_mfma_f32_16x16x32_bf16 a[64:67], v[92:95], v[220:223], a[64:67]
    buffer_load_dwordx4 v247, s[64:67], s33 offen offset:3072 lds
    v_mfma_f32_16x16x32_bf16 a[64:67], v[108:111], v[176:179], a[64:67]
    v_mfma_f32_16x16x32_bf16 a[60:63], v[108:111], a[220:223], a[60:63]
    v_mfma_f32_16x16x32_bf16 a[60:63], v[92:95], v[216:219], a[60:63]
    s_waitcnt lgkmcnt(0)
    s_waitcnt vmcnt(23)
    v_mfma_f32_16x16x32_bf16 a[0:3], a[128:131], v[224:227], a[0:3]
    buffer_load_dwordx4 v[108:111], v16, s[68:71], s55 offen offset:1024 sc1
    v_mfma_f32_16x16x32_bf16 a[0:3], a[144:147], a[252:255], a[0:3]
    ds_read_b64_tr_b16 v[100:101], v34 offset:49152
    v_mfma_f32_16x16x32_bf16 a[4:7], a[144:147], v[232:235], a[4:7]
    ds_read_b64_tr_b16 v[102:103], v34 offset:51200
    v_mfma_f32_16x16x32_bf16 a[4:7], a[128:131], v[228:231], a[4:7]
    ds_read_b64_tr_b16 v[88:89], v35 offset:49152
    v_mfma_f32_16x16x32_bf16 a[8:11], a[128:131], a[224:227], a[8:11]
    buffer_load_dwordx4 v[216:219], v17, s[68:71], s55 offen offset:1024 sc1
    v_mfma_f32_16x16x32_bf16 a[8:11], a[144:147], v[236:239], a[8:11]
    ds_read_b64_tr_b16 v[90:91], v35 offset:51200
    v_mfma_f32_16x16x32_bf16 a[12:15], a[144:147], a[80:83], a[12:15]
    ds_read_b64_tr_b16 v[92:93], v36 offset:49152
    v_mfma_f32_16x16x32_bf16 a[12:15], a[128:131], a[228:231], a[12:15]
    ds_read_b64_tr_b16 v[94:95], v36 offset:51200
    v_mfma_f32_16x16x32_bf16 a[16:19], a[128:131], a[240:243], a[16:19]
    buffer_load_dwordx4 v[220:223], v18, s[68:71], s55 offen offset:1024 sc1
    v_mfma_f32_16x16x32_bf16 a[16:19], a[144:147], a[84:87], a[16:19]
    ds_read_b64_tr_b16 v[104:105], v37 offset:49152
    v_mfma_f32_16x16x32_bf16 a[36:39], a[148:151], a[84:87], a[36:39]
    ds_read_b64_tr_b16 v[106:107], v37 offset:51200
    v_mfma_f32_16x16x32_bf16 a[36:39], a[132:135], a[240:243], a[36:39]
    v_mfma_f32_16x16x32_bf16 a[32:35], a[132:135], a[228:231], a[32:35]
    buffer_load_dwordx4 a[192:195], v19, s[68:71], s55 offen offset:1024 sc1
    v_mfma_f32_16x16x32_bf16 a[32:35], a[148:151], a[80:83], a[32:35]
    v_mfma_f32_16x16x32_bf16 a[28:31], a[148:151], v[236:239], a[28:31]
    v_mfma_f32_16x16x32_bf16 a[28:31], a[132:135], a[224:227], a[28:31]
    v_mfma_f32_16x16x32_bf16 a[24:27], a[132:135], v[228:231], a[24:27]
    buffer_load_dwordx4 a[196:199], v20, s[68:71], s55 offen offset:1024 sc1
    v_mfma_f32_16x16x32_bf16 a[24:27], a[148:151], v[232:235], a[24:27]
    v_mfma_f32_16x16x32_bf16 a[20:23], a[148:151], a[252:255], a[20:23]
    v_mfma_f32_16x16x32_bf16 a[20:23], a[132:135], v[224:227], a[20:23]
    s_waitcnt lgkmcnt(0)
    v_mfma_f32_16x16x32_bf16 a[40:43], a[136:139], v[224:227], a[40:43]
    buffer_load_dwordx4 v[184:187], v16, s[68:71], s55 offen offset:2048 sc1
    v_mfma_f32_16x16x32_bf16 a[40:43], a[152:155], a[252:255], a[40:43]
    ds_read_b64_tr_b16 a[208:209], v38 offset:32768
    v_mfma_f32_16x16x32_bf16 a[44:47], a[152:155], v[232:235], a[44:47]
    ds_read_b64_tr_b16 a[210:211], v38 offset:34816
    v_mfma_f32_16x16x32_bf16 a[44:47], a[136:139], v[228:231], a[44:47]
    ds_read_b64_tr_b16 a[220:221], v39 offset:32768
    v_mfma_f32_16x16x32_bf16 a[48:51], a[136:139], a[224:227], a[48:51]
    buffer_load_dwordx4 v[188:191], v17, s[68:71], s55 offen offset:2048 sc1
    v_mfma_f32_16x16x32_bf16 a[48:51], a[152:155], v[236:239], a[48:51]
    ds_read_b64_tr_b16 a[222:223], v39 offset:34816
    v_mfma_f32_16x16x32_bf16 a[52:55], a[152:155], a[80:83], a[52:55]
    ds_read_b64_tr_b16 v[176:177], v40 offset:32768
    v_mfma_f32_16x16x32_bf16 a[52:55], a[136:139], a[228:231], a[52:55]
    ds_read_b64_tr_b16 v[178:179], v40 offset:34816
    v_mfma_f32_16x16x32_bf16 a[56:59], a[136:139], a[240:243], a[56:59]
    buffer_load_dwordx4 a[128:131], v18, s[68:71], s55 offen offset:2048 sc1
    v_mfma_f32_16x16x32_bf16 a[56:59], a[152:155], a[84:87], a[56:59]
    ds_read_b64_tr_b16 v[180:181], v41 offset:32768
    v_mfma_f32_16x16x32_bf16 a[76:79], a[156:159], a[84:87], a[76:79]
    ds_read_b64_tr_b16 v[182:183], v41 offset:34816
    v_mfma_f32_16x16x32_bf16 a[76:79], a[140:143], a[240:243], a[76:79]
    v_mfma_f32_16x16x32_bf16 a[72:75], a[140:143], a[228:231], a[72:75]
    buffer_load_dwordx4 a[132:135], v19, s[68:71], s55 offen offset:2048 sc1
    v_mfma_f32_16x16x32_bf16 a[72:75], a[156:159], a[80:83], a[72:75]
    v_mfma_f32_16x16x32_bf16 a[68:71], a[156:159], v[236:239], a[68:71]
    v_mfma_f32_16x16x32_bf16 a[68:71], a[140:143], a[224:227], a[68:71]
    v_mfma_f32_16x16x32_bf16 a[64:67], a[140:143], v[228:231], a[64:67]
    buffer_load_dwordx4 a[144:147], v20, s[68:71], s55 offen offset:2048 sc1
    v_mfma_f32_16x16x32_bf16 a[64:67], a[156:159], v[232:235], a[64:67]
    v_mfma_f32_16x16x32_bf16 a[60:63], a[156:159], a[252:255], a[60:63]
    v_mfma_f32_16x16x32_bf16 a[60:63], a[140:143], v[224:227], a[60:63]
    s_waitcnt lgkmcnt(0)
    s_waitcnt vmcnt(19)
    v_mfma_f32_16x16x32_bf16 a[0:3], a[160:163], a[104:107], a[0:3]
    buffer_load_dwordx4 a[156:159], v16, s[68:71], s55 offen offset:3072 sc1
    v_mfma_f32_16x16x32_bf16 a[0:3], a[176:179], v[76:79], a[0:3]
    ds_read_b64_tr_b16 a[148:149], v42 offset:0
    v_mfma_f32_16x16x32_bf16 a[4:7], a[176:179], a[112:115], a[4:7]
    buffer_load_dwordx4 v[224:227], v17, s[68:71], s55 offen offset:3072 sc1
    v_mfma_f32_16x16x32_bf16 a[4:7], a[160:163], a[108:111], a[4:7]
    ds_read_b64_tr_b16 a[150:151], v42 offset:2048
    v_mfma_f32_16x16x32_bf16 a[8:11], a[160:163], v[48:51], a[8:11]
    buffer_load_dwordx4 v[228:231], v18, s[68:71], s55 offen offset:3072 sc1
    v_mfma_f32_16x16x32_bf16 a[8:11], a[176:179], a[116:119], a[8:11]
    ds_read_b64_tr_b16 a[136:137], v43 offset:0
    v_mfma_f32_16x16x32_bf16 a[12:15], a[176:179], a[120:123], a[12:15]
    buffer_load_dwordx4 a[224:227], v19, s[68:71], s55 offen offset:3072 sc1
    v_mfma_f32_16x16x32_bf16 a[12:15], a[160:163], v[52:55], a[12:15]
    ds_read_b64_tr_b16 a[138:139], v43 offset:2048
    v_mfma_f32_16x16x32_bf16 a[16:19], a[160:163], v[64:67], a[16:19]
    buffer_load_dwordx4 a[228:231], v20, s[68:71], s55 offen offset:3072 sc1
    v_mfma_f32_16x16x32_bf16 a[16:19], a[176:179], a[124:127], a[16:19]
    ds_read_b64_tr_b16 a[140:141], v44 offset:0
    v_mfma_f32_16x16x32_bf16 a[36:39], a[180:183], a[124:127], a[36:39]
    s_add_u32 m0, s96, 32768
    s_add_u32 s33, s98, 834560
    buffer_load_dwordx4 v244, s[64:67], s33 offen offset:0 lds
    v_mfma_f32_16x16x32_bf16 a[36:39], a[164:167], v[64:67], a[36:39]
    ds_read_b64_tr_b16 a[142:143], v44 offset:2048
    v_mfma_f32_16x16x32_bf16 a[32:35], a[164:167], v[52:55], a[32:35]
    buffer_load_dwordx4 v245, s[64:67], s33 offen offset:1024 lds
    v_mfma_f32_16x16x32_bf16 a[32:35], a[180:183], a[120:123], a[32:35]
    ds_read_b64_tr_b16 a[152:153], v45 offset:0
    v_mfma_f32_16x16x32_bf16 a[28:31], a[180:183], a[116:119], a[28:31]
    buffer_load_dwordx4 v246, s[64:67], s33 offen offset:2048 lds
    v_mfma_f32_16x16x32_bf16 a[28:31], a[164:167], v[48:51], a[28:31]
    ds_read_b64_tr_b16 a[154:155], v45 offset:2048
    v_mfma_f32_16x16x32_bf16 a[24:27], a[164:167], a[108:111], a[24:27]
    buffer_load_dwordx4 v247, s[64:67], s33 offen offset:3072 lds
    v_mfma_f32_16x16x32_bf16 a[24:27], a[180:183], a[112:115], a[24:27]
    v_mfma_f32_16x16x32_bf16 a[20:23], a[180:183], v[76:79], a[20:23]
    v_mfma_f32_16x16x32_bf16 a[20:23], a[164:167], a[104:107], a[20:23]
    s_waitcnt lgkmcnt(0)
    v_mfma_f32_16x16x32_bf16 a[40:43], a[168:171], a[104:107], a[40:43]
    s_add_u32 s55, s44, 12288
    buffer_load_dwordx4 a[80:83], v16, s[68:71], s55 offen offset:0 sc1
    v_mfma_f32_16x16x32_bf16 a[40:43], a[184:187], v[76:79], a[40:43]
    ds_read_b64_tr_b16 a[240:241], v38 offset:49152
    v_mfma_f32_16x16x32_bf16 a[44:47], a[184:187], a[112:115], a[44:47]
    ds_read_b64_tr_b16 a[242:243], v38 offset:51200
    v_mfma_f32_16x16x32_bf16 a[44:47], a[168:171], a[108:111], a[44:47]
    ds_read_b64_tr_b16 a[252:253], v39 offset:49152
    v_mfma_f32_16x16x32_bf16 a[48:51], a[168:171], v[48:51], a[48:51]
    buffer_load_dwordx4 a[84:87], v17, s[68:71], s55 offen offset:0 sc1
    v_mfma_f32_16x16x32_bf16 a[48:51], a[184:187], a[116:119], a[48:51]
    ds_read_b64_tr_b16 a[254:255], v39 offset:51200
    v_mfma_f32_16x16x32_bf16 a[52:55], a[184:187], a[120:123], a[52:55]
    ds_read_b64_tr_b16 v[232:233], v40 offset:49152
    v_mfma_f32_16x16x32_bf16 a[52:55], a[168:171], v[52:55], a[52:55]
    ds_read_b64_tr_b16 v[234:235], v40 offset:51200
    v_mfma_f32_16x16x32_bf16 a[56:59], a[168:171], v[64:67], a[56:59]
    buffer_load_dwordx4 a[160:163], v18, s[68:71], s55 offen offset:0 sc1
    v_mfma_f32_16x16x32_bf16 a[56:59], a[184:187], a[124:127], a[56:59]
    ds_read_b64_tr_b16 v[236:237], v41 offset:49152
    v_mfma_f32_16x16x32_bf16 a[76:79], a[188:191], a[124:127], a[76:79]
    ds_read_b64_tr_b16 v[238:239], v41 offset:51200
    v_mfma_f32_16x16x32_bf16 a[76:79], a[172:175], v[64:67], a[76:79]
    v_mfma_f32_16x16x32_bf16 a[72:75], a[172:175], v[52:55], a[72:75]
    buffer_load_dwordx4 a[164:167], v19, s[68:71], s55 offen offset:0 sc1
    v_mfma_f32_16x16x32_bf16 a[72:75], a[188:191], a[120:123], a[72:75]
    v_mfma_f32_16x16x32_bf16 a[68:71], a[188:191], a[116:119], a[68:71]
    v_mfma_f32_16x16x32_bf16 a[68:71], a[172:175], v[48:51], a[68:71]
    v_mfma_f32_16x16x32_bf16 a[64:67], a[172:175], a[108:111], a[64:67]
    buffer_load_dwordx4 a[176:179], v20, s[68:71], s55 offen offset:0 sc1
    v_mfma_f32_16x16x32_bf16 a[64:67], a[188:191], a[112:115], a[64:67]
    v_mfma_f32_16x16x32_bf16 a[60:63], a[188:191], v[76:79], a[60:63]
    v_mfma_f32_16x16x32_bf16 a[60:63], a[172:175], a[104:107], a[60:63]
    s_waitcnt lgkmcnt(0)
    s_waitcnt vmcnt(19)
    v_mfma_f32_16x16x32_bf16 a[0:3], v[144:147], v[208:211], a[0:3]
    buffer_load_dwordx4 a[188:191], v16, s[68:71], s55 offen offset:1024 sc1
    v_mfma_f32_16x16x32_bf16 a[0:3], v[160:163], v[108:111], a[0:3]
    ds_read_b64_tr_b16 a[180:181], v38 offset:0
    v_mfma_f32_16x16x32_bf16 a[4:7], v[160:163], v[216:219], a[4:7]
    ds_read_b64_tr_b16 a[182:183], v38 offset:2048
    v_mfma_f32_16x16x32_bf16 a[4:7], v[144:147], v[212:215], a[4:7]
    ds_read_b64_tr_b16 a[168:169], v39 offset:0
    v_mfma_f32_16x16x32_bf16 a[8:11], v[144:147], v[80:83], a[8:11]
    buffer_load_dwordx4 a[104:107], v17, s[68:71], s55 offen offset:1024 sc1
    v_mfma_f32_16x16x32_bf16 a[8:11], v[160:163], v[220:223], a[8:11]
    ds_read_b64_tr_b16 a[170:171], v39 offset:2048
    v_mfma_f32_16x16x32_bf16 a[12:15], v[160:163], a[192:195], a[12:15]
    ds_read_b64_tr_b16 a[172:173], v40 offset:0
    v_mfma_f32_16x16x32_bf16 a[12:15], v[144:147], v[84:87], a[12:15]
    ds_read_b64_tr_b16 a[174:175], v40 offset:2048
    v_mfma_f32_16x16x32_bf16 a[16:19], v[144:147], v[96:99], a[16:19]
    buffer_load_dwordx4 a[108:111], v18, s[68:71], s55 offen offset:1024 sc1
    v_mfma_f32_16x16x32_bf16 a[16:19], v[160:163], a[196:199], a[16:19]
    ds_read_b64_tr_b16 a[184:185], v41 offset:0
    v_mfma_f32_16x16x32_bf16 a[36:39], v[164:167], a[196:199], a[36:39]
    ds_read_b64_tr_b16 a[186:187], v41 offset:2048
    v_mfma_f32_16x16x32_bf16 a[36:39], v[148:151], v[96:99], a[36:39]
    v_mfma_f32_16x16x32_bf16 a[32:35], v[148:151], v[84:87], a[32:35]
    buffer_load_dwordx4 v[48:51], v19, s[68:71], s55 offen offset:1024 sc1
    v_mfma_f32_16x16x32_bf16 a[32:35], v[164:167], a[192:195], a[32:35]
    v_mfma_f32_16x16x32_bf16 a[28:31], v[164:167], v[220:223], a[28:31]
    v_mfma_f32_16x16x32_bf16 a[28:31], v[148:151], v[80:83], a[28:31]
    v_mfma_f32_16x16x32_bf16 a[24:27], v[148:151], v[212:215], a[24:27]
    buffer_load_dwordx4 v[52:55], v20, s[68:71], s55 offen offset:1024 sc1
    v_mfma_f32_16x16x32_bf16 a[24:27], v[164:167], v[216:219], a[24:27]
    v_mfma_f32_16x16x32_bf16 a[20:23], v[164:167], v[108:111], a[20:23]
    v_mfma_f32_16x16x32_bf16 a[20:23], v[148:151], v[208:211], a[20:23]
    s_waitcnt lgkmcnt(0)
    v_mfma_f32_16x16x32_bf16 a[40:43], v[152:155], v[208:211], a[40:43]
    buffer_load_dwordx4 a[120:123], v16, s[68:71], s55 offen offset:2048 sc1
    v_mfma_f32_16x16x32_bf16 a[40:43], v[168:171], v[108:111], a[40:43]
    ds_read_b64_tr_b16 v[64:65], v42 offset:4096
    v_mfma_f32_16x16x32_bf16 a[44:47], v[168:171], v[216:219], a[44:47]
    buffer_load_dwordx4 a[124:127], v17, s[68:71], s55 offen offset:2048 sc1
    v_mfma_f32_16x16x32_bf16 a[44:47], v[152:155], v[212:215], a[44:47]
    ds_read_b64_tr_b16 v[66:67], v42 offset:6144
    v_mfma_f32_16x16x32_bf16 a[48:51], v[152:155], v[80:83], a[48:51]
    buffer_load_dwordx4 v[144:147], v18, s[68:71], s55 offen offset:2048 sc1
    v_mfma_f32_16x16x32_bf16 a[48:51], v[168:171], v[220:223], a[48:51]
    ds_read_b64_tr_b16 v[76:77], v43 offset:4096
    v_mfma_f32_16x16x32_bf16 a[52:55], v[168:171], a[192:195], a[52:55]
    buffer_load_dwordx4 v[148:151], v19, s[68:71], s55 offen offset:2048 sc1
    v_mfma_f32_16x16x32_bf16 a[52:55], v[152:155], v[84:87], a[52:55]
    ds_read_b64_tr_b16 v[78:79], v43 offset:6144
    v_mfma_f32_16x16x32_bf16 a[56:59], v[152:155], v[96:99], a[56:59]
    buffer_load_dwordx4 v[160:163], v20, s[68:71], s55 offen offset:2048 sc1
    v_mfma_f32_16x16x32_bf16 a[56:59], v[168:171], a[196:199], a[56:59]
    ds_read_b64_tr_b16 a[112:113], v44 offset:4096
    v_mfma_f32_16x16x32_bf16 a[76:79], v[172:175], a[196:199], a[76:79]
    s_add_u32 m0, s96, 0
    s_add_u32 s33, s98, 983040
    buffer_load_dwordx4 v244, s[64:67], s33 offen offset:0 lds
    v_mfma_f32_16x16x32_bf16 a[76:79], v[156:159], v[96:99], a[76:79]
    ds_read_b64_tr_b16 a[114:115], v44 offset:6144
    v_mfma_f32_16x16x32_bf16 a[72:75], v[156:159], v[84:87], a[72:75]
    buffer_load_dwordx4 v245, s[64:67], s33 offen offset:1024 lds
    v_mfma_f32_16x16x32_bf16 a[72:75], v[172:175], a[192:195], a[72:75]
    ds_read_b64_tr_b16 a[116:117], v45 offset:4096
    v_mfma_f32_16x16x32_bf16 a[68:71], v[172:175], v[220:223], a[68:71]
    buffer_load_dwordx4 v246, s[64:67], s33 offen offset:2048 lds
    v_mfma_f32_16x16x32_bf16 a[68:71], v[156:159], v[80:83], a[68:71]
    ds_read_b64_tr_b16 a[118:119], v45 offset:6144
    v_mfma_f32_16x16x32_bf16 a[64:67], v[156:159], v[212:215], a[64:67]
    buffer_load_dwordx4 v247, s[64:67], s33 offen offset:3072 lds
    v_mfma_f32_16x16x32_bf16 a[64:67], v[172:175], v[216:219], a[64:67]
    v_mfma_f32_16x16x32_bf16 a[60:63], v[172:175], v[108:111], a[60:63]
    v_mfma_f32_16x16x32_bf16 a[60:63], v[156:159], v[208:211], a[60:63]
    s_waitcnt lgkmcnt(0)
    s_waitcnt vmcnt(23)
    v_mfma_f32_16x16x32_bf16 a[0:3], v[116:119], v[184:187], a[0:3]
    buffer_load_dwordx4 v[164:167], v16, s[68:71], s55 offen offset:3072 sc1
    v_mfma_f32_16x16x32_bf16 a[0:3], a[212:215], a[156:159], a[0:3]
    v_mfma_f32_16x16x32_bf16 a[4:7], a[212:215], v[224:227], a[4:7]
    v_mfma_f32_16x16x32_bf16 a[4:7], v[116:119], v[188:191], a[4:7]
    v_mfma_f32_16x16x32_bf16 a[8:11], v[116:119], a[128:131], a[8:11]
    buffer_load_dwordx4 v[152:155], v17, s[68:71], s55 offen offset:3072 sc1
    v_mfma_f32_16x16x32_bf16 a[8:11], a[212:215], v[228:231], a[8:11]
    v_mfma_f32_16x16x32_bf16 a[12:15], a[212:215], a[224:227], a[12:15]
    v_mfma_f32_16x16x32_bf16 a[12:15], v[116:119], a[132:135], a[12:15]
    v_mfma_f32_16x16x32_bf16 a[16:19], v[116:119], a[144:147], a[16:19]
    buffer_load_dwordx4 v[156:159], v18, s[68:71], s55 offen offset:3072 sc1
    v_mfma_f32_16x16x32_bf16 a[16:19], a[212:215], a[228:231], a[16:19]
    v_mfma_f32_16x16x32_bf16 a[36:39], a[200:203], a[228:231], a[36:39]
    v_mfma_f32_16x16x32_bf16 a[36:39], v[120:123], a[144:147], a[36:39]
    v_mfma_f32_16x16x32_bf16 a[32:35], v[120:123], a[132:135], a[32:35]
    buffer_load_dwordx4 v[168:171], v19, s[68:71], s55 offen offset:3072 sc1
    v_mfma_f32_16x16x32_bf16 a[32:35], a[200:203], a[224:227], a[32:35]
    v_mfma_f32_16x16x32_bf16 a[28:31], a[200:203], v[228:231], a[28:31]
    v_mfma_f32_16x16x32_bf16 a[28:31], v[120:123], a[128:131], a[28:31]
    v_mfma_f32_16x16x32_bf16 a[24:27], v[120:123], v[188:191], a[24:27]
    buffer_load_dwordx4 v[172:175], v20, s[68:71], s55 offen offset:3072 sc1
    v_mfma_f32_16x16x32_bf16 a[24:27], a[200:203], v[224:227], a[24:27]
    v_mfma_f32_16x16x32_bf16 a[20:23], a[200:203], a[156:159], a[20:23]
    v_mfma_f32_16x16x32_bf16 a[20:23], v[120:123], v[184:187], a[20:23]
    v_mfma_f32_16x16x32_bf16 a[40:43], v[124:127], v[184:187], a[40:43]
    s_add_u32 s55, s97, 16384
    buffer_load_dwordx4 v[208:211], v16, s[68:71], s55 offen offset:0 sc1
    v_mfma_f32_16x16x32_bf16 a[40:43], a[204:207], a[156:159], a[40:43]
    v_mfma_f32_16x16x32_bf16 a[44:47], a[204:207], v[224:227], a[44:47]
    v_mfma_f32_16x16x32_bf16 a[44:47], v[124:127], v[188:191], a[44:47]
    v_mfma_f32_16x16x32_bf16 a[48:51], v[124:127], a[128:131], a[48:51]
    buffer_load_dwordx4 v[212:215], v17, s[68:71], s55 offen offset:0 sc1
    v_mfma_f32_16x16x32_bf16 a[48:51], a[204:207], v[228:231], a[48:51]
    v_mfma_f32_16x16x32_bf16 a[52:55], a[204:207], a[224:227], a[52:55]
    v_mfma_f32_16x16x32_bf16 a[52:55], v[124:127], a[132:135], a[52:55]
    v_mfma_f32_16x16x32_bf16 a[56:59], v[124:127], a[144:147], a[56:59]
    buffer_load_dwordx4 v[80:83], v18, s[68:71], s55 offen offset:0 sc1
    v_mfma_f32_16x16x32_bf16 a[56:59], a[204:207], a[228:231], a[56:59]
    v_mfma_f32_16x16x32_bf16 a[76:79], a[216:219], a[228:231], a[76:79]
    v_mfma_f32_16x16x32_bf16 a[76:79], v[128:131], a[144:147], a[76:79]
    v_mfma_f32_16x16x32_bf16 a[72:75], v[128:131], a[132:135], a[72:75]
    buffer_load_dwordx4 v[84:87], v19, s[68:71], s55 offen offset:0 sc1
    v_mfma_f32_16x16x32_bf16 a[72:75], a[216:219], a[224:227], a[72:75]
    v_mfma_f32_16x16x32_bf16 a[68:71], a[216:219], v[228:231], a[68:71]
    v_mfma_f32_16x16x32_bf16 a[68:71], v[128:131], a[128:131], a[68:71]
    v_mfma_f32_16x16x32_bf16 a[64:67], v[128:131], v[188:191], a[64:67]
    buffer_load_dwordx4 v[96:99], v20, s[68:71], s55 offen offset:0 sc1
    v_mfma_f32_16x16x32_bf16 a[64:67], a[216:219], v[224:227], a[64:67]
    v_mfma_f32_16x16x32_bf16 a[60:63], a[216:219], a[156:159], a[60:63]
    v_mfma_f32_16x16x32_bf16 a[60:63], v[128:131], v[184:187], a[60:63]
    s_waitcnt vmcnt(19)
    v_mfma_f32_16x16x32_bf16 a[0:3], v[192:195], a[80:83], a[0:3]
    buffer_load_dwordx4 a[196:199], v16, s[68:71], s55 offen offset:1024 sc1
    v_mfma_f32_16x16x32_bf16 a[0:3], a[244:247], a[188:191], a[0:3]
    ds_read_b64_tr_b16 v[108:109], v34 offset:32768
    v_mfma_f32_16x16x32_bf16 a[4:7], a[244:247], a[104:107], a[4:7]
    buffer_load_dwordx4 v[116:119], v17, s[68:71], s55 offen offset:1024 sc1
    v_mfma_f32_16x16x32_bf16 a[4:7], v[192:195], a[84:87], a[4:7]
    ds_read_b64_tr_b16 v[110:111], v34 offset:34816
    v_mfma_f32_16x16x32_bf16 a[8:11], v[192:195], a[160:163], a[8:11]
    buffer_load_dwordx4 v[120:123], v18, s[68:71], s55 offen offset:1024 sc1
    v_mfma_f32_16x16x32_bf16 a[8:11], a[244:247], a[108:111], a[8:11]
    ds_read_b64_tr_b16 v[216:217], v35 offset:32768
    v_mfma_f32_16x16x32_bf16 a[12:15], a[244:247], v[48:51], a[12:15]
    buffer_load_dwordx4 a[212:215], v19, s[68:71], s55 offen offset:1024 sc1
    v_mfma_f32_16x16x32_bf16 a[12:15], v[192:195], a[164:167], a[12:15]
    ds_read_b64_tr_b16 v[218:219], v35 offset:34816
    v_mfma_f32_16x16x32_bf16 a[16:19], v[192:195], a[176:179], a[16:19]
    buffer_load_dwordx4 a[200:203], v20, s[68:71], s55 offen offset:1024 sc1
    v_mfma_f32_16x16x32_bf16 a[16:19], a[244:247], v[52:55], a[16:19]
    ds_read_b64_tr_b16 v[220:221], v36 offset:32768
    v_mfma_f32_16x16x32_bf16 a[36:39], a[232:235], v[52:55], a[36:39]
    s_add_u32 m0, s96, 81920
    s_add_u32 s33, s98, 988160
    buffer_load_dwordx4 v244, s[64:67], s33 offen offset:0 lds
    v_mfma_f32_16x16x32_bf16 a[36:39], v[196:199], a[176:179], a[36:39]
    ds_read_b64_tr_b16 v[222:223], v36 offset:34816
    v_mfma_f32_16x16x32_bf16 a[32:35], v[196:199], a[164:167], a[32:35]
    buffer_load_dwordx4 v245, s[64:67], s33 offen offset:1024 lds
    v_mfma_f32_16x16x32_bf16 a[32:35], a[232:235], v[48:51], a[32:35]
    ds_read_b64_tr_b16 a[192:193], v37 offset:32768
    v_mfma_f32_16x16x32_bf16 a[28:31], a[232:235], a[108:111], a[28:31]
    buffer_load_dwordx4 v246, s[64:67], s33 offen offset:2048 lds
    v_mfma_f32_16x16x32_bf16 a[28:31], v[196:199], a[160:163], a[28:31]
    ds_read_b64_tr_b16 a[194:195], v37 offset:34816
    v_mfma_f32_16x16x32_bf16 a[24:27], v[196:199], a[84:87], a[24:27]
    buffer_load_dwordx4 v247, s[64:67], s33 offen offset:3072 lds
    v_mfma_f32_16x16x32_bf16 a[24:27], a[232:235], a[104:107], a[24:27]
    v_mfma_f32_16x16x32_bf16 a[20:23], a[232:235], a[188:191], a[20:23]
    v_mfma_f32_16x16x32_bf16 a[20:23], v[196:199], a[80:83], a[20:23]
    s_waitcnt lgkmcnt(0)
    v_mfma_f32_16x16x32_bf16 a[40:43], v[200:203], a[80:83], a[40:43]
    buffer_load_dwordx4 v[124:127], v16, s[68:71], s55 offen offset:2048 sc1
    v_mfma_f32_16x16x32_bf16 a[40:43], a[236:239], a[188:191], a[40:43]
    v_mfma_f32_16x16x32_bf16 a[44:47], a[236:239], a[104:107], a[44:47]
    v_mfma_f32_16x16x32_bf16 a[44:47], v[200:203], a[84:87], a[44:47]
    v_mfma_f32_16x16x32_bf16 a[48:51], v[200:203], a[160:163], a[48:51]
    buffer_load_dwordx4 v[128:131], v17, s[68:71], s55 offen offset:2048 sc1
    v_mfma_f32_16x16x32_bf16 a[48:51], a[236:239], a[108:111], a[48:51]
    v_mfma_f32_16x16x32_bf16 a[52:55], a[236:239], v[48:51], a[52:55]
    v_mfma_f32_16x16x32_bf16 a[52:55], v[200:203], a[164:167], a[52:55]
    v_mfma_f32_16x16x32_bf16 a[56:59], v[200:203], a[176:179], a[56:59]
    buffer_load_dwordx4 a[204:207], v18, s[68:71], s55 offen offset:2048 sc1
    v_mfma_f32_16x16x32_bf16 a[56:59], a[236:239], v[52:55], a[56:59]
    v_mfma_f32_16x16x32_bf16 a[76:79], a[248:251], v[52:55], a[76:79]
    v_mfma_f32_16x16x32_bf16 a[76:79], v[204:207], a[176:179], a[76:79]
    v_mfma_f32_16x16x32_bf16 a[72:75], v[204:207], a[164:167], a[72:75]
    buffer_load_dwordx4 a[216:219], v19, s[68:71], s55 offen offset:2048 sc1
    v_mfma_f32_16x16x32_bf16 a[72:75], a[248:251], v[48:51], a[72:75]
    v_mfma_f32_16x16x32_bf16 a[68:71], a[248:251], a[108:111], a[68:71]
    v_mfma_f32_16x16x32_bf16 a[68:71], v[204:207], a[160:163], a[68:71]
    v_mfma_f32_16x16x32_bf16 a[64:67], v[204:207], a[84:87], a[64:67]
    buffer_load_dwordx4 v[184:187], v20, s[68:71], s55 offen offset:2048 sc1
    v_mfma_f32_16x16x32_bf16 a[64:67], a[248:251], a[104:107], a[64:67]
    v_mfma_f32_16x16x32_bf16 a[60:63], a[248:251], a[188:191], a[60:63]
    v_mfma_f32_16x16x32_bf16 a[60:63], v[204:207], a[80:83], a[60:63]
    s_waitcnt vmcnt(19)
    v_mfma_f32_16x16x32_bf16 a[0:3], a[88:91], a[120:123], a[0:3]
    buffer_load_dwordx4 a[156:159], v16, s[68:71], s55 offen offset:3072 sc1
    v_mfma_f32_16x16x32_bf16 a[0:3], v[68:71], v[164:167], a[0:3]
    ds_read_b64_tr_b16 v[188:189], v34 offset:0
    v_mfma_f32_16x16x32_bf16 a[4:7], v[68:71], v[152:155], a[4:7]
    ds_read_b64_tr_b16 v[190:191], v34 offset:2048
    v_mfma_f32_16x16x32_bf16 a[4:7], a[88:91], a[124:127], a[4:7]
    ds_read_b64_tr_b16 a[128:129], v35 offset:0
    v_mfma_f32_16x16x32_bf16 a[8:11], a[88:91], v[144:147], a[8:11]
    buffer_load_dwordx4 v[224:227], v17, s[68:71], s55 offen offset:3072 sc1
    v_mfma_f32_16x16x32_bf16 a[8:11], v[68:71], v[156:159], a[8:11]
    ds_read_b64_tr_b16 a[130:131], v35 offset:2048
    v_mfma_f32_16x16x32_bf16 a[12:15], v[68:71], v[168:171], a[12:15]
    ds_read_b64_tr_b16 a[132:133], v36 offset:0
    v_mfma_f32_16x16x32_bf16 a[12:15], a[88:91], v[148:151], a[12:15]
    ds_read_b64_tr_b16 a[134:135], v36 offset:2048
    v_mfma_f32_16x16x32_bf16 a[16:19], a[88:91], v[160:163], a[16:19]
    buffer_load_dwordx4 v[228:231], v18, s[68:71], s55 offen offset:3072 sc1
    v_mfma_f32_16x16x32_bf16 a[16:19], v[68:71], v[172:175], a[16:19]
    ds_read_b64_tr_b16 a[144:145], v37 offset:0
    v_mfma_f32_16x16x32_bf16 a[36:39], v[56:59], v[172:175], a[36:39]
    ds_read_b64_tr_b16 a[146:147], v37 offset:2048
    v_mfma_f32_16x16x32_bf16 a[36:39], a[92:95], v[160:163], a[36:39]
    v_mfma_f32_16x16x32_bf16 a[32:35], a[92:95], v[148:151], a[32:35]
    buffer_load_dwordx4 a[224:227], v19, s[68:71], s55 offen offset:3072 sc1
    v_mfma_f32_16x16x32_bf16 a[32:35], v[56:59], v[168:171], a[32:35]
    v_mfma_f32_16x16x32_bf16 a[28:31], v[56:59], v[156:159], a[28:31]
    v_mfma_f32_16x16x32_bf16 a[28:31], a[92:95], v[144:147], a[28:31]
    v_mfma_f32_16x16x32_bf16 a[24:27], a[92:95], a[124:127], a[24:27]
    buffer_load_dwordx4 a[228:231], v20, s[68:71], s55 offen offset:3072 sc1
    v_mfma_f32_16x16x32_bf16 a[24:27], v[56:59], v[152:155], a[24:27]
    v_mfma_f32_16x16x32_bf16 a[20:23], v[56:59], v[164:167], a[20:23]
    v_mfma_f32_16x16x32_bf16 a[20:23], a[92:95], a[120:123], a[20:23]
    s_waitcnt lgkmcnt(0)
    v_mfma_f32_16x16x32_bf16 a[40:43], a[96:99], a[120:123], a[40:43]
    s_add_u32 s55, s97, 20480
    buffer_load_dwordx4 v[192:195], v16, s[68:71], s55 offen offset:0 sc1
    v_mfma_f32_16x16x32_bf16 a[40:43], v[60:63], v[164:167], a[40:43]
    v_mfma_f32_16x16x32_bf16 a[44:47], v[60:63], v[152:155], a[44:47]
    buffer_load_dwordx4 v[196:199], v17, s[68:71], s55 offen offset:0 sc1
    v_mfma_f32_16x16x32_bf16 a[44:47], a[96:99], a[124:127], a[44:47]
    v_mfma_f32_16x16x32_bf16 a[48:51], a[96:99], v[144:147], a[48:51]
    buffer_load_dwordx4 a[244:247], v18, s[68:71], s55 offen offset:0 sc1
    v_mfma_f32_16x16x32_bf16 a[48:51], v[60:63], v[156:159], a[48:51]
    v_mfma_f32_16x16x32_bf16 a[52:55], v[60:63], v[168:171], a[52:55]
    buffer_load_dwordx4 a[232:235], v19, s[68:71], s55 offen offset:0 sc1
    v_mfma_f32_16x16x32_bf16 a[52:55], a[96:99], v[148:151], a[52:55]
    v_mfma_f32_16x16x32_bf16 a[56:59], a[96:99], v[160:163], a[56:59]
    buffer_load_dwordx4 v[200:203], v20, s[68:71], s55 offen offset:0 sc1
    v_mfma_f32_16x16x32_bf16 a[56:59], v[60:63], v[172:175], a[56:59]
    v_mfma_f32_16x16x32_bf16 a[76:79], v[72:75], v[172:175], a[76:79]
    s_add_u32 m0, s96, 16384
    s_add_u32 s33, s98, 993280
    buffer_load_dwordx4 v244, s[64:67], s33 offen offset:0 lds
    v_mfma_f32_16x16x32_bf16 a[76:79], a[100:103], v[160:163], a[76:79]
    v_mfma_f32_16x16x32_bf16 a[72:75], a[100:103], v[148:151], a[72:75]
    buffer_load_dwordx4 v245, s[64:67], s33 offen offset:1024 lds
    v_mfma_f32_16x16x32_bf16 a[72:75], v[72:75], v[168:171], a[72:75]
    v_mfma_f32_16x16x32_bf16 a[68:71], v[72:75], v[156:159], a[68:71]
    buffer_load_dwordx4 v246, s[64:67], s33 offen offset:2048 lds
    v_mfma_f32_16x16x32_bf16 a[68:71], a[100:103], v[144:147], a[68:71]
    v_mfma_f32_16x16x32_bf16 a[64:67], a[100:103], a[124:127], a[64:67]
    buffer_load_dwordx4 v247, s[64:67], s33 offen offset:3072 lds
    v_mfma_f32_16x16x32_bf16 a[64:67], v[72:75], v[152:155], a[64:67]
    v_mfma_f32_16x16x32_bf16 a[60:63], v[72:75], v[164:167], a[60:63]
    v_mfma_f32_16x16x32_bf16 a[60:63], a[100:103], a[120:123], a[60:63]
    s_waitcnt vmcnt(23)
    v_mfma_f32_16x16x32_bf16 a[0:3], v[112:115], v[208:211], a[0:3]
    buffer_load_dwordx4 v[204:207], v16, s[68:71], s55 offen offset:1024 sc1
    v_mfma_f32_16x16x32_bf16 a[0:3], v[100:103], a[196:199], a[0:3]
    v_mfma_f32_16x16x32_bf16 a[4:7], v[100:103], v[116:119], a[4:7]
    v_mfma_f32_16x16x32_bf16 a[4:7], v[112:115], v[212:215], a[4:7]
    v_mfma_f32_16x16x32_bf16 a[8:11], v[112:115], v[80:83], a[8:11]
    buffer_load_dwordx4 a[236:239], v17, s[68:71], s55 offen offset:1024 sc1
    v_mfma_f32_16x16x32_bf16 a[8:11], v[100:103], v[120:123], a[8:11]
    v_mfma_f32_16x16x32_bf16 a[12:15], v[100:103], a[212:215], a[12:15]
    v_mfma_f32_16x16x32_bf16 a[12:15], v[112:115], v[84:87], a[12:15]
    v_mfma_f32_16x16x32_bf16 a[16:19], v[112:115], v[96:99], a[16:19]
    buffer_load_dwordx4 a[248:251], v18, s[68:71], s55 offen offset:1024 sc1
    v_mfma_f32_16x16x32_bf16 a[16:19], v[100:103], a[200:203], a[16:19]
    v_mfma_f32_16x16x32_bf16 a[36:39], v[88:91], a[200:203], a[36:39]
    v_mfma_f32_16x16x32_bf16 a[36:39], v[132:135], v[96:99], a[36:39]
    v_mfma_f32_16x16x32_bf16 a[32:35], v[132:135], v[84:87], a[32:35]
    buffer_load_dwordx4 a[80:83], v19, s[68:71], s55 offen offset:1024 sc1
    v_mfma_f32_16x16x32_bf16 a[32:35], v[88:91], a[212:215], a[32:35]
    v_mfma_f32_16x16x32_bf16 a[28:31], v[88:91], v[120:123], a[28:31]
    v_mfma_f32_16x16x32_bf16 a[28:31], v[132:135], v[80:83], a[28:31]
    v_mfma_f32_16x16x32_bf16 a[24:27], v[132:135], v[212:215], a[24:27]
    buffer_load_dwordx4 a[84:87], v20, s[68:71], s55 offen offset:1024 sc1
    v_mfma_f32_16x16x32_bf16 a[24:27], v[88:91], v[116:119], a[24:27]
    v_mfma_f32_16x16x32_bf16 a[20:23], v[88:91], a[196:199], a[20:23]
    v_mfma_f32_16x16x32_bf16 a[20:23], v[132:135], v[208:211], a[20:23]
    v_mfma_f32_16x16x32_bf16 a[40:43], v[136:139], v[208:211], a[40:43]
    buffer_load_dwordx4 a[160:163], v16, s[68:71], s55 offen offset:2048 sc1
    v_mfma_f32_16x16x32_bf16 a[40:43], v[92:95], a[196:199], a[40:43]
    v_mfma_f32_16x16x32_bf16 a[44:47], v[92:95], v[116:119], a[44:47]
    v_mfma_f32_16x16x32_bf16 a[44:47], v[136:139], v[212:215], a[44:47]
    v_mfma_f32_16x16x32_bf16 a[48:51], v[136:139], v[80:83], a[48:51]
    buffer_load_dwordx4 a[164:167], v17, s[68:71], s55 offen offset:2048 sc1
    v_mfma_f32_16x16x32_bf16 a[48:51], v[92:95], v[120:123], a[48:51]
    v_mfma_f32_16x16x32_bf16 a[52:55], v[92:95], a[212:215], a[52:55]
    v_mfma_f32_16x16x32_bf16 a[52:55], v[136:139], v[84:87], a[52:55]
    v_mfma_f32_16x16x32_bf16 a[56:59], v[136:139], v[96:99], a[56:59]
    buffer_load_dwordx4 a[176:179], v18, s[68:71], s55 offen offset:2048 sc1
    v_mfma_f32_16x16x32_bf16 a[56:59], v[92:95], a[200:203], a[56:59]
    v_mfma_f32_16x16x32_bf16 a[76:79], v[104:107], a[200:203], a[76:79]
    v_mfma_f32_16x16x32_bf16 a[76:79], v[140:143], v[96:99], a[76:79]
    v_mfma_f32_16x16x32_bf16 a[72:75], v[140:143], v[84:87], a[72:75]
    buffer_load_dwordx4 a[188:191], v19, s[68:71], s55 offen offset:2048 sc1
    v_mfma_f32_16x16x32_bf16 a[72:75], v[104:107], a[212:215], a[72:75]
    v_mfma_f32_16x16x32_bf16 a[68:71], v[104:107], v[120:123], a[68:71]
    v_mfma_f32_16x16x32_bf16 a[68:71], v[140:143], v[80:83], a[68:71]
    v_mfma_f32_16x16x32_bf16 a[64:67], v[140:143], v[212:215], a[64:67]
    buffer_load_dwordx4 a[104:107], v20, s[68:71], s55 offen offset:2048 sc1
    v_mfma_f32_16x16x32_bf16 a[64:67], v[104:107], v[116:119], a[64:67]
    v_mfma_f32_16x16x32_bf16 a[60:63], v[104:107], a[196:199], a[60:63]
    v_mfma_f32_16x16x32_bf16 a[60:63], v[140:143], v[208:211], a[60:63]
    s_waitcnt vmcnt(19)
    v_mfma_f32_16x16x32_bf16 a[0:3], a[208:211], v[124:127], a[0:3]
    buffer_load_dwordx4 a[92:95], v16, s[68:71], s55 offen offset:3072 sc1
    v_mfma_f32_16x16x32_bf16 a[0:3], a[148:151], a[156:159], a[0:3]
    ds_read_b64_tr_b16 a[108:109], v38 offset:16384
    v_mfma_f32_16x16x32_bf16 a[4:7], a[148:151], v[224:227], a[4:7]
    buffer_load_dwordx4 v[68:71], v17, s[68:71], s55 offen offset:3072 sc1
    v_mfma_f32_16x16x32_bf16 a[4:7], a[208:211], v[128:131], a[4:7]
    ds_read_b64_tr_b16 a[110:111], v38 offset:18432
    v_mfma_f32_16x16x32_bf16 a[8:11], a[208:211], a[204:207], a[8:11]
    buffer_load_dwordx4 v[56:59], v18, s[68:71], s55 offen offset:3072 sc1
    v_mfma_f32_16x16x32_bf16 a[8:11], a[148:151], v[228:231], a[8:11]
    ds_read_b64_tr_b16 v[48:49], v39 offset:16384
    v_mfma_f32_16x16x32_bf16 a[12:15], a[148:151], a[224:227], a[12:15]
    buffer_load_dwordx4 a[96:99], v19, s[68:71], s55 offen offset:3072 sc1
    v_mfma_f32_16x16x32_bf16 a[12:15], a[208:211], a[216:219], a[12:15]
    ds_read_b64_tr_b16 v[50:51], v39 offset:18432
    v_mfma_f32_16x16x32_bf16 a[16:19], a[208:211], v[184:187], a[16:19]
    buffer_load_dwordx4 a[100:103], v20, s[68:71], s55 offen offset:3072 sc1
    v_mfma_f32_16x16x32_bf16 a[16:19], a[148:151], a[228:231], a[16:19]
    ds_read_b64_tr_b16 v[52:53], v40 offset:16384
    v_mfma_f32_16x16x32_bf16 a[36:39], a[136:139], a[228:231], a[36:39]
    s_add_u32 m0, s96, 49152
    s_add_u32 s33, s98, 998400
    buffer_load_dwordx4 v244, s[64:67], s33 offen offset:0 lds
    v_mfma_f32_16x16x32_bf16 a[36:39], a[220:223], v[184:187], a[36:39]
    ds_read_b64_tr_b16 v[54:55], v40 offset:18432
    v_mfma_f32_16x16x32_bf16 a[32:35], a[220:223], a[216:219], a[32:35]
    buffer_load_dwordx4 v245, s[64:67], s33 offen offset:1024 lds
    v_mfma_f32_16x16x32_bf16 a[32:35], a[136:139], a[224:227], a[32:35]
    ds_read_b64_tr_b16 a[88:89], v41 offset:16384
    v_mfma_f32_16x16x32_bf16 a[28:31], a[136:139], v[228:231], a[28:31]
    buffer_load_dwordx4 v246, s[64:67], s33 offen offset:2048 lds
    v_mfma_f32_16x16x32_bf16 a[28:31], a[220:223], a[204:207], a[28:31]
    ds_read_b64_tr_b16 a[90:91], v41 offset:18432
    v_mfma_f32_16x16x32_bf16 a[24:27], a[220:223], v[128:131], a[24:27]
    buffer_load_dwordx4 v247, s[64:67], s33 offen offset:3072 lds
    v_mfma_f32_16x16x32_bf16 a[24:27], a[136:139], v[224:227], a[24:27]
    v_mfma_f32_16x16x32_bf16 a[20:23], a[136:139], a[156:159], a[20:23]
    v_mfma_f32_16x16x32_bf16 a[20:23], a[220:223], v[124:127], a[20:23]
    s_waitcnt lgkmcnt(0)
    v_mfma_f32_16x16x32_bf16 a[40:43], v[176:179], v[124:127], a[40:43]
    s_add_u32 s55, s97, 24576
    buffer_load_dwordx4 v[60:63], v16, s[68:71], s55 offen offset:0 sc1
    v_mfma_f32_16x16x32_bf16 a[40:43], a[140:143], a[156:159], a[40:43]
    v_mfma_f32_16x16x32_bf16 a[44:47], a[140:143], v[224:227], a[44:47]
    v_mfma_f32_16x16x32_bf16 a[44:47], v[176:179], v[128:131], a[44:47]
    v_mfma_f32_16x16x32_bf16 a[48:51], v[176:179], a[204:207], a[48:51]
    buffer_load_dwordx4 v[72:75], v17, s[68:71], s55 offen offset:0 sc1
    v_mfma_f32_16x16x32_bf16 a[48:51], a[140:143], v[228:231], a[48:51]
    v_mfma_f32_16x16x32_bf16 a[52:55], a[140:143], a[224:227], a[52:55]
    v_mfma_f32_16x16x32_bf16 a[52:55], v[176:179], a[216:219], a[52:55]
    v_mfma_f32_16x16x32_bf16 a[56:59], v[176:179], v[184:187], a[56:59]
    buffer_load_dwordx4 a[120:123], v18, s[68:71], s55 offen offset:0 sc1
    v_mfma_f32_16x16x32_bf16 a[56:59], a[140:143], a[228:231], a[56:59]
    v_mfma_f32_16x16x32_bf16 a[76:79], a[152:155], a[228:231], a[76:79]
    v_mfma_f32_16x16x32_bf16 a[76:79], v[180:183], v[184:187], a[76:79]
    v_mfma_f32_16x16x32_bf16 a[72:75], v[180:183], a[216:219], a[72:75]
    buffer_load_dwordx4 a[124:127], v19, s[68:71], s55 offen offset:0 sc1
    v_mfma_f32_16x16x32_bf16 a[72:75], a[152:155], a[224:227], a[72:75]
    v_mfma_f32_16x16x32_bf16 a[68:71], a[152:155], v[228:231], a[68:71]
    v_mfma_f32_16x16x32_bf16 a[68:71], v[180:183], a[204:207], a[68:71]
    v_mfma_f32_16x16x32_bf16 a[64:67], v[180:183], v[128:131], a[64:67]
    buffer_load_dwordx4 v[144:147], v20, s[68:71], s55 offen offset:0 sc1
    v_mfma_f32_16x16x32_bf16 a[64:67], a[152:155], v[224:227], a[64:67]
    v_mfma_f32_16x16x32_bf16 a[60:63], a[152:155], a[156:159], a[60:63]
    v_mfma_f32_16x16x32_bf16 a[60:63], v[180:183], v[124:127], a[60:63]
    s_waitcnt vmcnt(19)
    v_mfma_f32_16x16x32_bf16 a[0:3], a[240:243], v[192:195], a[0:3]
    buffer_load_dwordx4 v[156:159], v16, s[68:71], s55 offen offset:1024 sc1
    v_mfma_f32_16x16x32_bf16 a[0:3], a[180:183], v[204:207], a[0:3]
    ds_read_b64_tr_b16 v[148:149], v34 offset:16384
    v_mfma_f32_16x16x32_bf16 a[4:7], a[180:183], a[236:239], a[4:7]
    ds_read_b64_tr_b16 v[150:151], v34 offset:18432
    v_mfma_f32_16x16x32_bf16 a[4:7], a[240:243], v[196:199], a[4:7]
    ds_read_b64_tr_b16 v[160:161], v35 offset:16384
    v_mfma_f32_16x16x32_bf16 a[8:11], a[240:243], a[244:247], a[8:11]
    buffer_load_dwordx4 v[168:171], v17, s[68:71], s55 offen offset:1024 sc1
    v_mfma_f32_16x16x32_bf16 a[8:11], a[180:183], a[248:251], a[8:11]
    ds_read_b64_tr_b16 v[162:163], v35 offset:18432
    v_mfma_f32_16x16x32_bf16 a[12:15], a[180:183], a[80:83], a[12:15]
    ds_read_b64_tr_b16 v[164:165], v36 offset:16384
    v_mfma_f32_16x16x32_bf16 a[12:15], a[240:243], a[232:235], a[12:15]
    ds_read_b64_tr_b16 v[166:167], v36 offset:18432
    v_mfma_f32_16x16x32_bf16 a[16:19], a[240:243], v[200:203], a[16:19]
    buffer_load_dwordx4 v[172:175], v18, s[68:71], s55 offen offset:1024 sc1
    v_mfma_f32_16x16x32_bf16 a[16:19], a[180:183], a[84:87], a[16:19]
    ds_read_b64_tr_b16 v[152:153], v37 offset:16384
    v_mfma_f32_16x16x32_bf16 a[36:39], a[168:171], a[84:87], a[36:39]
    ds_read_b64_tr_b16 v[154:155], v37 offset:18432
    v_mfma_f32_16x16x32_bf16 a[36:39], a[252:255], v[200:203], a[36:39]
    v_mfma_f32_16x16x32_bf16 a[32:35], a[252:255], a[232:235], a[32:35]
    buffer_load_dwordx4 v[112:115], v19, s[68:71], s55 offen offset:1024 sc1
    v_mfma_f32_16x16x32_bf16 a[32:35], a[168:171], a[80:83], a[32:35]
    v_mfma_f32_16x16x32_bf16 a[28:31], a[168:171], a[248:251], a[28:31]
    v_mfma_f32_16x16x32_bf16 a[28:31], a[252:255], a[244:247], a[28:31]
    v_mfma_f32_16x16x32_bf16 a[24:27], a[252:255], v[196:199], a[24:27]
    buffer_load_dwordx4 v[132:135], v20, s[68:71], s55 offen offset:1024 sc1
    v_mfma_f32_16x16x32_bf16 a[24:27], a[168:171], a[236:239], a[24:27]
    v_mfma_f32_16x16x32_bf16 a[20:23], a[168:171], v[204:207], a[20:23]
    v_mfma_f32_16x16x32_bf16 a[20:23], a[252:255], v[192:195], a[20:23]
    s_waitcnt lgkmcnt(0)
    s_waitcnt vmcnt(10)
    v_mfma_f32_16x16x32_bf16 a[40:43], v[232:235], v[192:195], a[40:43]
    buffer_load_dwordx4 v[92:95], v16, s[68:71], s55 offen offset:2048 sc1
    v_mfma_f32_16x16x32_bf16 a[40:43], a[172:175], v[204:207], a[40:43]
    ds_read_b64_tr_b16 v[100:101], v34 offset:49152
    v_mfma_f32_16x16x32_bf16 a[44:47], a[172:175], a[236:239], a[44:47]
    ds_read_b64_tr_b16 v[102:103], v34 offset:51200
    v_mfma_f32_16x16x32_bf16 a[44:47], v[232:235], v[196:199], a[44:47]
    ds_read_b64_tr_b16 v[88:89], v35 offset:49152
    v_mfma_f32_16x16x32_bf16 a[48:51], v[232:235], a[244:247], a[48:51]
    buffer_load_dwordx4 v[104:107], v17, s[68:71], s55 offen offset:2048 sc1
    v_mfma_f32_16x16x32_bf16 a[48:51], a[172:175], a[248:251], a[48:51]
    ds_read_b64_tr_b16 v[90:91], v35 offset:51200
    v_mfma_f32_16x16x32_bf16 a[52:55], a[172:175], a[80:83], a[52:55]
    ds_read_b64_tr_b16 v[136:137], v36 offset:49152
    v_mfma_f32_16x16x32_bf16 a[52:55], v[232:235], a[232:235], a[52:55]
    ds_read_b64_tr_b16 v[138:139], v36 offset:51200
    v_mfma_f32_16x16x32_bf16 a[56:59], v[232:235], v[200:203], a[56:59]
    buffer_load_dwordx4 v[208:211], v18, s[68:71], s55 offen offset:2048 sc1
    v_mfma_f32_16x16x32_bf16 a[56:59], a[172:175], a[84:87], a[56:59]
    ds_read_b64_tr_b16 v[140:141], v37 offset:49152
    v_mfma_f32_16x16x32_bf16 a[76:79], a[184:187], a[84:87], a[76:79]
    ds_read_b64_tr_b16 v[142:143], v37 offset:51200
    v_mfma_f32_16x16x32_bf16 a[76:79], v[236:239], v[200:203], a[76:79]
    v_mfma_f32_16x16x32_bf16 a[72:75], v[236:239], a[232:235], a[72:75]
    buffer_load_dwordx4 v[212:215], v19, s[68:71], s55 offen offset:2048 sc1
    v_mfma_f32_16x16x32_bf16 a[72:75], a[184:187], a[80:83], a[72:75]
    v_mfma_f32_16x16x32_bf16 a[68:71], a[184:187], a[248:251], a[68:71]
    v_mfma_f32_16x16x32_bf16 a[68:71], v[236:239], a[244:247], a[68:71]
    v_mfma_f32_16x16x32_bf16 a[64:67], v[236:239], v[196:199], a[64:67]
    buffer_load_dwordx4 v[80:83], v20, s[68:71], s55 offen offset:2048 sc1
    v_mfma_f32_16x16x32_bf16 a[64:67], a[184:187], a[236:239], a[64:67]
    v_mfma_f32_16x16x32_bf16 a[60:63], a[184:187], v[204:207], a[60:63]
    v_mfma_f32_16x16x32_bf16 a[60:63], v[236:239], v[192:195], a[60:63]
    s_waitcnt lgkmcnt(0)
    s_waitcnt vmcnt(19)
    v_mfma_f32_16x16x32_bf16 a[0:3], v[64:67], a[160:163], a[0:3]
    buffer_load_dwordx4 v[84:87], v16, s[68:71], s55 offen offset:3072 sc1
    v_mfma_f32_16x16x32_bf16 a[0:3], v[108:111], a[92:95], a[0:3]
    v_mfma_f32_16x16x32_bf16 a[4:7], v[108:111], v[68:71], a[4:7]
    v_mfma_f32_16x16x32_bf16 a[4:7], v[64:67], a[164:167], a[4:7]
    v_mfma_f32_16x16x32_bf16 a[8:11], v[64:67], a[176:179], a[8:11]
    buffer_load_dwordx4 v[96:99], v17, s[68:71], s55 offen offset:3072 sc1
    v_mfma_f32_16x16x32_bf16 a[8:11], v[108:111], v[56:59], a[8:11]
    v_mfma_f32_16x16x32_bf16 a[12:15], v[108:111], a[96:99], a[12:15]
    v_mfma_f32_16x16x32_bf16 a[12:15], v[64:67], a[188:191], a[12:15]
    v_mfma_f32_16x16x32_bf16 a[16:19], v[64:67], a[104:107], a[16:19]
    buffer_load_dwordx4 a[196:199], v18, s[68:71], s55 offen offset:3072 sc1
    v_mfma_f32_16x16x32_bf16 a[16:19], v[108:111], a[100:103], a[16:19]
    v_mfma_f32_16x16x32_bf16 a[36:39], v[216:219], a[100:103], a[36:39]
    v_mfma_f32_16x16x32_bf16 a[36:39], v[76:79], a[104:107], a[36:39]
    v_mfma_f32_16x16x32_bf16 a[32:35], v[76:79], a[188:191], a[32:35]
    buffer_load_dwordx4 v[116:119], v19, s[68:71], s55 offen offset:3072 sc1
    v_mfma_f32_16x16x32_bf16 a[32:35], v[216:219], a[96:99], a[32:35]
    v_mfma_f32_16x16x32_bf16 a[28:31], v[216:219], v[56:59], a[28:31]
    v_mfma_f32_16x16x32_bf16 a[28:31], v[76:79], a[176:179], a[28:31]
    v_mfma_f32_16x16x32_bf16 a[24:27], v[76:79], a[164:167], a[24:27]
    buffer_load_dwordx4 v[120:123], v20, s[68:71], s55 offen offset:3072 sc1
    v_mfma_f32_16x16x32_bf16 a[24:27], v[216:219], v[68:71], a[24:27]
    v_mfma_f32_16x16x32_bf16 a[20:23], v[216:219], a[92:95], a[20:23]
    v_mfma_f32_16x16x32_bf16 a[20:23], v[76:79], a[160:163], a[20:23]
    v_mfma_f32_16x16x32_bf16 a[40:43], a[112:115], a[160:163], a[40:43]
    v_mfma_f32_16x16x32_bf16 a[40:43], v[220:223], a[92:95], a[40:43]
    v_mfma_f32_16x16x32_bf16 a[44:47], v[220:223], v[68:71], a[44:47]
    v_mfma_f32_16x16x32_bf16 a[44:47], a[112:115], a[164:167], a[44:47]
    v_mfma_f32_16x16x32_bf16 a[48:51], a[112:115], a[176:179], a[48:51]
    v_mfma_f32_16x16x32_bf16 a[48:51], v[220:223], v[56:59], a[48:51]
    v_mfma_f32_16x16x32_bf16 a[52:55], v[220:223], a[96:99], a[52:55]
    v_mfma_f32_16x16x32_bf16 a[52:55], a[112:115], a[188:191], a[52:55]
    v_mfma_f32_16x16x32_bf16 a[56:59], a[112:115], a[104:107], a[56:59]
    v_mfma_f32_16x16x32_bf16 a[56:59], v[220:223], a[100:103], a[56:59]
    v_mfma_f32_16x16x32_bf16 a[76:79], a[192:195], a[100:103], a[76:79]
    v_mfma_f32_16x16x32_bf16 a[76:79], a[116:119], a[104:107], a[76:79]
    v_mfma_f32_16x16x32_bf16 a[72:75], a[116:119], a[188:191], a[72:75]
    v_mfma_f32_16x16x32_bf16 a[72:75], a[192:195], a[96:99], a[72:75]
    v_mfma_f32_16x16x32_bf16 a[68:71], a[192:195], v[56:59], a[68:71]
    v_mfma_f32_16x16x32_bf16 a[68:71], a[116:119], a[176:179], a[68:71]
    v_mfma_f32_16x16x32_bf16 a[64:67], a[116:119], a[164:167], a[64:67]
    v_mfma_f32_16x16x32_bf16 a[64:67], a[192:195], v[68:71], a[64:67]
    v_mfma_f32_16x16x32_bf16 a[60:63], a[192:195], a[92:95], a[60:63]
    v_mfma_f32_16x16x32_bf16 a[60:63], a[116:119], a[160:163], a[60:63]
    s_waitcnt vmcnt(10)
    v_mfma_f32_16x16x32_bf16 a[0:3], v[188:191], v[60:63], a[0:3]
    v_mfma_f32_16x16x32_bf16 a[0:3], a[108:111], v[156:159], a[0:3]
    v_mfma_f32_16x16x32_bf16 a[4:7], a[108:111], v[168:171], a[4:7]
    v_mfma_f32_16x16x32_bf16 a[4:7], v[188:191], v[72:75], a[4:7]
    v_mfma_f32_16x16x32_bf16 a[8:11], v[188:191], a[120:123], a[8:11]
    v_mfma_f32_16x16x32_bf16 a[8:11], a[108:111], v[172:175], a[8:11]
    v_mfma_f32_16x16x32_bf16 a[12:15], a[108:111], v[112:115], a[12:15]
    v_mfma_f32_16x16x32_bf16 a[12:15], v[188:191], a[124:127], a[12:15]
    v_mfma_f32_16x16x32_bf16 a[16:19], v[188:191], v[144:147], a[16:19]
    v_mfma_f32_16x16x32_bf16 a[16:19], a[108:111], v[132:135], a[16:19]
    v_mfma_f32_16x16x32_bf16 a[36:39], v[48:51], v[132:135], a[36:39]
    v_mfma_f32_16x16x32_bf16 a[36:39], a[128:131], v[144:147], a[36:39]
    v_mfma_f32_16x16x32_bf16 a[32:35], a[128:131], a[124:127], a[32:35]
    v_mfma_f32_16x16x32_bf16 a[32:35], v[48:51], v[112:115], a[32:35]
    v_mfma_f32_16x16x32_bf16 a[28:31], v[48:51], v[172:175], a[28:31]
    v_mfma_f32_16x16x32_bf16 a[28:31], a[128:131], a[120:123], a[28:31]
    v_mfma_f32_16x16x32_bf16 a[24:27], a[128:131], v[72:75], a[24:27]
    v_mfma_f32_16x16x32_bf16 a[24:27], v[48:51], v[168:171], a[24:27]
    v_mfma_f32_16x16x32_bf16 a[20:23], v[48:51], v[156:159], a[20:23]
    v_mfma_f32_16x16x32_bf16 a[20:23], a[128:131], v[60:63], a[20:23]
    v_mfma_f32_16x16x32_bf16 a[40:43], a[132:135], v[60:63], a[40:43]
    v_mfma_f32_16x16x32_bf16 a[40:43], v[52:55], v[156:159], a[40:43]
    v_mfma_f32_16x16x32_bf16 a[44:47], v[52:55], v[168:171], a[44:47]
    v_mfma_f32_16x16x32_bf16 a[44:47], a[132:135], v[72:75], a[44:47]
    v_mfma_f32_16x16x32_bf16 a[48:51], a[132:135], a[120:123], a[48:51]
    v_mfma_f32_16x16x32_bf16 a[48:51], v[52:55], v[172:175], a[48:51]
    v_mfma_f32_16x16x32_bf16 a[52:55], v[52:55], v[112:115], a[52:55]
    v_mfma_f32_16x16x32_bf16 a[52:55], a[132:135], a[124:127], a[52:55]
    v_mfma_f32_16x16x32_bf16 a[56:59], a[132:135], v[144:147], a[56:59]
    v_mfma_f32_16x16x32_bf16 a[56:59], v[52:55], v[132:135], a[56:59]
    v_mfma_f32_16x16x32_bf16 a[76:79], a[88:91], v[132:135], a[76:79]
    v_mfma_f32_16x16x32_bf16 a[76:79], a[144:147], v[144:147], a[76:79]
    v_mfma_f32_16x16x32_bf16 a[72:75], a[144:147], a[124:127], a[72:75]
    v_mfma_f32_16x16x32_bf16 a[72:75], a[88:91], v[112:115], a[72:75]
    v_mfma_f32_16x16x32_bf16 a[68:71], a[88:91], v[172:175], a[68:71]
    v_mfma_f32_16x16x32_bf16 a[68:71], a[144:147], a[120:123], a[68:71]
    v_mfma_f32_16x16x32_bf16 a[64:67], a[144:147], v[72:75], a[64:67]
    v_mfma_f32_16x16x32_bf16 a[64:67], a[88:91], v[168:171], a[64:67]
    v_mfma_f32_16x16x32_bf16 a[60:63], a[88:91], v[156:159], a[60:63]
    v_mfma_f32_16x16x32_bf16 a[60:63], a[144:147], v[60:63], a[60:63]
    s_waitcnt vmcnt(0)
    v_mfma_f32_16x16x32_bf16 a[0:3], v[148:151], v[92:95], a[0:3]
    s_lshl_b32 s52, s35, 7
    v_mfma_f32_16x16x32_bf16 a[0:3], v[100:103], v[84:87], a[0:3]
    s_mul_i32 s53, s3, 1280
    v_mfma_f32_16x16x32_bf16 a[20:23], v[160:163], v[92:95], a[20:23]
    s_add_u32 s52, s52, s53
    v_mfma_f32_16x16x32_bf16 a[20:23], v[88:91], v[84:87], a[20:23]
    v_mfma_f32_16x16x32_bf16 a[40:43], v[164:167], v[92:95], a[40:43]
    v_mfma_f32_16x16x32_bf16 a[40:43], v[136:139], v[84:87], a[40:43]
    v_mfma_f32_16x16x32_bf16 a[60:63], v[152:155], v[92:95], a[60:63]
    v_mfma_f32_16x16x32_bf16 a[60:63], v[140:143], v[84:87], a[60:63]
    v_mfma_f32_16x16x32_bf16 a[4:7], v[148:151], v[104:107], a[4:7]
    ds_write_b128 v24, a[0:3] offset:0
    v_mfma_f32_16x16x32_bf16 a[4:7], v[100:103], v[96:99], a[4:7]
    v_mfma_f32_16x16x32_bf16 a[24:27], v[160:163], v[104:107], a[24:27]
    ds_write_b128 v25, a[20:23] offset:1024
    v_mfma_f32_16x16x32_bf16 a[24:27], v[88:91], v[96:99], a[24:27]
    v_mfma_f32_16x16x32_bf16 a[44:47], v[164:167], v[104:107], a[44:47]
    ds_write_b128 v26, a[40:43] offset:2048
    v_mfma_f32_16x16x32_bf16 a[44:47], v[136:139], v[96:99], a[44:47]
    v_mfma_f32_16x16x32_bf16 a[64:67], v[152:155], v[104:107], a[64:67]
    ds_write_b128 v27, a[60:63] offset:3072
    v_mfma_f32_16x16x32_bf16 a[64:67], v[140:143], v[96:99], a[64:67]
    v_mfma_f32_16x16x32_bf16 a[8:11], v[148:151], v[208:211], a[8:11]
    ds_write_b128 v24, a[4:7] offset:16384
    v_mfma_f32_16x16x32_bf16 a[8:11], v[100:103], a[196:199], a[8:11]
    v_mfma_f32_16x16x32_bf16 a[28:31], v[160:163], v[208:211], a[28:31]
    ds_write_b128 v25, a[24:27] offset:17408
    v_mfma_f32_16x16x32_bf16 a[28:31], v[88:91], a[196:199], a[28:31]
    v_mfma_f32_16x16x32_bf16 a[48:51], v[164:167], v[208:211], a[48:51]
    ds_write_b128 v26, a[44:47] offset:18432
    v_mfma_f32_16x16x32_bf16 a[48:51], v[136:139], a[196:199], a[48:51]
    v_mfma_f32_16x16x32_bf16 a[68:71], v[152:155], v[208:211], a[68:71]
    ds_write_b128 v27, a[64:67] offset:19456
    v_mfma_f32_16x16x32_bf16 a[68:71], v[140:143], a[196:199], a[68:71]
    v_mfma_f32_16x16x32_bf16 a[12:15], v[148:151], v[212:215], a[12:15]
    ds_write_b128 v24, a[8:11] offset:32768
    v_mfma_f32_16x16x32_bf16 a[12:15], v[100:103], v[116:119], a[12:15]
    v_mfma_f32_16x16x32_bf16 a[32:35], v[160:163], v[212:215], a[32:35]
    ds_write_b128 v25, a[28:31] offset:33792
    v_mfma_f32_16x16x32_bf16 a[32:35], v[88:91], v[116:119], a[32:35]
    v_mfma_f32_16x16x32_bf16 a[52:55], v[164:167], v[212:215], a[52:55]
    ds_write_b128 v26, a[48:51] offset:34816
    v_mfma_f32_16x16x32_bf16 a[52:55], v[136:139], v[116:119], a[52:55]
    v_mfma_f32_16x16x32_bf16 a[72:75], v[152:155], v[212:215], a[72:75]
    ds_write_b128 v27, a[68:71] offset:35840
    v_mfma_f32_16x16x32_bf16 a[72:75], v[140:143], v[116:119], a[72:75]
    v_mfma_f32_16x16x32_bf16 a[16:19], v[148:151], v[80:83], a[16:19]
    ds_write_b128 v24, a[12:15] offset:49152
    v_mfma_f32_16x16x32_bf16 a[16:19], v[100:103], v[120:123], a[16:19]
    v_mfma_f32_16x16x32_bf16 a[36:39], v[160:163], v[80:83], a[36:39]
    ds_write_b128 v25, a[32:35] offset:50176
    v_mfma_f32_16x16x32_bf16 a[36:39], v[88:91], v[120:123], a[36:39]
    v_mfma_f32_16x16x32_bf16 a[56:59], v[164:167], v[80:83], a[56:59]
    ds_write_b128 v26, a[52:55] offset:51200
    v_mfma_f32_16x16x32_bf16 a[56:59], v[136:139], v[120:123], a[56:59]
    v_mfma_f32_16x16x32_bf16 a[76:79], v[152:155], v[80:83], a[76:79]
    ds_write_b128 v27, a[72:75] offset:52224
    v_mfma_f32_16x16x32_bf16 a[76:79], v[140:143], v[120:123], a[76:79]
    s_nop 3
    ds_write_b128 v28, a[16:19] offset:0
    ds_write_b128 v29, a[36:39] offset:1024
    ds_write_b128 v30, a[56:59] offset:2048
    s_nop 1
    ds_write_b128 v31, a[76:79] offset:3072
    s_waitcnt lgkmcnt(0)
    s_barrier
    ds_read_b128 v[48:51], v10 offset:0
    ds_read_b128 v[52:55], v10 offset:4096
    ds_read_b128 v[56:59], v10 offset:8192
    ds_read_b128 v[60:63], v10 offset:12288
    ds_read_b128 v[64:67], v10 offset:16384
    ds_read_b128 v[68:71], v10 offset:20480
    ds_read_b128 v[72:75], v10 offset:24576
    ds_read_b128 v[76:79], v10 offset:28672
    ds_read_b128 v[80:83], v10 offset:32768
    ds_read_b128 v[84:87], v10 offset:36864
    ds_read_b128 v[88:91], v10 offset:40960
    ds_read_b128 v[92:95], v10 offset:45056
    s_waitcnt lgkmcnt(8)
    ds_read_b128 v[96:99], v10 offset:49152
    ds_read_b128 v[100:103], v10 offset:53248
    ds_read_b128 v[104:107], v10 offset:57344
    ds_read_b128 v[108:111], v10 offset:61440
    v_pk_add_f32 v[48:49], v[48:49], v[52:53]
    v_pk_add_f32 v[56:57], v[56:57], v[60:61]
    v_pk_add_f32 v[50:51], v[50:51], v[54:55]
    v_pk_add_f32 v[58:59], v[58:59], v[62:63]
    v_pk_add_f32 v[48:49], v[48:49], v[56:57]
    v_pk_add_f32 v[50:51], v[50:51], v[58:59]
    v_cvt_pk_bf16_f32 v52, v48, v49
    v_cvt_pk_bf16_f32 v53, v50, v51
    buffer_store_dwordx2 v[52:53], v21, s[72:75], s52 offen
    s_add_u32 s52, s52, 20480
    s_waitcnt lgkmcnt(8)
    ds_read_b128 v[112:115], v11 offset:0
    ds_read_b128 v[116:119], v11 offset:4096
    ds_read_b128 v[120:123], v11 offset:8192
    ds_read_b128 v[124:127], v11 offset:12288
    v_pk_add_f32 v[64:65], v[64:65], v[68:69]
    v_pk_add_f32 v[72:73], v[72:73], v[76:77]
    v_pk_add_f32 v[66:67], v[66:67], v[70:71]
    v_pk_add_f32 v[74:75], v[74:75], v[78:79]
    v_pk_add_f32 v[64:65], v[64:65], v[72:73]
    v_pk_add_f32 v[66:67], v[66:67], v[74:75]
    v_cvt_pk_bf16_f32 v68, v64, v65
    v_cvt_pk_bf16_f32 v69, v66, v67
    buffer_store_dwordx2 v[68:69], v21, s[72:75], s52 offen
    s_add_u32 s52, s52, 20480
    s_waitcnt lgkmcnt(8)
    v_pk_add_f32 v[80:81], v[80:81], v[84:85]
    v_pk_add_f32 v[88:89], v[88:89], v[92:93]
    v_pk_add_f32 v[82:83], v[82:83], v[86:87]
    v_pk_add_f32 v[90:91], v[90:91], v[94:95]
    v_pk_add_f32 v[80:81], v[80:81], v[88:89]
    v_pk_add_f32 v[82:83], v[82:83], v[90:91]
    v_cvt_pk_bf16_f32 v84, v80, v81
    v_cvt_pk_bf16_f32 v85, v82, v83
    buffer_store_dwordx2 v[84:85], v21, s[72:75], s52 offen
    s_add_u32 s52, s52, 20480
    s_waitcnt lgkmcnt(4)
    v_pk_add_f32 v[96:97], v[96:97], v[100:101]
    v_pk_add_f32 v[104:105], v[104:105], v[108:109]
    v_pk_add_f32 v[98:99], v[98:99], v[102:103]
    v_pk_add_f32 v[106:107], v[106:107], v[110:111]
    v_pk_add_f32 v[96:97], v[96:97], v[104:105]
    v_pk_add_f32 v[98:99], v[98:99], v[106:107]
    v_cvt_pk_bf16_f32 v100, v96, v97
    v_cvt_pk_bf16_f32 v101, v98, v99
    buffer_store_dwordx2 v[100:101], v21, s[72:75], s52 offen
    s_add_u32 s52, s52, 20480
    s_waitcnt lgkmcnt(0)
    v_pk_add_f32 v[112:113], v[112:113], v[116:117]
    v_pk_add_f32 v[120:121], v[120:121], v[124:125]
    v_pk_add_f32 v[114:115], v[114:115], v[118:119]
    v_pk_add_f32 v[122:123], v[122:123], v[126:127]
    v_pk_add_f32 v[112:113], v[112:113], v[120:121]
    v_pk_add_f32 v[114:115], v[114:115], v[122:123]
    v_cvt_pk_bf16_f32 v116, v112, v113
    v_cvt_pk_bf16_f32 v117, v114, v115
    buffer_store_dwordx2 v[116:117], v21, s[72:75], s52 offen
    s_add_u32 s52, s52, 20480
L1_fin:
L1_end:
    s_endpgm
L1_fallback:
    s_waitcnt vmcnt(0) lgkmcnt(0)
    s_mov_b32 s54, 0x7f800000
    s_sub_u32 s52, s96, 32768
    v_lshlrev_b32 v11, 4, v1
    s_nop 7
    v_add_u32 v16, s96, v16
    v_add_u32 v17, s96, v17
    v_add_u32 v18, s96, v18
    v_add_u32 v19, s96, v19
    v_add_u32 v20, s52, v20
    v_add_u32 v21, s52, v21
    v_add_u32 v22, s52, v22
    v_add_u32 v23, s52, v23
    v_add_u32 v24, s52, v24
    v_add_u32 v25, s52, v25
    v_add_u32 v26, s52, v26
    v_add_u32 v27, s52, v27
    v_accvgpr_write_b32 a0, 0
    v_accvgpr_write_b32 a1, 0
    v_accvgpr_write_b32 a2, 0
    v_accvgpr_write_b32 a3, 0
    v_accvgpr_write_b32 a4, 0
    v_accvgpr_write_b32 a5, 0
    v_accvgpr_write_b32 a6, 0
    v_accvgpr_write_b32 a7, 0
    v_accvgpr_write_b32 a8, 0
    v_accvgpr_write_b32 a9, 0
    v_accvgpr_write_b32 a10, 0
    v_accvgpr_write_b32 a11, 0
    v_accvgpr_write_b32 a12, 0
    v_accvgpr_write_b32 a13, 0
    v_accvgpr_write_b32 a14, 0
    v_accvgpr_write_b32 a15, 0
    v_accvgpr_write_b32 a16, 0
    v_accvgpr_write_b32 a17, 0
    v_accvgpr_write_b32 a18, 0
    v_accvgpr_write_b32 a19, 0
    v_accvgpr_write_b32 a20, 0
    v_accvgpr_write_b32 a21, 0
    v_accvgpr_write_b32 a22, 0
    v_accvgpr_write_b32 a23, 0
    v_accvgpr_write_b32 a24, 0
    v_accvgpr_write_b32 a25, 0
    v_accvgpr_write_b32 a26, 0
    v_accvgpr_write_b32 a27, 0
    v_accvgpr_write_b32 a28, 0
    v_accvgpr_write_b32 a29, 0
    v_accvgpr_write_b32 a30, 0
    v_accvgpr_write_b32 a31, 0
    v_accvgpr_write_b32 a32, 0
    v_accvgpr_write_b32 a33, 0
    v_accvgpr_write_b32 a34, 0
    v_accvgpr_write_b32 a35, 0
    v_accvgpr_write_b32 a36, 0
    v_accvgpr_write_b32 a37, 0
    v_accvgpr_write_b32 a38, 0
    v_accvgpr_write_b32 a39, 0
    v_accvgpr_write_b32 a40, 0
    v_accvgpr_write_b32 a41, 0
    v_accvgpr_write_b32 a42, 0
    v_accvgpr_write_b32 a43, 0
    v_accvgpr_write_b32 a44, 0
    v_accvgpr_write_b32 a45, 0
    v_accvgpr_write_b32 a46, 0
    v_accvgpr_write_b32 a47, 0
    v_accvgpr_write_b32 a48, 0
    v_accvgpr_write_b32 a49, 0
    v_accvgpr_write_b32 a50, 0
    v_accvgpr_write_b32 a51, 0
    v_accvgpr_write_b32 a52, 0
    v_accvgpr_write_b32 a53, 0
    v_accvgpr_write_b32 a54, 0
    v_accvgpr_write_b32 a55, 0
    v_accvgpr_write_b32 a56, 0
    v_accvgpr_write_b32 a57, 0
    v_accvgpr_write_b32 a58, 0
    v_accvgpr_write_b32 a59, 0
    v_accvgpr_write_b32 a60, 0
    v_accvgpr_write_b32 a61, 0
    v_accvgpr_write_b32 a62, 0
    v_accvgpr_write_b32 a63, 0
    v_accvgpr_write_b32 a64, 0
    v_accvgpr_write_b32 a65, 0
    v_accvgpr_write_b32 a66, 0
    v_accvgpr_write_b32 a67, 0
    v_accvgpr_write_b32 a68, 0
    v_accvgpr_write_b32 a69, 0
    v_accvgpr_write_b32 a70, 0
    v_accvgpr_write_b32 a71, 0
    v_accvgpr_write_b32 a72, 0
    v_accvgpr_write_b32 a73, 0
    v_accvgpr_write_b32 a74, 0
    v_accvgpr_write_b32 a75, 0
    v_accvgpr_write_b32 a76, 0
    v_accvgpr_write_b32 a77, 0
    v_accvgpr_write_b32 a78, 0
    v_accvgpr_write_b32 a79, 0
    v_accvgpr_write_b32 a80, 0
    v_accvgpr_write_b32 a81, 0
    v_accvgpr_write_b32 a82, 0
    v_accvgpr_write_b32 a83, 0
    v_accvgpr_write_b32 a84, 0
    v_accvgpr_write_b32 a85, 0
    v_accvgpr_write_b32 a86, 0
    v_accvgpr_write_b32 a87, 0
    v_accvgpr_write_b32 a88, 0
    v_accvgpr_write_b32 a89, 0
    v_accvgpr_write_b32 a90, 0
    v_accvgpr_write_b32 a91, 0
    v_accvgpr_write_b32 a92, 0
    v_accvgpr_write_b32 a93, 0
    v_accvgpr_write_b32 a94, 0
    v_accvgpr_write_b32 a95, 0
    v_accvgpr_write_b32 a96, 0
    v_accvgpr_write_b32 a97, 0
    v_accvgpr_write_b32 a98, 0
    v_accvgpr_write_b32 a99, 0
    v_accvgpr_write_b32 a100, 0
    v_accvgpr_write_b32 a101, 0
    v_accvgpr_write_b32 a102, 0
    v_accvgpr_write_b32 a103, 0
    v_accvgpr_write_b32 a104, 0
    v_accvgpr_write_b32 a105, 0
    v_accvgpr_write_b32 a106, 0
    v_accvgpr_write_b32 a107, 0
    v_accvgpr_write_b32 a108, 0
    v_accvgpr_write_b32 a109, 0
    v_accvgpr_write_b32 a110, 0
    v_accvgpr_write_b32 a111, 0
    v_accvgpr_write_b32 a112, 0
    v_accvgpr_write_b32 a113, 0
    v_accvgpr_write_b32 a114, 0
    v_accvgpr_write_b32 a115, 0
    v_accvgpr_write_b32 a116, 0
    v_accvgpr_write_b32 a117, 0
    v_accvgpr_write_b32 a118, 0
    v_accvgpr_write_b32 a119, 0
    v_accvgpr_write_b32 a120, 0
    v_accvgpr_write_b32 a121, 0
    v_accvgpr_write_b32 a122, 0
    v_accvgpr_write_b32 a123, 0
    v_accvgpr_write_b32 a124, 0
    v_accvgpr_write_b32 a125, 0
    v_accvgpr_write_b32 a126, 0
    v_accvgpr_write_b32 a127, 0
    v_mov_b32 v224, 0
    v_mov_b32 v225, 0
    v_mov_b32 v226, 0
    v_mov_b32 v227, 0
    v_mov_b32 v228, 0
    v_mov_b32 v229, 0
    v_mov_b32 v230, 0
    v_mov_b32 v231, 0
    v_mov_b32 v232, 0
    v_mov_b32 v233, 0
    v_mov_b32 v234, 0
    v_mov_b32 v235, 0
    v_mov_b32 v236, 0
    v_mov_b32 v237, 0
    v_mov_b32 v238, 0
    v_mov_b32 v239, 0
    v_mov_b32 v160, 0xff61b1e6
    v_mov_b32 v161, 0xff61b1e6
    v_mov_b32 v162, 0xff61b1e6
    v_mov_b32 v163, 0xff61b1e6
    s_mov_b32 s50, 0
L1_fbloop:
    s_add_u32 m0, s96, 0
    s_add_u32 s52, s50, 0
    buffer_load_dwordx4 v28, s[16:19], s52 offen offset:0 nt lds
    buffer_load_dwordx4 v29, s[16:19], s52 offen offset:1024 nt lds
    buffer_load_dwordx4 v30, s[16:19], s52 offen offset:2048 nt lds
    buffer_load_dwordx4 v31, s[16:19], s52 offen offset:3072 nt lds
    s_add_u32 m0, s96, 32768
    s_nop 0
    buffer_load_dwordx4 v32, s[20:23], s52 offen offset:0 nt lds
    buffer_load_dwordx4 v33, s[20:23], s52 offen offset:1024 nt lds
    buffer_load_dwordx4 v32, s[20:23], s52 offen offset:2048 nt lds
    buffer_load_dwordx4 v33, s[20:23], s52 offen offset:3072 nt lds
    s_add_u32 m0, s96, 16384
    s_add_u32 s52, s50, 4096
    buffer_load_dwordx4 v28, s[16:19], s52 offen offset:0 nt lds
    buffer_load_dwordx4 v29, s[16:19], s52 offen offset:1024 nt lds
    buffer_load_dwordx4 v30, s[16:19], s52 offen offset:2048 nt lds
    buffer_load_dwordx4 v31, s[16:19], s52 offen offset:3072 nt lds
    s_add_u32 m0, s96, 49152
    s_nop 0
    buffer_load_dwordx4 v32, s[20:23], s52 offen offset:0 nt lds
    buffer_load_dwordx4 v33, s[20:23], s52 offen offset:1024 nt lds
    buffer_load_dwordx4 v32, s[20:23], s52 offen offset:2048 nt lds
    buffer_load_dwordx4 v33, s[20:23], s52 offen offset:3072 nt lds
    s_waitcnt vmcnt(0)
    ds_read_b128 a[128:131], v16 offset:0
    ds_read_b128 a[132:135], v17 offset:0
    ds_read_b128 a[136:139], v18 offset:0
    ds_read_b128 a[140:143], v19 offset:0
    ds_read_b128 a[144:147], v16 offset:16384
    ds_read_b128 a[148:151], v17 offset:16384
    ds_read_b128 a[152:155], v18 offset:16384
    ds_read_b128 a[156:159], v19 offset:16384
    ds_read_b64_tr_b16 a[160:161], v20 offset:0
    ds_read_b64_tr_b16 a[162:163], v20 offset:16384
    ds_read_b64_tr_b16 a[164:165], v21 offset:0
    ds_read_b64_tr_b16 a[166:167], v21 offset:16384
    s_waitcnt lgkmcnt(0)
    ds_read_b64_tr_b16 a[168:169], v22 offset:0
    ds_read_b64_tr_b16 a[170:171], v22 offset:16384
    ds_read_b64_tr_b16 a[172:173], v23 offset:0
    ds_read_b64_tr_b16 a[174:175], v23 offset:16384
    s_waitcnt lgkmcnt(0)
    ds_read_b64_tr_b16 a[176:177], v24 offset:0
    ds_read_b64_tr_b16 a[178:179], v24 offset:16384
    ds_read_b64_tr_b16 a[180:181], v25 offset:0
    ds_read_b64_tr_b16 a[182:183], v25 offset:16384
    s_waitcnt lgkmcnt(0)
    ds_read_b64_tr_b16 a[184:185], v26 offset:0
    ds_read_b64_tr_b16 a[186:187], v26 offset:16384
    ds_read_b64_tr_b16 a[188:189], v27 offset:0
    ds_read_b64_tr_b16 a[190:191], v27 offset:16384
    s_waitcnt lgkmcnt(0)
    v_mfma_f32_16x16x32_bf16 v[112:115], a[128:131], v[48:51], 0
    v_mfma_f32_16x16x32_bf16 v[112:115], a[132:135], v[52:55], v[112:115]
    v_mfma_f32_16x16x32_bf16 v[112:115], a[136:139], v[56:59], v[112:115]
    v_mfma_f32_16x16x32_bf16 v[112:115], a[140:143], v[60:63], v[112:115]
    v_mfma_f32_16x16x32_bf16 v[116:119], a[156:159], v[60:63], 0
    v_mfma_f32_16x16x32_bf16 v[116:119], a[152:155], v[56:59], v[116:119]
    v_mfma_f32_16x16x32_bf16 v[116:119], a[148:151], v[52:55], v[116:119]
    v_mfma_f32_16x16x32_bf16 v[116:119], a[144:147], v[48:51], v[116:119]
    v_mfma_f32_16x16x32_bf16 v[124:127], a[144:147], v[64:67], 0
    v_mfma_f32_16x16x32_bf16 v[124:127], a[148:151], v[68:71], v[124:127]
    v_mfma_f32_16x16x32_bf16 v[124:127], a[152:155], v[72:75], v[124:127]
    v_mfma_f32_16x16x32_bf16 v[124:127], a[156:159], v[76:79], v[124:127]
    v_mfma_f32_16x16x32_bf16 v[120:123], a[140:143], v[76:79], 0
    v_mfma_f32_16x16x32_bf16 v[120:123], a[136:139], v[72:75], v[120:123]
    v_mfma_f32_16x16x32_bf16 v[120:123], a[132:135], v[68:71], v[120:123]
    v_mfma_f32_16x16x32_bf16 v[120:123], a[128:131], v[64:67], v[120:123]
    v_mfma_f32_16x16x32_bf16 v[128:131], a[128:131], v[80:83], 0
    v_mfma_f32_16x16x32_bf16 v[128:131], a[132:135], v[84:87], v[128:131]
    v_mfma_f32_16x16x32_bf16 v[128:131], a[136:139], v[88:91], v[128:131]
    v_mfma_f32_16x16x32_bf16 v[128:131], a[140:143], v[92:95], v[128:131]
    v_mfma_f32_16x16x32_bf16 v[132:135], a[156:159], v[92:95], 0
    v_mfma_f32_16x16x32_bf16 v[132:135], a[152:155], v[88:91], v[132:135]
    v_mfma_f32_16x16x32_bf16 v[132:135], a[148:151], v[84:87], v[132:135]
    v_mfma_f32_16x16x32_bf16 v[132:135], a[144:147], v[80:83], v[132:135]
    v_mfma_f32_16x16x32_bf16 v[140:143], a[144:147], v[96:99], 0
    v_mfma_f32_16x16x32_bf16 v[140:143], a[148:151], v[100:103], v[140:143]
    v_mfma_f32_16x16x32_bf16 v[140:143], a[152:155], v[104:107], v[140:143]
    v_mfma_f32_16x16x32_bf16 v[140:143], a[156:159], v[108:111], v[140:143]
    v_mfma_f32_16x16x32_bf16 v[136:139], a[140:143], v[108:111], 0
    v_mfma_f32_16x16x32_bf16 v[136:139], a[136:139], v[104:107], v[136:139]
    v_mfma_f32_16x16x32_bf16 v[136:139], a[132:135], v[100:103], v[136:139]
    v_mfma_f32_16x16x32_bf16 v[136:139], a[128:131], v[96:99], v[136:139]
    s_nop 7
    v_max3_f32 v164, v112, v113, v160
    v_max3_f32 v164, v164, v114, v115
    v_max3_f32 v164, v164, v116, v117
    v_max3_f32 v164, v164, v118, v119
    v_mov_b32 v165, v164
    s_nop 1
    v_permlane16_swap_b32 v164, v165
    v_max_f32 v164, v164, v165
    v_mov_b32 v165, v164
    s_nop 1
    v_permlane32_swap_b32 v164, v165
    v_max_f32 v164, v164, v165
    v_sub_f32 v166, v160, v164
    v_exp_f32 v166, v166
    v_mov_b32 v160, v164
    ds_bpermute_b32 v168, v11, v166 offset:0
    ds_bpermute_b32 v169, v11, v166 offset:4
    ds_bpermute_b32 v170, v11, v166 offset:8
    ds_bpermute_b32 v171, v11, v166 offset:12
    v_sub_f32 v112, v112, v164
    v_sub_f32 v113, v113, v164
    v_sub_f32 v114, v114, v164
    v_sub_f32 v115, v115, v164
    v_sub_f32 v116, v116, v164
    v_sub_f32 v117, v117, v164
    v_sub_f32 v118, v118, v164
    v_sub_f32 v119, v119, v164
    v_exp_f32 v112, v112
    v_exp_f32 v113, v113
    v_exp_f32 v114, v114
    v_exp_f32 v115, v115
    v_exp_f32 v116, v116
    v_exp_f32 v117, v117
    v_exp_f32 v118, v118
    v_exp_f32 v119, v119
    s_waitcnt lgkmcnt(0)
    v_cvt_pk_bf16_f32 v144, v112, v113
    v_cvt_pk_bf16_f32 v145, v114, v115
    v_cvt_pk_bf16_f32 v146, v116, v117
    v_cvt_pk_bf16_f32 v147, v118, v119
    v_mul_f32 v224, v224, v168
    v_mul_f32 v225, v225, v169
    v_mul_f32 v226, v226, v170
    v_mul_f32 v227, v227, v171
    v_accvgpr_read_b32 v165, a0
    v_mul_f32 v165, v165, v168
    v_accvgpr_write_b32 a0, v165
    v_accvgpr_read_b32 v165, a1
    v_mul_f32 v165, v165, v169
    v_accvgpr_write_b32 a1, v165
    v_accvgpr_read_b32 v165, a2
    v_mul_f32 v165, v165, v170
    v_accvgpr_write_b32 a2, v165
    v_accvgpr_read_b32 v165, a3
    v_mul_f32 v165, v165, v171
    v_accvgpr_write_b32 a3, v165
    v_accvgpr_read_b32 v165, a4
    v_mul_f32 v165, v165, v168
    v_accvgpr_write_b32 a4, v165
    v_accvgpr_read_b32 v165, a5
    v_mul_f32 v165, v165, v169
    v_accvgpr_write_b32 a5, v165
    v_accvgpr_read_b32 v165, a6
    v_mul_f32 v165, v165, v170
    v_accvgpr_write_b32 a6, v165
    v_accvgpr_read_b32 v165, a7
    v_mul_f32 v165, v165, v171
    v_accvgpr_write_b32 a7, v165
    v_accvgpr_read_b32 v165, a8
    v_mul_f32 v165, v165, v168
    v_accvgpr_write_b32 a8, v165
    v_accvgpr_read_b32 v165, a9
    v_mul_f32 v165, v165, v169
    v_accvgpr_write_b32 a9, v165
    v_accvgpr_read_b32 v165, a10
    v_mul_f32 v165, v165, v170
    v_accvgpr_write_b32 a10, v165
    v_accvgpr_read_b32 v165, a11
    v_mul_f32 v165, v165, v171
    v_accvgpr_write_b32 a11, v165
    v_accvgpr_read_b32 v165, a12
    v_mul_f32 v165, v165, v168
    v_accvgpr_write_b32 a12, v165
    v_accvgpr_read_b32 v165, a13
    v_mul_f32 v165, v165, v169
    v_accvgpr_write_b32 a13, v165
    v_accvgpr_read_b32 v165, a14
    v_mul_f32 v165, v165, v170
    v_accvgpr_write_b32 a14, v165
    v_accvgpr_read_b32 v165, a15
    v_mul_f32 v165, v165, v171
    v_accvgpr_write_b32 a15, v165
    v_accvgpr_read_b32 v165, a16
    v_mul_f32 v165, v165, v168
    v_accvgpr_write_b32 a16, v165
    v_accvgpr_read_b32 v165, a17
    v_mul_f32 v165, v165, v169
    v_accvgpr_write_b32 a17, v165
    v_accvgpr_read_b32 v165, a18
    v_mul_f32 v165, v165, v170
    v_accvgpr_write_b32 a18, v165
    v_accvgpr_read_b32 v165, a19
    v_mul_f32 v165, v165, v171
    v_accvgpr_write_b32 a19, v165
    v_accvgpr_read_b32 v165, a20
    v_mul_f32 v165, v165, v168
    v_accvgpr_write_b32 a20, v165
    v_accvgpr_read_b32 v165, a21
    v_mul_f32 v165, v165, v169
    v_accvgpr_write_b32 a21, v165
    v_accvgpr_read_b32 v165, a22
    v_mul_f32 v165, v165, v170
    v_accvgpr_write_b32 a22, v165
    v_accvgpr_read_b32 v165, a23
    v_mul_f32 v165, v165, v171
    v_accvgpr_write_b32 a23, v165
    v_accvgpr_read_b32 v165, a24
    v_mul_f32 v165, v165, v168
    v_accvgpr_write_b32 a24, v165
    v_accvgpr_read_b32 v165, a25
    v_mul_f32 v165, v165, v169
    v_accvgpr_write_b32 a25, v165
    v_accvgpr_read_b32 v165, a26
    v_mul_f32 v165, v165, v170
    v_accvgpr_write_b32 a26, v165
    v_accvgpr_read_b32 v165, a27
    v_mul_f32 v165, v165, v171
    v_accvgpr_write_b32 a27, v165
    v_accvgpr_read_b32 v165, a28
    v_mul_f32 v165, v165, v168
    v_accvgpr_write_b32 a28, v165
    v_accvgpr_read_b32 v165, a29
    v_mul_f32 v165, v165, v169
    v_accvgpr_write_b32 a29, v165
    v_accvgpr_read_b32 v165, a30
    v_mul_f32 v165, v165, v170
    v_accvgpr_write_b32 a30, v165
    v_accvgpr_read_b32 v165, a31
    v_mul_f32 v165, v165, v171
    v_accvgpr_write_b32 a31, v165
    s_nop 1
    v_mfma_f32_16x16x32_bf16 a[0:3], v[144:147], a[160:163], a[0:3]
    v_mfma_f32_16x16x32_bf16 a[4:7], v[144:147], a[164:167], a[4:7]
    v_mfma_f32_16x16x32_bf16 a[8:11], v[144:147], a[168:171], a[8:11]
    v_mfma_f32_16x16x32_bf16 a[12:15], v[144:147], a[172:175], a[12:15]
    v_mfma_f32_16x16x32_bf16 a[16:19], v[144:147], a[176:179], a[16:19]
    v_mfma_f32_16x16x32_bf16 a[20:23], v[144:147], a[180:183], a[20:23]
    v_mfma_f32_16x16x32_bf16 a[24:27], v[144:147], a[184:187], a[24:27]
    v_mfma_f32_16x16x32_bf16 a[28:31], v[144:147], a[188:191], a[28:31]
    v_mfma_f32_16x16x32_bf16 v[224:227], v[144:147], v[248:251], v[224:227]
    v_max3_f32 v164, v120, v121, v161
    v_max3_f32 v164, v164, v122, v123
    v_max3_f32 v164, v164, v124, v125
    v_max3_f32 v164, v164, v126, v127
    v_mov_b32 v165, v164
    s_nop 1
    v_permlane16_swap_b32 v164, v165
    v_max_f32 v164, v164, v165
    v_mov_b32 v165, v164
    s_nop 1
    v_permlane32_swap_b32 v164, v165
    v_max_f32 v164, v164, v165
    v_sub_f32 v166, v161, v164
    v_exp_f32 v166, v166
    v_mov_b32 v161, v164
    ds_bpermute_b32 v168, v11, v166 offset:0
    ds_bpermute_b32 v169, v11, v166 offset:4
    ds_bpermute_b32 v170, v11, v166 offset:8
    ds_bpermute_b32 v171, v11, v166 offset:12
    v_sub_f32 v120, v120, v164
    v_sub_f32 v121, v121, v164
    v_sub_f32 v122, v122, v164
    v_sub_f32 v123, v123, v164
    v_sub_f32 v124, v124, v164
    v_sub_f32 v125, v125, v164
    v_sub_f32 v126, v126, v164
    v_sub_f32 v127, v127, v164
    v_exp_f32 v120, v120
    v_exp_f32 v121, v121
    v_exp_f32 v122, v122
    v_exp_f32 v123, v123
    v_exp_f32 v124, v124
    v_exp_f32 v125, v125
    v_exp_f32 v126, v126
    v_exp_f32 v127, v127
    s_waitcnt lgkmcnt(0)
    v_cvt_pk_bf16_f32 v148, v120, v121
    v_cvt_pk_bf16_f32 v149, v122, v123
    v_cvt_pk_bf16_f32 v150, v124, v125
    v_cvt_pk_bf16_f32 v151, v126, v127
    v_mul_f32 v228, v228, v168
    v_mul_f32 v229, v229, v169
    v_mul_f32 v230, v230, v170
    v_mul_f32 v231, v231, v171
    v_accvgpr_read_b32 v165, a32
    v_mul_f32 v165, v165, v168
    v_accvgpr_write_b32 a32, v165
    v_accvgpr_read_b32 v165, a33
    v_mul_f32 v165, v165, v169
    v_accvgpr_write_b32 a33, v165
    v_accvgpr_read_b32 v165, a34
    v_mul_f32 v165, v165, v170
    v_accvgpr_write_b32 a34, v165
    v_accvgpr_read_b32 v165, a35
    v_mul_f32 v165, v165, v171
    v_accvgpr_write_b32 a35, v165
    v_accvgpr_read_b32 v165, a36
    v_mul_f32 v165, v165, v168
    v_accvgpr_write_b32 a36, v165
    v_accvgpr_read_b32 v165, a37
    v_mul_f32 v165, v165, v169
    v_accvgpr_write_b32 a37, v165
    v_accvgpr_read_b32 v165, a38
    v_mul_f32 v165, v165, v170
    v_accvgpr_write_b32 a38, v165
    v_accvgpr_read_b32 v165, a39
    v_mul_f32 v165, v165, v171
    v_accvgpr_write_b32 a39, v165
    v_accvgpr_read_b32 v165, a40
    v_mul_f32 v165, v165, v168
    v_accvgpr_write_b32 a40, v165
    v_accvgpr_read_b32 v165, a41
    v_mul_f32 v165, v165, v169
    v_accvgpr_write_b32 a41, v165
    v_accvgpr_read_b32 v165, a42
    v_mul_f32 v165, v165, v170
    v_accvgpr_write_b32 a42, v165
    v_accvgpr_read_b32 v165, a43
    v_mul_f32 v165, v165, v171
    v_accvgpr_write_b32 a43, v165
    v_accvgpr_read_b32 v165, a44
    v_mul_f32 v165, v165, v168
    v_accvgpr_write_b32 a44, v165
    v_accvgpr_read_b32 v165, a45
    v_mul_f32 v165, v165, v169
    v_accvgpr_write_b32 a45, v165
    v_accvgpr_read_b32 v165, a46
    v_mul_f32 v165, v165, v170
    v_accvgpr_write_b32 a46, v165
    v_accvgpr_read_b32 v165, a47
    v_mul_f32 v165, v165, v171
    v_accvgpr_write_b32 a47, v165
    v_accvgpr_read_b32 v165, a48
    v_mul_f32 v165, v165, v168
    v_accvgpr_write_b32 a48, v165
    v_accvgpr_read_b32 v165, a49
    v_mul_f32 v165, v165, v169
    v_accvgpr_write_b32 a49, v165
    v_accvgpr_read_b32 v165, a50
    v_mul_f32 v165, v165, v170
    v_accvgpr_write_b32 a50, v165
    v_accvgpr_read_b32 v165, a51
    v_mul_f32 v165, v165, v171
    v_accvgpr_write_b32 a51, v165
    v_accvgpr_read_b32 v165, a52
    v_mul_f32 v165, v165, v168
    v_accvgpr_write_b32 a52, v165
    v_accvgpr_read_b32 v165, a53
    v_mul_f32 v165, v165, v169
    v_accvgpr_write_b32 a53, v165
    v_accvgpr_read_b32 v165, a54
    v_mul_f32 v165, v165, v170
    v_accvgpr_write_b32 a54, v165
    v_accvgpr_read_b32 v165, a55
    v_mul_f32 v165, v165, v171
    v_accvgpr_write_b32 a55, v165
    v_accvgpr_read_b32 v165, a56
    v_mul_f32 v165, v165, v168
    v_accvgpr_write_b32 a56, v165
    v_accvgpr_read_b32 v165, a57
    v_mul_f32 v165, v165, v169
    v_accvgpr_write_b32 a57, v165
    v_accvgpr_read_b32 v165, a58
    v_mul_f32 v165, v165, v170
    v_accvgpr_write_b32 a58, v165
    v_accvgpr_read_b32 v165, a59
    v_mul_f32 v165, v165, v171
    v_accvgpr_write_b32 a59, v165
    v_accvgpr_read_b32 v165, a60
    v_mul_f32 v165, v165, v168
    v_accvgpr_write_b32 a60, v165
    v_accvgpr_read_b32 v165, a61
    v_mul_f32 v165, v165, v169
    v_accvgpr_write_b32 a61, v165
    v_accvgpr_read_b32 v165, a62
    v_mul_f32 v165, v165, v170
    v_accvgpr_write_b32 a62, v165
    v_accvgpr_read_b32 v165, a63
    v_mul_f32 v165, v165, v171
    v_accvgpr_write_b32 a63, v165
    s_nop 1
    v_mfma_f32_16x16x32_bf16 a[32:35], v[148:151], a[160:163], a[32:35]
    v_mfma_f32_16x16x32_bf16 a[36:39], v[148:151], a[164:167], a[36:39]
    v_mfma_f32_16x16x32_bf16 a[40:43], v[148:151], a[168:171], a[40:43]
    v_mfma_f32_16x16x32_bf16 a[44:47], v[148:151], a[172:175], a[44:47]
    v_mfma_f32_16x16x32_bf16 a[48:51], v[148:151], a[176:179], a[48:51]
    v_mfma_f32_16x16x32_bf16 a[52:55], v[148:151], a[180:183], a[52:55]
    v_mfma_f32_16x16x32_bf16 a[56:59], v[148:151], a[184:187], a[56:59]
    v_mfma_f32_16x16x32_bf16 a[60:63], v[148:151], a[188:191], a[60:63]
    v_mfma_f32_16x16x32_bf16 v[228:231], v[148:151], v[248:251], v[228:231]
    v_max3_f32 v164, v128, v129, v162
    v_max3_f32 v164, v164, v130, v131
    v_max3_f32 v164, v164, v132, v133
    v_max3_f32 v164, v164, v134, v135
    v_mov_b32 v165, v164
    s_nop 1
    v_permlane16_swap_b32 v164, v165
    v_max_f32 v164, v164, v165
    v_mov_b32 v165, v164
    s_nop 1
    v_permlane32_swap_b32 v164, v165
    v_max_f32 v164, v164, v165
    v_sub_f32 v166, v162, v164
    v_exp_f32 v166, v166
    v_mov_b32 v162, v164
    ds_bpermute_b32 v168, v11, v166 offset:0
    ds_bpermute_b32 v169, v11, v166 offset:4
    ds_bpermute_b32 v170, v11, v166 offset:8
    ds_bpermute_b32 v171, v11, v166 offset:12
    v_sub_f32 v128, v128, v164
    v_sub_f32 v129, v129, v164
    v_sub_f32 v130, v130, v164
    v_sub_f32 v131, v131, v164
    v_sub_f32 v132, v132, v164
    v_sub_f32 v133, v133, v164
    v_sub_f32 v134, v134, v164
    v_sub_f32 v135, v135, v164
    v_exp_f32 v128, v128
    v_exp_f32 v129, v129
    v_exp_f32 v130, v130
    v_exp_f32 v131, v131
    v_exp_f32 v132, v132
    v_exp_f32 v133, v133
    v_exp_f32 v134, v134
    v_exp_f32 v135, v135
    s_waitcnt lgkmcnt(0)
    v_cvt_pk_bf16_f32 v152, v128, v129
    v_cvt_pk_bf16_f32 v153, v130, v131
    v_cvt_pk_bf16_f32 v154, v132, v133
    v_cvt_pk_bf16_f32 v155, v134, v135
    v_mul_f32 v232, v232, v168
    v_mul_f32 v233, v233, v169
    v_mul_f32 v234, v234, v170
    v_mul_f32 v235, v235, v171
    v_accvgpr_read_b32 v165, a64
    v_mul_f32 v165, v165, v168
    v_accvgpr_write_b32 a64, v165
    v_accvgpr_read_b32 v165, a65
    v_mul_f32 v165, v165, v169
    v_accvgpr_write_b32 a65, v165
    v_accvgpr_read_b32 v165, a66
    v_mul_f32 v165, v165, v170
    v_accvgpr_write_b32 a66, v165
    v_accvgpr_read_b32 v165, a67
    v_mul_f32 v165, v165, v171
    v_accvgpr_write_b32 a67, v165
    v_accvgpr_read_b32 v165, a68
    v_mul_f32 v165, v165, v168
    v_accvgpr_write_b32 a68, v165
    v_accvgpr_read_b32 v165, a69
    v_mul_f32 v165, v165, v169
    v_accvgpr_write_b32 a69, v165
    v_accvgpr_read_b32 v165, a70
    v_mul_f32 v165, v165, v170
    v_accvgpr_write_b32 a70, v165
    v_accvgpr_read_b32 v165, a71
    v_mul_f32 v165, v165, v171
    v_accvgpr_write_b32 a71, v165
    v_accvgpr_read_b32 v165, a72
    v_mul_f32 v165, v165, v168
    v_accvgpr_write_b32 a72, v165
    v_accvgpr_read_b32 v165, a73
    v_mul_f32 v165, v165, v169
    v_accvgpr_write_b32 a73, v165
    v_accvgpr_read_b32 v165, a74
    v_mul_f32 v165, v165, v170
    v_accvgpr_write_b32 a74, v165
    v_accvgpr_read_b32 v165, a75
    v_mul_f32 v165, v165, v171
    v_accvgpr_write_b32 a75, v165
    v_accvgpr_read_b32 v165, a76
    v_mul_f32 v165, v165, v168
    v_accvgpr_write_b32 a76, v165
    v_accvgpr_read_b32 v165, a77
    v_mul_f32 v165, v165, v169
    v_accvgpr_write_b32 a77, v165
    v_accvgpr_read_b32 v165, a78
    v_mul_f32 v165, v165, v170
    v_accvgpr_write_b32 a78, v165
    v_accvgpr_read_b32 v165, a79
    v_mul_f32 v165, v165, v171
    v_accvgpr_write_b32 a79, v165
    v_accvgpr_read_b32 v165, a80
    v_mul_f32 v165, v165, v168
    v_accvgpr_write_b32 a80, v165
    v_accvgpr_read_b32 v165, a81
    v_mul_f32 v165, v165, v169
    v_accvgpr_write_b32 a81, v165
    v_accvgpr_read_b32 v165, a82
    v_mul_f32 v165, v165, v170
    v_accvgpr_write_b32 a82, v165
    v_accvgpr_read_b32 v165, a83
    v_mul_f32 v165, v165, v171
    v_accvgpr_write_b32 a83, v165
    v_accvgpr_read_b32 v165, a84
    v_mul_f32 v165, v165, v168
    v_accvgpr_write_b32 a84, v165
    v_accvgpr_read_b32 v165, a85
    v_mul_f32 v165, v165, v169
    v_accvgpr_write_b32 a85, v165
    v_accvgpr_read_b32 v165, a86
    v_mul_f32 v165, v165, v170
    v_accvgpr_write_b32 a86, v165
    v_accvgpr_read_b32 v165, a87
    v_mul_f32 v165, v165, v171
    v_accvgpr_write_b32 a87, v165
    v_accvgpr_read_b32 v165, a88
    v_mul_f32 v165, v165, v168
    v_accvgpr_write_b32 a88, v165
    v_accvgpr_read_b32 v165, a89
    v_mul_f32 v165, v165, v169
    v_accvgpr_write_b32 a89, v165
    v_accvgpr_read_b32 v165, a90
    v_mul_f32 v165, v165, v170
    v_accvgpr_write_b32 a90, v165
    v_accvgpr_read_b32 v165, a91
    v_mul_f32 v165, v165, v171
    v_accvgpr_write_b32 a91, v165
    v_accvgpr_read_b32 v165, a92
    v_mul_f32 v165, v165, v168
    v_accvgpr_write_b32 a92, v165
    v_accvgpr_read_b32 v165, a93
    v_mul_f32 v165, v165, v169
    v_accvgpr_write_b32 a93, v165
    v_accvgpr_read_b32 v165, a94
    v_mul_f32 v165, v165, v170
    v_accvgpr_write_b32 a94, v165
    v_accvgpr_read_b32 v165, a95
    v_mul_f32 v165, v165, v171
    v_accvgpr_write_b32 a95, v165
    s_nop 1
    v_mfma_f32_16x16x32_bf16 a[64:67], v[152:155], a[160:163], a[64:67]
    v_mfma_f32_16x16x32_bf16 a[68:71], v[152:155], a[164:167], a[68:71]
    v_mfma_f32_16x16x32_bf16 a[72:75], v[152:155], a[168:171], a[72:75]
    v_mfma_f32_16x16x32_bf16 a[76:79], v[152:155], a[172:175], a[76:79]
    v_mfma_f32_16x16x32_bf16 a[80:83], v[152:155], a[176:179], a[80:83]
    v_mfma_f32_16x16x32_bf16 a[84:87], v[152:155], a[180:183], a[84:87]
    v_mfma_f32_16x16x32_bf16 a[88:91], v[152:155], a[184:187], a[88:91]
    v_mfma_f32_16x16x32_bf16 a[92:95], v[152:155], a[188:191], a[92:95]
    v_mfma_f32_16x16x32_bf16 v[232:235], v[152:155], v[248:251], v[232:235]
    v_max3_f32 v164, v136, v137, v163
    v_max3_f32 v164, v164, v138, v139
    v_max3_f32 v164, v164, v140, v141
    v_max3_f32 v164, v164, v142, v143
    v_mov_b32 v165, v164
    s_nop 1
    v_permlane16_swap_b32 v164, v165
    v_max_f32 v164, v164, v165
    v_mov_b32 v165, v164
    s_nop 1
    v_permlane32_swap_b32 v164, v165
    v_max_f32 v164, v164, v165
    v_sub_f32 v166, v163, v164
    v_exp_f32 v166, v166
    v_mov_b32 v163, v164
    ds_bpermute_b32 v168, v11, v166 offset:0
    ds_bpermute_b32 v169, v11, v166 offset:4
    ds_bpermute_b32 v170, v11, v166 offset:8
    ds_bpermute_b32 v171, v11, v166 offset:12
    v_sub_f32 v136, v136, v164
    v_sub_f32 v137, v137, v164
    v_sub_f32 v138, v138, v164
    v_sub_f32 v139, v139, v164
    v_sub_f32 v140, v140, v164
    v_sub_f32 v141, v141, v164
    v_sub_f32 v142, v142, v164
    v_sub_f32 v143, v143, v164
    v_exp_f32 v136, v136
    v_exp_f32 v137, v137
    v_exp_f32 v138, v138
    v_exp_f32 v139, v139
    v_exp_f32 v140, v140
    v_exp_f32 v141, v141
    v_exp_f32 v142, v142
    v_exp_f32 v143, v143
    s_waitcnt lgkmcnt(0)
    v_cvt_pk_bf16_f32 v156, v136, v137
    v_cvt_pk_bf16_f32 v157, v138, v139
    v_cvt_pk_bf16_f32 v158, v140, v141
    v_cvt_pk_bf16_f32 v159, v142, v143
    v_mul_f32 v236, v236, v168
    v_mul_f32 v237, v237, v169
    v_mul_f32 v238, v238, v170
    v_mul_f32 v239, v239, v171
    v_accvgpr_read_b32 v165, a96
    v_mul_f32 v165, v165, v168
    v_accvgpr_write_b32 a96, v165
    v_accvgpr_read_b32 v165, a97
    v_mul_f32 v165, v165, v169
    v_accvgpr_write_b32 a97, v165
    v_accvgpr_read_b32 v165, a98
    v_mul_f32 v165, v165, v170
    v_accvgpr_write_b32 a98, v165
    v_accvgpr_read_b32 v165, a99
    v_mul_f32 v165, v165, v171
    v_accvgpr_write_b32 a99, v165
    v_accvgpr_read_b32 v165, a100
    v_mul_f32 v165, v165, v168
    v_accvgpr_write_b32 a100, v165
    v_accvgpr_read_b32 v165, a101
    v_mul_f32 v165, v165, v169
    v_accvgpr_write_b32 a101, v165
    v_accvgpr_read_b32 v165, a102
    v_mul_f32 v165, v165, v170
    v_accvgpr_write_b32 a102, v165
    v_accvgpr_read_b32 v165, a103
    v_mul_f32 v165, v165, v171
    v_accvgpr_write_b32 a103, v165
    v_accvgpr_read_b32 v165, a104
    v_mul_f32 v165, v165, v168
    v_accvgpr_write_b32 a104, v165
    v_accvgpr_read_b32 v165, a105
    v_mul_f32 v165, v165, v169
    v_accvgpr_write_b32 a105, v165
    v_accvgpr_read_b32 v165, a106
    v_mul_f32 v165, v165, v170
    v_accvgpr_write_b32 a106, v165
    v_accvgpr_read_b32 v165, a107
    v_mul_f32 v165, v165, v171
    v_accvgpr_write_b32 a107, v165
    v_accvgpr_read_b32 v165, a108
    v_mul_f32 v165, v165, v168
    v_accvgpr_write_b32 a108, v165
    v_accvgpr_read_b32 v165, a109
    v_mul_f32 v165, v165, v169
    v_accvgpr_write_b32 a109, v165
    v_accvgpr_read_b32 v165, a110
    v_mul_f32 v165, v165, v170
    v_accvgpr_write_b32 a110, v165
    v_accvgpr_read_b32 v165, a111
    v_mul_f32 v165, v165, v171
    v_accvgpr_write_b32 a111, v165
    v_accvgpr_read_b32 v165, a112
    v_mul_f32 v165, v165, v168
    v_accvgpr_write_b32 a112, v165
    v_accvgpr_read_b32 v165, a113
    v_mul_f32 v165, v165, v169
    v_accvgpr_write_b32 a113, v165
    v_accvgpr_read_b32 v165, a114
    v_mul_f32 v165, v165, v170
    v_accvgpr_write_b32 a114, v165
    v_accvgpr_read_b32 v165, a115
    v_mul_f32 v165, v165, v171
    v_accvgpr_write_b32 a115, v165
    v_accvgpr_read_b32 v165, a116
    v_mul_f32 v165, v165, v168
    v_accvgpr_write_b32 a116, v165
    v_accvgpr_read_b32 v165, a117
    v_mul_f32 v165, v165, v169
    v_accvgpr_write_b32 a117, v165
    v_accvgpr_read_b32 v165, a118
    v_mul_f32 v165, v165, v170
    v_accvgpr_write_b32 a118, v165
    v_accvgpr_read_b32 v165, a119
    v_mul_f32 v165, v165, v171
    v_accvgpr_write_b32 a119, v165
    v_accvgpr_read_b32 v165, a120
    v_mul_f32 v165, v165, v168
    v_accvgpr_write_b32 a120, v165
    v_accvgpr_read_b32 v165, a121
    v_mul_f32 v165, v165, v169
    v_accvgpr_write_b32 a121, v165
    v_accvgpr_read_b32 v165, a122
    v_mul_f32 v165, v165, v170
    v_accvgpr_write_b32 a122, v165
    v_accvgpr_read_b32 v165, a123
    v_mul_f32 v165, v165, v171
    v_accvgpr_write_b32 a123, v165
    v_accvgpr_read_b32 v165, a124
    v_mul_f32 v165, v165, v168
    v_accvgpr_write_b32 a124, v165
    v_accvgpr_read_b32 v165, a125
    v_mul_f32 v165, v165, v169
    v_accvgpr_write_b32 a125, v165
    v_accvgpr_read_b32 v165, a126
    v_mul_f32 v165, v165, v170
    v_accvgpr_write_b32 a126, v165
    v_accvgpr_read_b32 v165, a127
    v_mul_f32 v165, v165, v171
    v_accvgpr_write_b32 a127, v165
    s_nop 1
    v_mfma_f32_16x16x32_bf16 a[96:99], v[156:159], a[160:163], a[96:99]
    v_mfma_f32_16x16x32_bf16 a[100:103], v[156:159], a[164:167], a[100:103]
    v_mfma_f32_16x16x32_bf16 a[104:107], v[156:159], a[168:171], a[104:107]
    v_mfma_f32_16x16x32_bf16 a[108:111], v[156:159], a[172:175], a[108:111]
    v_mfma_f32_16x16x32_bf16 a[112:115], v[156:159], a[176:179], a[112:115]
    v_mfma_f32_16x16x32_bf16 a[116:119], v[156:159], a[180:183], a[116:119]
    v_mfma_f32_16x16x32_bf16 a[120:123], v[156:159], a[184:187], a[120:123]
    v_mfma_f32_16x16x32_bf16 a[124:127], v[156:159], a[188:191], a[124:127]
    v_mfma_f32_16x16x32_bf16 v[236:239], v[156:159], v[248:251], v[236:239]
    s_nop 7
    s_add_u32 s50, s50, 8192
    s_cmp_lt_u32 s50, 524288
    s_cbranch_scc1 L1_fbloop
    v_mov_b32 v176, 0
    v_mov_b32 v177, 0
    v_mov_b32 v178, 0
    v_mov_b32 v179, 0
    v_mov_b32 v180, 0
    v_mov_b32 v181, 0
    v_mov_b32 v182, 0
    v_mov_b32 v183, 0
    v_mov_b32 v184, 0
    v_mov_b32 v185, 0
    v_mov_b32 v186, 0
    v_mov_b32 v187, 0
    v_mov_b32 v188, 0
    v_mov_b32 v189, 0
    v_mov_b32 v190, 0
    v_mov_b32 v191, 0
    v_mov_b32 v192, 0
    v_mov_b32 v193, 0
    v_mov_b32 v194, 0
    v_mov_b32 v195, 0
    v_mov_b32 v196, 0
    v_mov_b32 v197, 0
    v_mov_b32 v198, 0
    v_mov_b32 v199, 0
    v_mov_b32 v200, 0
    v_mov_b32 v201, 0
    v_mov_b32 v202, 0
    v_mov_b32 v203, 0
    v_mov_b32 v204, 0
    v_mov_b32 v205, 0
    v_mov_b32 v206, 0
    v_mov_b32 v207, 0
    v_accvgpr_write_b32 a128, 0
    v_accvgpr_write_b32 a129, 0
    v_accvgpr_write_b32 a130, 0
    v_accvgpr_write_b32 a131, 0
    v_accvgpr_write_b32 a132, 0
    v_accvgpr_write_b32 a133, 0
    v_accvgpr_write_b32 a134, 0
    v_accvgpr_write_b32 a135, 0
    v_accvgpr_write_b32 a136, 0
    v_accvgpr_write_b32 a137, 0
    v_accvgpr_write_b32 a138, 0
    v_accvgpr_write_b32 a139, 0
    v_accvgpr_write_b32 a140, 0
    v_accvgpr_write_b32 a141, 0
    v_accvgpr_write_b32 a142, 0
    v_accvgpr_write_b32 a143, 0
    v_accvgpr_write_b32 a144, 0
    v_accvgpr_write_b32 a145, 0
    v_accvgpr_write_b32 a146, 0
    v_accvgpr_write_b32 a147, 0
    v_accvgpr_write_b32 a148, 0
    v_accvgpr_write_b32 a149, 0
    v_accvgpr_write_b32 a150, 0
    v_accvgpr_write_b32 a151, 0
    v_accvgpr_write_b32 a152, 0
    v_accvgpr_write_b32 a153, 0
    v_accvgpr_write_b32 a154, 0
    v_accvgpr_write_b32 a155, 0
    v_accvgpr_write_b32 a156, 0
    v_accvgpr_write_b32 a157, 0
    v_accvgpr_write_b32 a158, 0
    v_accvgpr_write_b32 a159, 0
    v_accvgpr_write_b32 a160, 0
    v_accvgpr_write_b32 a161, 0
    v_accvgpr_write_b32 a162, 0
    v_accvgpr_write_b32 a163, 0
    v_accvgpr_write_b32 a164, 0
    v_accvgpr_write_b32 a165, 0
    v_accvgpr_write_b32 a166, 0
    v_accvgpr_write_b32 a167, 0
    v_accvgpr_write_b32 a168, 0
    v_accvgpr_write_b32 a169, 0
    v_accvgpr_write_b32 a170, 0
    v_accvgpr_write_b32 a171, 0
    v_accvgpr_write_b32 a172, 0
    v_accvgpr_write_b32 a173, 0
    v_accvgpr_write_b32 a174, 0
    v_accvgpr_write_b32 a175, 0
    v_accvgpr_write_b32 a176, 0
    v_accvgpr_write_b32 a177, 0
    v_accvgpr_write_b32 a178, 0
    v_accvgpr_write_b32 a179, 0
    v_accvgpr_write_b32 a180, 0
    v_accvgpr_write_b32 a181, 0
    v_accvgpr_write_b32 a182, 0
    v_accvgpr_write_b32 a183, 0
    v_accvgpr_write_b32 a184, 0
    v_accvgpr_write_b32 a185, 0
    v_accvgpr_write_b32 a186, 0
    v_accvgpr_write_b32 a187, 0
    v_accvgpr_write_b32 a188, 0
    v_accvgpr_write_b32 a189, 0
    v_accvgpr_write_b32 a190, 0
    v_accvgpr_write_b32 a191, 0
    s_add_u32 m0, s47, 0
    s_add_u32 s33, s45, 0
    buffer_load_dwordx4 v244, s[64:67], s33 offen offset:0 lds
    buffer_load_dwordx4 v245, s[64:67], s33 offen offset:1024 lds
    buffer_load_dwordx4 v246, s[64:67], s33 offen offset:2048 lds
    buffer_load_dwordx4 v247, s[64:67], s33 offen offset:3072 lds
    s_add_u32 m0, s96, 65536
    s_add_u32 s33, s45, 5120
    buffer_load_dwordx4 v244, s[64:67], s33 offen offset:0 lds
    buffer_load_dwordx4 v245, s[64:67], s33 offen offset:1024 lds
    buffer_load_dwordx4 v246, s[64:67], s33 offen offset:2048 lds
    buffer_load_dwordx4 v247, s[64:67], s33 offen offset:3072 lds
    s_add_u32 m0, s47, 4096
    s_add_u32 s33, s45, 10240
    buffer_load_dwordx4 v244, s[64:67], s33 offen offset:0 lds
    buffer_load_dwordx4 v245, s[64:67], s33 offen offset:1024 lds
    buffer_load_dwordx4 v246, s[64:67], s33 offen offset:2048 lds
    buffer_load_dwordx4 v247, s[64:67], s33 offen offset:3072 lds
    s_add_u32 m0, s96, 32768
    s_add_u32 s33, s45, 15360
    buffer_load_dwordx4 v244, s[64:67], s33 offen offset:0 lds
    buffer_load_dwordx4 v245, s[64:67], s33 offen offset:1024 lds
    buffer_load_dwordx4 v246, s[64:67], s33 offen offset:2048 lds
    buffer_load_dwordx4 v247, s[64:67], s33 offen offset:3072 lds
    s_add_u32 m0, s96, 0
    s_add_u32 s33, s45, 163840
    buffer_load_dwordx4 v244, s[64:67], s33 offen offset:0 lds
    buffer_load_dwordx4 v245, s[64:67], s33 offen offset:1024 lds
    buffer_load_dwordx4 v246, s[64:67], s33 offen offset:2048 lds
    buffer_load_dwordx4 v247, s[64:67], s33 offen offset:3072 lds
    s_add_u32 m0, s96, 81920
    s_add_u32 s33, s45, 168960
    buffer_load_dwordx4 v244, s[64:67], s33 offen offset:0 lds
    buffer_load_dwordx4 v245, s[64:67], s33 offen offset:1024 lds
    buffer_load_dwordx4 v246, s[64:67], s33 offen offset:2048 lds
    buffer_load_dwordx4 v247, s[64:67], s33 offen offset:3072 lds
    s_add_u32 m0, s96, 16384
    s_add_u32 s33, s45, 174080
    buffer_load_dwordx4 v244, s[64:67], s33 offen offset:0 lds
    buffer_load_dwordx4 v245, s[64:67], s33 offen offset:1024 lds
    buffer_load_dwordx4 v246, s[64:67], s33 offen offset:2048 lds
    buffer_load_dwordx4 v247, s[64:67], s33 offen offset:3072 lds
    s_add_u32 m0, s96, 49152
    s_add_u32 s33, s45, 179200
    buffer_load_dwordx4 v244, s[64:67], s33 offen offset:0 lds
    buffer_load_dwordx4 v245, s[64:67], s33 offen offset:1024 lds
    buffer_load_dwordx4 v246, s[64:67], s33 offen offset:2048 lds
    buffer_load_dwordx4 v247, s[64:67], s33 offen offset:3072 lds
    s_add_u32 m0, s96, 98304
    s_add_u32 s33, s45, 327680
    buffer_load_dwordx4 v244, s[64:67], s33 offen offset:0 lds
    buffer_load_dwordx4 v245, s[64:67], s33 offen offset:1024 lds
    buffer_load_dwordx4 v246, s[64:67], s33 offen offset:2048 lds
    buffer_load_dwordx4 v247, s[64:67], s33 offen offset:3072 lds
    s_branch L1_epi
.section .rodata,"a"
.p2align 6
.amdhsa_kernel standalone__mha_block_cached__near_ridge_kernel
  .amdhsa_next_free_vgpr 512
  .amdhsa_next_free_sgpr 102
  .amdhsa_accum_offset 256
  .amdhsa_group_segment_fixed_size 0
  .amdhsa_kernarg_size 64
  .amdhsa_user_sgpr_count 2
  .amdhsa_user_sgpr_kernarg_segment_ptr 1
  .amdhsa_system_sgpr_workgroup_id_x 1
.end_amdhsa_kernel
```
